```python
import torch

def _softmax(x, axis=-1):
    return torch.softmax(x, dim=axis)
def _gelu(x):
    return torch.nn.functional.gelu(x, approximate="tanh")
def _silu(x):
    return torch.nn.functional.silu(x)
def _sigmoid(x):
    return torch.sigmoid(x)
def _layernorm(x, axis=-1, eps=1e-5):
    m = x.mean(dim=axis, keepdim=True)
    v = x.var(dim=axis, keepdim=True, unbiased=False)
    return (x - m) / torch.sqrt(v + eps)
def _scatter_add(tgt, idx, src, axis=0):
    return tgt.clone().index_add_(axis, idx, src)
def _segment_sum(src, seg, n):
    out = torch.zeros((n,) + src.shape[1:], dtype=src.dtype)
    return out.index_add_(0, seg, src)
def _pad(x, pw):
    flat = tuple(v for pair in reversed(pw) for v in pair)
    return torch.nn.functional.pad(x, flat)

kernel_name = 'interleave_layers__spectral_gfnet__mixer_token_mlp__prompt'

def setup_inputs():

    _w = (lambda a: (lambda t: t.to(torch.bfloat16) if t.is_floating_point() else t)(torch.as_tensor(a)))
    def _A_setup():
        B, S, D = 1, 2048, 448
        Df = D // 2 + 1
        return {
            "x": _w((lambda *s: torch.randn(*s, dtype=torch.bfloat16) * 0.05)(B, S, D)),
            "w_r": _w((lambda *s: torch.randn(*s, dtype=torch.bfloat16) * 1.6)(S, Df) * 0.02),
            "w_i": _w((lambda *s: torch.randn(*s, dtype=torch.bfloat16) * 1.6)(S, Df) * 0.02),
        }
    _A_in = _A_setup()

    def _B_setup():
        B, S, D, F = 1, 2048, 448, 1792
        return {
            "x": _w((lambda *s: torch.randn(*s, dtype=torch.bfloat16) * 0.05)(B, S, D)),
            "w1": _w((lambda *s: torch.randn(*s, dtype=torch.bfloat16) * 0.4)(S, F) * (S ** -0.5)),
            "b1": _w((lambda *s: torch.randn(*s, dtype=torch.bfloat16) * 3.2)(F) * 0.02),
            "w2": _w((lambda *s: torch.randn(*s, dtype=torch.bfloat16) * 0.8)(F, S) * (F ** -0.5)),
            "b2": _w((lambda *s: torch.randn(*s, dtype=torch.bfloat16) * 3.2)(S) * 0.02),
        }
    _B_in = _B_setup()

    return {
        "A_x": _A_in["x"],
        "A_w_r": _A_in["w_r"],
        "A_w_i": _A_in["w_i"],
        "B_x": _B_in["x"],
        "B_w1": _B_in["w1"],
        "B_b1": _B_in["b1"],
        "B_w2": _B_in["w2"],
        "B_b2": _B_in["b2"],
    }

def reference(A_x, A_w_r, A_w_i, B_x, B_w1, B_b1, B_w2, B_b2):
    def _A_ref(x, w_r, w_i):
        B, S, D = x.shape
        X = (lambda x, axes=(-2,-1): torch.fft.rfft2(x.float(), dim=axes))(x, axes=(-2, -1))
        W = w_r + 1j * w_i
        X = X * W
        y = (lambda x, s, axes=(-2,-1): torch.fft.irfft2(x, s=s, dim=axes).to(torch.bfloat16))(X, (S, D), axes=(-2, -1))
        return y

    def _B_ref(x, w1, b1, w2, b2):
        B, S, D = x.shape
        h = _layernorm(x, axis=-1)
        u = torch.einsum("bsd,sf->bdf", h, w1) + b1
        u = _gelu(u)
        y = torch.einsum("bdf,fs->bds", u, w2) + b2
        return (lambda x, *d: x.permute(*d))(y, 0, 2, 1)

    x = A_x
    x = x + _A_ref(_layernorm(x, axis=-1), A_w_r, A_w_i)
    x = x + _B_ref(_layernorm(x, axis=-1), B_w1, B_b1, B_w2, B_b2)
    x = x + _A_ref(_layernorm(x, axis=-1), A_w_r, A_w_i)
    x = x + _B_ref(_layernorm(x, axis=-1), B_w1, B_b1, B_w2, B_b2)
    return x
```

```asm
; @launch grid=(256,1,1) block=(256,1,1) lds=163840
.amdgcn_target "amdgcn-amd-amdhsa--gfx950"
.text
.globl interleave_layers__spectral_gfnet__mixer_token_mlp__prompt_kernel
.p2align 8
.type interleave_layers__spectral_gfnet__mixer_token_mlp__prompt_kernel,@function
interleave_layers__spectral_gfnet__mixer_token_mlp__prompt_kernel:
    s_cmp_ge_u32 s2, 256
    s_cbranch_scc1 L_exit
    s_load_dwordx16 s[32:47], s[0:1], 0
    s_load_dwordx4 s[56:59], s[0:1], 64
    s_load_dwordx2 s[60:61], s[0:1], 80
    s_getpc_b64 s[48:49]
L_pc0:
    s_add_u32 s24, s48, interleave_layers__spectral_gfnet__mixer_token_mlp__prompt_kernel-L_pc0
    s_addc_u32 s49, s49, -1
    s_and_b32 s25, s49, 0xffff
    s_mov_b32 s26, L_table_end-interleave_layers__spectral_gfnet__mixer_token_mlp__prompt_kernel
    s_mov_b32 s27, 0x00020000
    v_readfirstlane_b32 s3, v0
    v_and_b32 v1, 63, v0
    v_lshlrev_b32 v121, 4, v1
    s_lshr_b32 s3, s3, 6
    s_nop 0
    s_mul_i32 s50, s3, 3072
    s_add_u32 m0, s50, 17920
    s_add_u32 s50, s50, L_table-interleave_layers__spectral_gfnet__mixer_token_mlp__prompt_kernel
    buffer_load_dwordx4 v121, s[24:27], s50 offen offset:0  lds
    buffer_load_dwordx4 v121, s[24:27], s50 offen offset:1024  lds
    buffer_load_dwordx4 v121, s[24:27], s50 offen offset:2048  lds
    s_bfe_u32 s50, s2, 0x30003
    s_lshl_b32 s50, s50, 2
    s_add_u32 s50, s50, s3
    s_mul_i32 s50, s50, 1408
    v_lshlrev_b32_e64 v120, 7, v1
    s_mov_b64 exec, 0x7ff
    buffer_load_dword v118, v120, s[24:27], s50 offen
    s_mov_b64 exec, -1
    s_lshl_b32 s51, s3, 11
    v_add_u32_e64 v116, s51, v121
    v_min_u32 v122, 880, v121
    s_lshl_b32 s48, s3, 9
    s_add_u32 s48, s48, s2
    s_mul_i32 s85, s48, 896
    s_add_u32 s86, s85, 229376
    v_lshlrev_b32_e64 v123, 4, v0
    v_min_u32 v123, 3584, v123
    s_mov_b32 s64, 0
    s_waitcnt lgkmcnt(0)
    s_mov_b32 s8, s32
    s_nop 0
    s_and_b32 s9, s33, 0xffff
    s_mov_b32 s10, 1835008
    s_mov_b32 s11, 0x00020000
    buffer_load_dwordx4 v[100:103], v122, s[8:11], s85 offen
    buffer_load_dwordx4 v[104:107], v122, s[8:11], s86 offen
    s_mov_b32 s4, s60
    s_nop 0
    s_and_b32 s5, s61, 0xffff
    s_mov_b32 s6, 31457280
    s_mov_b32 s7, 0x00020000
    s_add_u32 s48, s60, 25165824
    s_addc_u32 s49, s61, 0
    s_load_dword s69, s[48:49], 0
    s_lshl_b32 s50, s3, 12
    s_add_u32 m0, s50, 30208
    s_add_u32 s50, s50, L_table-interleave_layers__spectral_gfnet__mixer_token_mlp__prompt_kernel+12288
    buffer_load_dwordx4 v121, s[24:27], s50 offen offset:0  lds
    buffer_load_dwordx4 v121, s[24:27], s50 offen offset:1024  lds
    buffer_load_dwordx4 v121, s[24:27], s50 offen offset:2048  lds
    buffer_load_dwordx4 v121, s[24:27], s50 offen offset:3072  lds
    s_mov_b32 m0, 46592
    s_mov_b32 s50, L_table-interleave_layers__spectral_gfnet__mixer_token_mlp__prompt_kernel+28672
    buffer_load_dwordx4 v121, s[24:27], s50 offen lds
    s_mov_b32 s24, s34
    s_and_b32 s25, s35, 0xffff
    s_mov_b32 s26, 921600
    s_mov_b32 s27, 0x00020000
    s_mov_b32 s28, s36
    s_and_b32 s29, s37, 0xffff
    s_mov_b32 s30, 921600
    s_mov_b32 s31, 0x00020000
    s_mul_i32 s52, s2, 3600
    s_lshl_b32 s53, s3, 10
    s_add_u32 m0, s53, 73728
    s_nop 0
    buffer_load_dwordx4 v123, s[24:27], s52 offen  lds
    s_add_u32 m0, s53, 77824
    s_nop 0
    buffer_load_dwordx4 v123, s[28:31], s52 offen  lds
    s_mov_b32 s16, s40
    s_and_b32 s17, s41, 0xffff
    s_mov_b32 s18, 7340032
    s_mov_b32 s19, 0x00020000
    s_mov_b32 s65, 0
    s_mov_b32 s67, 200000
    s_mov_b64 s[96:97], s[56:57]
    s_add_u32 s12, s60, 23068672
    s_addc_u32 s13, s61, 0
    s_nop 0
    s_and_b32 s13, s13, 0xffff
    s_mov_b32 s14, 1835008
    s_mov_b32 s15, 0x00020000
    v_bfe_u32 v125, v0, 4, 2
    v_and_b32 v126, 1, v0
    v_lshlrev_b32 v125, 1, v125
    v_cmp_eq_u32_e64 vcc, 1, v126
    v_bfe_u32 v124, v0, 1, 3
    v_lshl_add_u32 v126, v125, 8, s2
    v_lshl_add_u32 v127, v124, 8, s2
    v_mul_u32_u24 v126, v126, v124
    v_mul_u32_u24 v127, v127, v125
    v_cvt_f32_u32 v126, v126
    v_cvt_f32_u32 v127, v127
    v_mul_f32 v126, 0x3a000000, v126
    v_mul_f32 v127, 0x3a000000, v127
    v_cos_f32 v128, v126
    v_sin_f32 v129, v126
    v_lshl_add_u32 v126, v125, 8, s2
    v_cvt_pk_bf16_f32 v130, v128, v129
    v_cvt_pk_bf16_f32 v131, -v129, v128
    v_add_u32 v126, 256, v126
    v_cos_f32 v128, v127
    v_sin_f32 v129, v127
    v_mul_u32_u24 v126, v126, v124
    v_cndmask_b32 v2, v130, v131, vcc
    v_cvt_f32_u32 v126, v126
    v_add_u32 v125, 1, v125
    v_mul_f32 v126, 0x3a000000, v126
    v_lshl_add_u32 v127, v124, 8, s2
    v_cvt_pk_bf16_f32 v130, v128, -v129
    v_cvt_pk_bf16_f32 v131, v129, v128
    v_cos_f32 v128, v126
    v_sin_f32 v129, v126
    v_mul_u32_u24 v127, v127, v125
    v_cndmask_b32 v96, v130, v131, vcc
    v_cvt_f32_u32_e64 v127, v127
    v_cvt_pk_bf16_f32 v130, v128, v129
    v_mul_f32 v127, 0x3a000000, v127
    v_cvt_pk_bf16_f32 v131, -v129, v128
    v_cos_f32 v128, v127
    v_sin_f32 v129, v127
    v_cndmask_b32_e64 v3, v130, v131, vcc
    v_cvt_pk_bf16_f32 v130, v128, -v129
    v_cvt_pk_bf16_f32 v131, v129, v128
    v_cndmask_b32 v97, v130, v131, vcc
    s_waitcnt vmcnt(7) lgkmcnt(0)
    s_barrier
    s_nop 0
    s_mul_i32 s68, s69, 0x9E3779B1
    s_add_u32 s68, s68, 0x7F4A7C15
    ds_read_b128 v[4:7], v121 offset:17920
    ds_read_b128 v[8:11], v121 offset:18944
    ds_read_b128 v[12:15], v121 offset:19968
    ds_read_b128 v[16:19], v121 offset:20992
    ds_read_b128 v[20:23], v121 offset:22016
    ds_read_b128 v[24:27], v121 offset:23040
    ds_read_b128 v[28:31], v121 offset:24064
    ds_read_b128 v[32:35], v121 offset:25088
    ds_read_b128 v[36:39], v121 offset:26112
    ds_read_b128 v[40:43], v121 offset:27136
    ds_read_b128 v[44:47], v121 offset:28160
    s_waitcnt lgkmcnt(0)
    s_lshl_b32 s48, s3, 11
    v_add_u32_e64 v39, s48, v39
    s_mul_i32 s49, s3, 2176
    s_add_u32 s49, s49, 8192
    v_add_u32 v40, s49, v40
    s_lshl_b32 s49, s3, 9
    s_add_u32 s50, s49, 8192
    v_add_u32 v41, s50, v41
    s_lshl_b32 s50, s2, 11
    s_add_u32 s50, s50, s49
    v_add_u32 v42, s50, v42
L_layer:
    s_cmp_eq_u32 s64, 0
    s_cbranch_scc1 L_p1go_2
    s_mov_b32 s66, 0
L_p1poll_3:
    buffer_load_dwordx4 v[100:103], v38, s[8:11], s85 offen sc1
    buffer_load_dwordx4 v[104:107], v38, s[8:11], s86 offen sc1
    s_waitcnt vmcnt(0)
    v_max3_u32 v120, v100, v101, v102
    v_max3_u32 v120, v120, v103, v104
    v_max3_u32 v120, v120, v105, v106
    v_max_u32 v120, v120, v107
    v_cmp_eq_u32 vcc, -1, v120
    s_cbranch_vccz L_p1polld_4
    s_add_u32 s66, s66, 1
    s_cmp_lt_u32 s66, s67
    s_sleep 4
    s_cbranch_scc1 L_p1poll_3
    s_mov_b32 s67, 1
L_p1polld_4:
L_p1go_2:
    ds_write_b128 v116, v[100:103]
    ds_write_b128 v116, v[104:107] offset:1024
    ds_read_b64_tr_b16 v[100:101], v39 offset:0
    ds_read_b64_tr_b16 v[102:103], v39 offset:32
    ds_read_b64_tr_b16 v[104:105], v39 offset:1024
    ds_read_b64_tr_b16 v[106:107], v39 offset:1056
    s_waitcnt lgkmcnt(3)
    v_readlane_b32 s94, v100, 0
    v_and_b32 v123, 0xffff0000, v100
    s_waitcnt lgkmcnt(1)
    v_readlane_b32 s95, v104, 0
    s_pack_ll_b32_b16 s54, s94, s94
    s_lshl_b32 s94, s94, 16
    s_pack_ll_b32_b16 s55, s95, s95
    v_lshlrev_b32 v134, 16, v104
    s_lshl_b32 s95, s95, 16
    v_bfi_b32 v101, v43, v101, s54
    v_lshlrev_b32 v122, 16, v100
    v_and_b32 v127, 0xffff0000, v102
    v_pk_add_f32 v[122:123], v[122:123], s[94:95] op_sel_hi:[1,0] neg_lo:[0,1] neg_hi:[0,1]
    v_bfi_b32 v105, v43, v105, s55
    v_pk_mul_f32 v[154:155], v[122:123], v[122:123]
    v_and_b32 v137, 0xffff0000, v105
    v_lshlrev_b32 v136, 16, v105
    s_waitcnt lgkmcnt(0)
    v_bfi_b32 v107, v43, v107, s55
    v_pk_add_f32 v[136:137], v[136:137], s[94:95] op_sel:[0,1] op_sel_hi:[1,1] neg_lo:[0,1] neg_hi:[0,1]
    v_and_b32 v141, 0xffff0000, v107
    v_and_b32 v135, 0xffff0000, v104
    v_and_b32 v139, 0xffff0000, v106
    v_pk_add_f32 v[134:135], v[134:135], s[94:95] op_sel:[0,1] op_sel_hi:[1,1] neg_lo:[0,1] neg_hi:[0,1]
    v_and_b32 v125, 0xffff0000, v101
    v_pk_add_f32 v[152:153], v[134:135], v[136:137]
    v_pk_mul_f32 v[156:157], v[134:135], v[134:135]
    v_cvt_pk_bf16_f32 v142, v122, v123
    v_pk_fma_f32 v[156:157], v[136:137], v[136:137], v[156:157]
    v_lshlrev_b32 v126, 16, v102
    v_lshlrev_b32 v140, 16, v107
    v_pk_add_f32 v[126:127], v[126:127], s[94:95] op_sel_hi:[1,0] neg_lo:[0,1] neg_hi:[0,1]
    v_pk_add_f32 v[140:141], v[140:141], s[94:95] op_sel:[0,1] op_sel_hi:[1,1] neg_lo:[0,1] neg_hi:[0,1]
    v_lshlrev_b32 v124, 16, v101
    v_lshlrev_b32 v138, 16, v106
    v_pk_add_f32 v[124:125], v[124:125], s[94:95] op_sel_hi:[1,0] neg_lo:[0,1] neg_hi:[0,1]
    v_pk_add_f32 v[138:139], v[138:139], s[94:95] op_sel:[0,1] op_sel_hi:[1,1] neg_lo:[0,1] neg_hi:[0,1]
    v_pk_add_f32 v[150:151], v[122:123], v[124:125]
    v_pk_add_f32 v[152:153], v[152:153], v[138:139]
    v_pk_fma_f32 v[154:155], v[124:125], v[124:125], v[154:155]
    v_pk_add_f32 v[152:153], v[152:153], v[140:141]
    v_pk_add_f32 v[150:151], v[150:151], v[126:127]
    v_pk_fma_f32 v[154:155], v[126:127], v[126:127], v[154:155]
    v_pk_fma_f32 v[156:157], v[138:139], v[138:139], v[156:157]
    v_cvt_pk_bf16_f32 v143, v124, v125
    v_pk_fma_f32 v[156:157], v[140:141], v[140:141], v[156:157]
    v_cvt_pk_bf16_f32 v148, v138, v139
    v_mfma_f32_16x16x16_bf16 v[176:179], v[142:143], v[4:5], 0
    v_cvt_pk_bf16_f32 v146, v134, v135
    v_bfi_b32 v103, v43, v103, s54
    v_mfma_f32_16x16x16_bf16 v[180:183], v[142:143], v[6:7], 0
    v_and_b32 v129, 0xffff0000, v103
    v_lshlrev_b32 v128, 16, v103
    v_add_f32 v156, v156, v157
    v_add_f32_e64 v152, v152, v153
    v_cvt_pk_bf16_f32 v144, v126, v127
    v_pk_add_f32 v[128:129], v[128:129], s[94:95] op_sel_hi:[1,0] neg_lo:[0,1] neg_hi:[0,1]
    v_pk_mul_f32 v[158:159], v[176:177], v[16:17]
    v_pk_add_f32 v[150:151], v[150:151], v[128:129]
    v_pk_fma_f32 v[154:155], v[128:129], v[128:129], v[154:155]
    v_pk_mul_f32 v[176:177], v[176:177], v[8:9]
    v_pk_mul_f32 v[160:161], v[178:179], v[18:19]
    v_pk_fma_f32 v[176:177], v[180:181], v[16:17], v[176:177]
    v_pk_mul_f32 v[178:179], v[178:179], v[10:11]
    v_pk_fma_f32 v[180:181], v[180:181], v[8:9], v[158:159] neg_lo:[0,0,1] neg_hi:[0,0,1]
    v_pk_fma_f32 v[178:179], v[182:183], v[18:19], v[178:179]
    v_pk_fma_f32 v[182:183], v[182:183], v[10:11], v[160:161] neg_lo:[0,0,1] neg_hi:[0,0,1]
    v_add_f32 v150, v150, v151
    v_add_f32 v154, v154, v155
    v_cvt_pk_bf16_f32 v145, v128, v129
    v_cvt_pk_bf16_f32 v149, v140, v141
    v_cvt_pk_bf16_f32 v147, v136, v137
    v_mfma_f32_16x16x16_bf16 v[184:187], v[144:145], v[4:5], 0
    v_permlane32_swap_b32 v150, v152
    v_mfma_f32_16x16x16_bf16 v[200:203], v[148:149], v[4:5], 0
    v_permlane32_swap_b32 v154, v156
    v_mfma_f32_16x16x16_bf16 v[192:195], v[146:147], v[4:5], 0
    v_add_f32 v150, v150, v152
    v_add_f32 v154, v154, v156
    v_mfma_f32_16x16x16_bf16 v[196:199], v[146:147], v[6:7], 0
    s_nop 0
    v_permlane16_swap_b32 v150, v154
    v_mfma_f32_16x16x16_bf16 v[188:191], v[144:145], v[6:7], 0
    v_add_f32_e64 v150, v150, v154
    v_cvt_pk_bf16_f32 v212, v180, v181
    v_mfma_f32_16x16x16_bf16 v[204:207], v[148:149], v[6:7], 0
    v_add_f32_dpp v150, v150, v150 row_ror:8 row_mask:0xf bank_mask:0xf
    v_cvt_pk_bf16_f32 v209, v178, v179
    v_cvt_pk_bf16_f32 v208, v176, v177
    v_add_f32_dpp v150, v150, v150 row_ror:4 row_mask:0xf bank_mask:0xf
    v_cvt_pk_bf16_f32 v213, v182, v183
    v_pk_mul_f32 v[172:173], v[202:203], v[22:23]
    v_pk_mul_f32 v[164:165], v[186:187], v[22:23]
    v_pk_mul_f32 v[166:167], v[192:193], v[16:17]
    v_pk_mul_f32 v[162:163], v[184:185], v[20:21]
    v_pk_mul_f32 v[202:203], v[202:203], v[14:15]
    v_pk_mul_f32 v[192:193], v[192:193], v[8:9]
    v_pk_fma_f32 v[202:203], v[206:207], v[22:23], v[202:203]
    v_pk_fma_f32 v[192:193], v[196:197], v[16:17], v[192:193]
    v_pk_fma_f32 v[196:197], v[196:197], v[8:9], v[166:167] neg_lo:[0,0,1] neg_hi:[0,0,1]
    v_pk_mul_f32 v[184:185], v[184:185], v[12:13]
    v_pk_mul_f32 v[170:171], v[200:201], v[20:21]
    v_pk_mul_f32 v[200:201], v[200:201], v[12:13]
    v_pk_fma_f32 v[184:185], v[188:189], v[20:21], v[184:185]
    v_pk_mul_f32 v[168:169], v[194:195], v[18:19]
    v_pk_mul_f32 v[194:195], v[194:195], v[10:11]
    v_pk_mul_f32 v[186:187], v[186:187], v[14:15]
    v_pk_fma_f32 v[194:195], v[198:199], v[18:19], v[194:195]
    v_pk_fma_f32 v[198:199], v[198:199], v[10:11], v[168:169] neg_lo:[0,0,1] neg_hi:[0,0,1]
    v_pk_fma_f32 v[186:187], v[190:191], v[22:23], v[186:187]
    v_pk_fma_f32 v[190:191], v[190:191], v[14:15], v[164:165] neg_lo:[0,0,1] neg_hi:[0,0,1]
    v_pk_fma_f32 v[188:189], v[188:189], v[12:13], v[162:163] neg_lo:[0,0,1] neg_hi:[0,0,1]
    v_pk_fma_f32 v[200:201], v[204:205], v[20:21], v[200:201]
    v_pk_fma_f32 v[204:205], v[204:205], v[12:13], v[170:171] neg_lo:[0,0,1] neg_hi:[0,0,1]
    v_pk_fma_f32 v[206:207], v[206:207], v[14:15], v[172:173] neg_lo:[0,0,1] neg_hi:[0,0,1]
    v_cvt_pk_bf16_f32 v215, v190, v191
    v_cvt_pk_bf16_f32 v214, v188, v189
    v_cvt_pk_bf16_f32 v223, v206, v207
    v_cvt_pk_bf16_f32 v211, v186, v187
    v_mfma_f32_16x16x32_bf16 v[228:231], v[24:27], v[212:215], 0
    v_cvt_pk_bf16_f32 v219, v202, v203
    v_cvt_pk_bf16_f32 v217, v194, v195
    v_cvt_pk_bf16_f32 v220, v196, v197
    v_cvt_pk_bf16_f32 v210, v184, v185
    v_cvt_pk_bf16_f32 v218, v200, v201
    v_add_f32_dpp v150, v150, v150 row_ror:2 row_mask:0xf bank_mask:0xf
    v_mfma_f32_16x16x32_bf16 v[228:231], v[32:35], v[208:211], v[228:231]
    v_cvt_pk_bf16_f32 v221, v198, v199
    v_cvt_pk_bf16_f32 v216, v192, v193
    v_mfma_f32_16x16x32_bf16 v[224:227], v[24:27], v[208:211], 0
    v_cvt_pk_bf16_f32 v222, v204, v205
    v_add_f32_dpp v150, v150, v150 row_ror:1 row_mask:0xf bank_mask:0xf
    v_mfma_f32_16x16x32_bf16 v[232:235], v[24:27], v[216:219], 0
    v_readlane_b32 s50, v150, 16
    v_readlane_b32 s51, v150, 48
    v_mfma_f32_16x16x32_bf16 v[236:239], v[24:27], v[220:223], 0
    v_readlane_b32 s49, v150, 32
    v_readlane_b32 s48, v150, 0
    v_mfma_f32_16x16x32_bf16 v[224:227], v[28:31], v[212:215], v[224:227]
    v_mul_f32 v153, s51, v36
    v_mul_f32 v152, s50, v36
    v_mfma_f32_16x16x32_bf16 v[232:235], v[28:31], v[220:223], v[232:235]
    v_mul_f32 v151, s49, v36
    v_mul_f32 v150, s48, v36
    v_mfma_f32_16x16x32_bf16 v[236:239], v[32:35], v[216:219], v[236:239]
    v_fma_f32 v153, -v151, v151, v153
    v_fma_f32 v152, -v150, v150, v152
    v_max_f32 v153, 0, v153
    v_max_f32 v152, 0, v152
    v_add_f32 v153, v37, v153
    v_add_f32 v152, v37, v152
    v_rsq_f32 v155, v153
    v_rsq_f32 v154, v152
    s_nop 0
    s_nop 0
    v_pk_mul_f32 v[232:233], v[232:233], v[154:155] op_sel:[0,1] op_sel_hi:[1,1]
    v_pk_mul_f32 v[228:229], v[228:229], v[154:155] op_sel_hi:[1,0]
    v_pk_mul_f32 v[224:225], v[224:225], v[154:155] op_sel_hi:[1,0]
    v_pk_mul_f32 v[236:237], v[236:237], v[154:155] op_sel:[0,1] op_sel_hi:[1,1]
    v_pk_mul_f32 v[238:239], v[238:239], v[154:155] op_sel:[0,1] op_sel_hi:[1,1]
    v_pk_mul_f32 v[234:235], v[234:235], v[154:155] op_sel:[0,1] op_sel_hi:[1,1]
    v_pk_mul_f32 v[226:227], v[226:227], v[154:155] op_sel_hi:[1,0]
    v_pk_mul_f32 v[230:231], v[230:231], v[154:155] op_sel_hi:[1,0]
    v_cvt_pk_bf16_f32 v145, v233, v237
    v_cvt_pk_bf16_f32 v143, v232, v236
    v_cvt_pk_bf16_f32 v142, v224, v228
    v_and_b32 v143, v44, v143
    v_and_b32 v142, v44, v142
    v_cvt_pk_bf16_f32 v146, v226, v230
    ds_write_b64 v40, v[142:143] offset:0
    v_cvt_pk_bf16_f32 v144, v225, v229
    v_cvt_pk_bf16_f32 v149, v235, v239
    ds_write_b64 v40, v[144:145] offset:112
    v_cvt_pk_bf16_f32 v148, v227, v231
    v_cvt_pk_bf16_f32 v147, v234, v238
    ds_write_b64 v40, v[146:147] offset:224
    ds_write_b64 v40, v[148:149] offset:336
    s_cmp_lg_u32 s64, 0
    s_cbranch_scc1 L_p1w_5
    v_bfe_u32 v216, v0, 4, 2
    v_mul_u32_u24 v216, 900, v216
    v_and_b32_e64 v217, 15, v0
    v_lshl_add_u32 v216, v217, 2, v216
    s_lshl_b32 s48, s3, 7
    s_add_u32 s48, s48, 73728
    v_add_u32 v216, s48, v216
    s_waitcnt vmcnt(0)
    s_waitcnt lgkmcnt(0)
    s_barrier
    s_nop 0
    ds_read_u16 v192, v216 offset:0
    ds_read_u16 v200, v216 offset:4096
    ds_read_u16 v193, v216 offset:450
    ds_read_u16 v201, v216 offset:4546
    ds_read_u16 v194, v216 offset:2
    ds_read_u16 v202, v216 offset:4098
    ds_read_u16 v195, v216 offset:452
    ds_read_u16 v203, v216 offset:4548
    ds_read_u16 v196, v216 offset:64
    ds_read_u16 v204, v216 offset:4160
    ds_read_u16 v197, v216 offset:514
    ds_read_u16 v205, v216 offset:4610
    ds_read_u16 v198, v216 offset:66
    ds_read_u16 v206, v216 offset:4162
    ds_read_u16 v199, v216 offset:516
    ds_read_u16 v207, v216 offset:4612
    s_branch L_p1x_6
L_p1w_5:
    s_waitcnt lgkmcnt(0)
    s_barrier
L_p1x_6:
    ds_read_b128 v[208:211], v41
    ds_read_b128 v[212:215], v41 offset:256
    s_waitcnt lgkmcnt(1)
    v_mfma_f32_16x16x16_bf16 v[180:183], v[2:3], v[210:211], 0
    s_waitcnt lgkmcnt(0)
    v_mfma_f32_16x16x16_bf16 v[184:187], v[2:3], v[212:213], 0
    v_mfma_f32_16x16x16_bf16 v[176:179], v[2:3], v[208:209], 0
    s_nop 4
    v_cvt_pk_bf16_f32 v145, v182, v183
    v_mfma_f32_16x16x16_bf16 v[188:191], v[2:3], v[214:215], 0
    v_cvt_pk_bf16_f32 v144, v180, v181
    v_cvt_pk_bf16_f32 v146, v184, v185
    v_cvt_pk_bf16_f32 v147, v186, v187
    v_min_u32 v146, -2, v146
    v_min_u32 v147, -2, v147
    v_cvt_pk_bf16_f32 v142, v176, v177
    v_cvt_pk_bf16_f32 v143, v178, v179
    v_min_u32 v142, -2, v142
    v_min_u32 v143, -2, v143
    v_cvt_pk_bf16_f32 v149, v190, v191
    v_cvt_pk_bf16_f32 v148, v188, v189
    v_min_u32 v144, -2, v144
    v_min_u32 v148, -2, v148
    v_min_u32 v145, -2, v145
    v_min_u32 v149, -2, v149
    buffer_store_dwordx4 v[142:145], v42, s[4:7], 0 offen sc1
    buffer_store_dwordx4 v[146:149], v42, s[4:7], 0 offen offset:256 sc1
    s_cmp_lg_u32 s64, 0
    s_cbranch_scc1 L_l0_10
    s_mov_b32 s48, 10485760
    v_lshl_or_b32 v192, v200, 16, v192
    v_lshl_or_b32 v193, v201, 16, v193
    v_lshl_or_b32 v194, v202, 16, v194
    v_lshl_or_b32 v195, v203, 16, v195
    v_lshl_or_b32 v196, v204, 16, v196
    v_lshl_or_b32 v197, v205, 16, v197
    v_lshl_or_b32 v198, v206, 16, v198
    v_lshl_or_b32 v199, v207, 16, v199
    buffer_store_dwordx4 v[192:195], v42, s[4:7], s48 offen sc1
    buffer_store_dwordx4 v[196:199], v42, s[4:7], s48 offen offset:256 sc1
    v_mov_b32 v216, 17152
    ds_read_b32 v118, v216
    v_lshlrev_b32_e64 v216, 4, v1
    ds_read_b128 v[48:51], v216 offset:29184
    ds_read_b128 v[52:55], v216 offset:30208
    ds_read_b128 v[56:59], v216 offset:31232
    ds_read_b128 v[60:63], v216 offset:32256
    ds_read_b128 v[64:67], v216 offset:33280
    ds_read_b128 v[68:71], v216 offset:34304
    ds_read_b128 v[72:75], v216 offset:35328
    ds_read_b128 v[76:79], v216 offset:36352
    ds_read_b128 v[80:83], v216 offset:37376
    ds_read_b128 v[84:87], v216 offset:38400
    ds_read_b128 v[88:91], v216 offset:39424
    ds_read_b128 v[92:95], v216 offset:40448
    ds_read_b128 a[64:67], v216 offset:41472
    ds_read_b128 a[68:71], v216 offset:42496
    ds_read_b128 a[72:75], v216 offset:43520
    ds_read_b128 a[76:79], v216 offset:44544
    ds_read_b128 a[80:83], v216 offset:45568
    ds_read_b128 a[84:87], v216 offset:46592
    s_lshl_b32 s48, s3, 11
    s_add_u32 s48, s48, 32768
    s_mul_i32 s49, s3, 2176
    s_add_u32 s49, s49, 8192
    s_lshl_b32 s50, s3, 2
    s_add_u32 s50, s50, 20480
    s_waitcnt lgkmcnt(0)
    v_add_u32 v94, s48, v94
    v_add_u32 v86, s49, v86
    v_add_u32 v93, s50, v93
    v_and_b32 v216, 0x7ff, v42
    v_add_u32 v216, 256, v216
    v_min_u32 v216, 1792, v216
    v_and_b32 v95, 0xfffff800, v42
    v_add_u32 v95, v95, v216
    s_waitcnt vmcnt(0)
    s_barrier
    s_cmp_lg_u32 s3, 0
    s_cbranch_scc1 L_tok_11
    s_lshl_b32 s48, s2, 3
    s_add_u32 s48, s48, 25247744
    v_mov_b32 v218, s68
    v_mov_b32 v219, 0
    s_mov_b64 exec, 1
    buffer_store_dword v218, v219, s[4:7], s48 offen sc1
    s_mov_b64 exec, -1
L_tok_11:
    s_mov_b32 s74, s2
    s_mov_b32 s20, s44
    s_and_b32 s21, s45, 0xffff
    s_mov_b32 s22, 7340032
    s_mov_b32 s23, 0x00020000
    s_lshr_b32 s80, s74, 3
    s_bfe_u32 s81, s74, 0x20001
    s_and_b32 s50, s74, 1
    s_sub_u32 s52, 4, s50
    s_mul_i32 s54, s52, 7
    s_cmp_lt_u32 s80, s54
    s_cselect_b32 s70, 1, 0
    s_lshl_b32 s53, s52, 3
    s_cmp_lt_u32 s80, s53
    s_cselect_b32 s71, 1, 0
    s_sub_u32 s53, s80, s54
    s_mul_i32 s54, s50, 7
    s_add_u32 s54, s54, 4
    s_add_u32 s48, s53, s54
    s_cmp_lt_u32 s48, s54
    s_cselect_b32 s73, 1, 2
    s_cselect_b32 s53, s48, s53
    s_cmp_lg_u32 s70, 0
    s_cselect_b32 s73, s73, 0
    s_mul_i32 s54, s54, s81
    s_add_u32 s53, s53, s54
    s_lshl_b32 s54, s50, 4
    s_add_u32 s53, s53, s54
    s_mov_b32 s55, s53
    s_mul_i32 s78, s53, 4370
    s_bfe_u32 s78, s78, 0x20010
    s_mul_i32 s54, s78, 15
    s_sub_u32 s79, s53, s54
    s_and_b32 s79, s79, 15
    s_add_u32 s54, s79, s73
    s_cmp_eq_u32 s54, 15
    s_cselect_b32 s73, 2, s73
    s_mul_i32 s54, s50, 5462
    s_add_u32 s54, s54, 16384
    s_mul_i32 s53, s80, s54
    s_lshr_b32 s53, s53, 16
    s_mul_i32 s54, s53, s52
    s_sub_u32 s54, s80, s54
    s_mul_i32 s48, s53, 21846
    s_lshr_b32 s48, s48, 16
    s_mul_i32 s48, s48, 3
    s_sub_u32 s52, s53, s48
    s_mul_i32 s48, s52, 3
    s_mul_i32 s82, s50, 1
    s_add_u32 s82, s82, 2
    s_mul_i32 s82, s82, s54
    s_add_u32 s82, s82, s48
    s_mul_i32 s48, s50, 0
    s_add_u32 s82, s82, s48
    s_and_b32 s82, s82, 7
    s_mul_i32 s48, s52, 0
    s_mul_i32 s83, s54, 0
    s_add_u32 s48, s48, s83
    s_sub_u32 s83, s48, 14
    s_cselect_b32 s48, s48, s83
    s_min_u32 s83, s48, 13
    s_lshl_b32 s48, s50, 2
    s_add_u32 s54, s54, s48
    s_lshl_b32 s76, s54, 6
    s_mul_i32 s48, s81, 7
    s_add_u32 s48, s48, s53
    s_min_u32 s48, s48, 27
    s_lshl_b32 s75, s48, 6
    s_lshl_b32 s48, s81, 3
    s_add_u32 s48, s48, s53
    s_min_u32 s48, s48, 31
    s_lshl_b32 s77, s48, 6
    s_mov_b32 s72, s76
    s_cmp_lt_u32 s80, 28
    s_cselect_b32 s71, 1, 0
    s_and_b32 s48, s74, 1
    s_mul_i32 s48, s48, s80
    s_cmp_ge_u32 s48, 24
    s_cselect_b32 s54, 1, 0
    s_sub_u32 s48, s80, 24
    s_and_b32 s48, s48, 3
    s_lshl_b32 s48, s48, 6
    s_lshl_b32 s53, s81, 9
    s_add_u32 s53, s53, 448
    s_cmp_lg_u32 s54, 0
    s_cselect_b32 s72, s48, s76
    s_cselect_b32 s77, s53, s77
    s_mul_i32 s90, s3, 1835008
    s_lshl_b32 s50, s77, 1
    s_add_u32 s90, s90, s50
    s_and_b32 s50, s74, 1
    s_mul_i32 s51, s50, 7
    s_sub_u32 s51, 28, s51
    s_mul_i32 s51, s51, s81
    s_mul_i32 s50, s50, 112
    s_add_u32 s51, s51, s50
    s_add_u32 s51, s51, s80
    s_cmp_lg_u32 s70, 0
    s_cselect_b32 s84, s51, s55
    s_lshl_b32 s50, s3, 4
    s_add_u32 s50, s50, s75
    s_lshl_b32 s50, s50, 1
    s_add_u32 s98, s42, s50
    s_addc_u32 s99, s43, 0
    s_mov_b32 s28, s46
    s_and_b32 s29, s47, 0xffff
    s_mov_b32 s30, 4096
    s_mov_b32 s31, 0x00020000
    v_lshrrev_b32 v216, 3, v1
    s_lshl_b32 s50, s3, 4
    s_add_u32 s51, s50, s77
    v_add_lshl_u32 v99, v216, s51, 1
    buffer_load_ushort v98, v99, s[28:31], 0 offen
    buffer_load_ushort v99, v99, s[28:31], 0 offen offset:16
L_l0_10:
    s_cmp_lg_u32 s64, 0
    s_cbranch_scc1 L_l0_12
    s_cmp_eq_u32 s70, 0
    s_cbranch_scc1 L_l0_12
    v_mov_b32 v120, -1
    v_mov_b32 v121, -1
    v_mov_b32 v122, -1
    v_mov_b32 v123, -1
    s_mul_i32 s48, s84, 20480
    s_mul_i32 s49, s3, 5120
    s_add_u32 s48, s48, s49
    s_nop 0
    s_add_u32 s48, s48, 2097152
    buffer_store_dwordx4 v[120:123], v45, s[4:7], s48 offen offset:0 sc1
    buffer_store_dwordx4 v[120:123], v45, s[4:7], s48 offen offset:1024 sc1
    buffer_store_dwordx4 v[120:123], v45, s[4:7], s48 offen offset:2048 sc1
    buffer_store_dwordx4 v[120:123], v45, s[4:7], s48 offen offset:3072 sc1
    s_add_u32 s48, s48, 4096
    buffer_store_dwordx4 v[120:123], v45, s[4:7], s48 offen offset:0 sc1
    v_lshrrev_b32 v108, 5, v1
    v_lshlrev_b32 v108, 4, v108
    global_load_dwordx4 v[112:115], v108, s[98:99]
    v_lshrrev_b32_e64 v117, 3, v1
    s_mov_b32 s48, 917504
    v_mul_lo_u32 v117, v117, s48
    v_bfe_u32 v120, v1, 4, 1
    v_lshlrev_b32 v120, 2, v120
    v_and_b32 v121, 7, v1
    v_xor_b32_e64 v120, v120, v121
    v_lshl_add_u32 v117, v120, 4, v117
    s_mul_i32 s87, s3, 229376
    s_lshl_b32 s48, s75, 1
    s_add_u32 s87, s87, s48
    s_lshl_b32 s89, s82, 3
    s_lshl_b32 s88, s3, 15
    s_add_u32 s88, s88, 32768
    v_add_u32 v132, s88, v90
    v_add_u32 v133, s88, v91
    s_add_u32 m0, s88, 16384
    s_mov_b32 s54, 5
L_w1dma_13:
    s_mul_i32 s53, s89, 3584
    s_add_u32 s53, s53, s87
    buffer_load_dwordx4 v117, s[16:19], s53 offen  lds
    s_add_u32 m0, m0, 1024
    s_add_u32 s89, s89, 1
    s_and_b32 s89, s89, 63
    s_sub_u32 s54, s54, 1
    s_cmp_lg_u32 s54, 0
    s_cbranch_scc1 L_w1dma_13
    s_waitcnt vmcnt(5)
    s_barrier
    s_cmp_lg_u32 s3, 0
    s_cbranch_scc1 L_tok_14
    s_lshl_b32 s48, s84, 6
    s_lshl_b32 s49, s64, 14
    s_add_u32 s48, s48, s49
    s_add_u32 s48, s48, 25198592
    v_mov_b32 v120, s68
    v_mov_b32 v121, 0
    s_mov_b64 exec, 1
    buffer_store_dword v120, v121, s[4:7], s48 offen sc1
    s_mov_b64 exec, -1
L_tok_14:
    s_add_u32 m0, s88, 21504
    s_mov_b32 s54, 11
L_w1dma_15:
    s_mul_i32 s53, s89, 3584
    s_add_u32 s53, s53, s87
    buffer_load_dwordx4 v117, s[16:19], s53 offen  lds
    s_add_u32 m0, m0, 1024
    s_add_u32 s89, s89, 1
    s_and_b32 s89, s89, 63
    s_sub_u32 s54, s54, 1
    s_cmp_lg_u32 s54, 0
    s_cbranch_scc1 L_w1dma_15
    s_add_u32 m0, s88, 0
    s_mov_b32 s54, 16
L_w1dma_16:
    s_mul_i32 s53, s89, 3584
    s_add_u32 s53, s53, s87
    buffer_load_dwordx4 v117, s[16:19], s53 offen  lds
    s_add_u32 m0, m0, 1024
    s_add_u32 s89, s89, 1
    s_and_b32 s89, s89, 63
    s_sub_u32 s54, s54, 1
    s_cmp_lg_u32 s54, 0
    s_cbranch_scc1 L_w1dma_16
    s_waitcnt vmcnt(24)
    ds_read_b64_tr_b16 a[0:1], v132 offset:16384
    ds_read_b64_tr_b16 a[2:3], v132 offset:16896
    ds_read_b64_tr_b16 a[4:5], v133 offset:16384
    ds_read_b64_tr_b16 a[6:7], v133 offset:16896
    ds_read_b64_tr_b16 a[8:9], v132 offset:18432
    ds_read_b64_tr_b16 a[10:11], v132 offset:18944
    ds_read_b64_tr_b16 a[12:13], v133 offset:18432
    ds_read_b64_tr_b16 a[14:15], v133 offset:18944
    ds_read_b64_tr_b16 a[16:17], v132 offset:20480
    ds_read_b64_tr_b16 a[18:19], v132 offset:20992
    ds_read_b64_tr_b16 a[20:21], v133 offset:20480
    ds_read_b64_tr_b16 a[22:23], v133 offset:20992
    ds_read_b64_tr_b16 a[24:25], v132 offset:22528
    ds_read_b64_tr_b16 a[26:27], v132 offset:23040
    ds_read_b64_tr_b16 a[28:29], v133 offset:22528
    ds_read_b64_tr_b16 a[30:31], v133 offset:23040
    s_waitcnt lgkmcnt(0)
    s_add_u32 m0, s88, 16384
    s_mov_b32 s54, 8
L_w1dma_17:
    s_mul_i32 s53, s89, 3584
    s_add_u32 s53, s53, s87
    buffer_load_dwordx4 v117, s[16:19], s53 offen  lds
    s_add_u32 m0, m0, 1024
    s_add_u32 s89, s89, 1
    s_and_b32 s89, s89, 63
    s_sub_u32 s54, s54, 1
    s_cmp_lg_u32 s54, 0
    s_cbranch_scc1 L_w1dma_17
    s_waitcnt vmcnt(24)
    s_nop 0
    ds_read_b64_tr_b16 a[32:33], v132 offset:24576
    ds_read_b64_tr_b16 a[34:35], v132 offset:25088
    ds_read_b64_tr_b16 a[36:37], v133 offset:24576
    ds_read_b64_tr_b16 a[38:39], v133 offset:25088
    ds_read_b64_tr_b16 a[40:41], v132 offset:26624
    ds_read_b64_tr_b16 a[42:43], v132 offset:27136
    ds_read_b64_tr_b16 a[44:45], v133 offset:26624
    ds_read_b64_tr_b16 a[46:47], v133 offset:27136
    ds_read_b64_tr_b16 a[48:49], v132 offset:28672
    ds_read_b64_tr_b16 a[50:51], v132 offset:29184
    ds_read_b64_tr_b16 a[52:53], v133 offset:28672
    ds_read_b64_tr_b16 a[54:55], v133 offset:29184
    ds_read_b64_tr_b16 a[56:57], v132 offset:30720
    ds_read_b64_tr_b16 a[58:59], v132 offset:31232
    ds_read_b64_tr_b16 a[60:61], v133 offset:30720
    ds_read_b64_tr_b16 a[62:63], v133 offset:31232
    s_waitcnt lgkmcnt(0)
    s_add_u32 m0, s88, 24576
    s_mov_b32 s54, 8
L_w1dma_18:
    s_mul_i32 s53, s89, 3584
    s_add_u32 s53, s53, s87
    buffer_load_dwordx4 v117, s[16:19], s53 offen  lds
    s_add_u32 m0, m0, 1024
    s_add_u32 s89, s89, 1
    s_and_b32 s89, s89, 63
    s_sub_u32 s54, s54, 1
    s_cmp_lg_u32 s54, 0
    s_cbranch_scc1 L_w1dma_18
    s_waitcnt vmcnt(24)
    s_nop 0
    ds_read_b64_tr_b16 a[64:65], v132 offset:0
    ds_read_b64_tr_b16 a[66:67], v132 offset:512
    ds_read_b64_tr_b16 a[68:69], v133 offset:0
    ds_read_b64_tr_b16 a[70:71], v133 offset:512
    ds_read_b64_tr_b16 a[72:73], v132 offset:2048
    ds_read_b64_tr_b16 a[74:75], v132 offset:2560
    ds_read_b64_tr_b16 a[76:77], v133 offset:2048
    ds_read_b64_tr_b16 a[78:79], v133 offset:2560
    ds_read_b64_tr_b16 a[80:81], v132 offset:4096
    ds_read_b64_tr_b16 a[82:83], v132 offset:4608
    ds_read_b64_tr_b16 a[84:85], v133 offset:4096
    ds_read_b64_tr_b16 a[86:87], v133 offset:4608
    ds_read_b64_tr_b16 a[88:89], v132 offset:6144
    ds_read_b64_tr_b16 a[90:91], v132 offset:6656
    ds_read_b64_tr_b16 a[92:93], v133 offset:6144
    ds_read_b64_tr_b16 a[94:95], v133 offset:6656
    s_waitcnt lgkmcnt(0)
    s_add_u32 m0, s88, 0
    s_mov_b32 s54, 8
L_w1dma_19:
    s_mul_i32 s53, s89, 3584
    s_add_u32 s53, s53, s87
    buffer_load_dwordx4 v117, s[16:19], s53 offen  lds
    s_add_u32 m0, m0, 1024
    s_add_u32 s89, s89, 1
    s_and_b32 s89, s89, 63
    s_sub_u32 s54, s54, 1
    s_cmp_lg_u32 s54, 0
    s_cbranch_scc1 L_w1dma_19
    s_waitcnt vmcnt(24)
    ds_read_b64_tr_b16 a[96:97], v132 offset:8192
    ds_read_b64_tr_b16 a[98:99], v132 offset:8704
    ds_read_b64_tr_b16 a[100:101], v133 offset:8192
    ds_read_b64_tr_b16 a[102:103], v133 offset:8704
    ds_read_b64_tr_b16 a[104:105], v132 offset:10240
    ds_read_b64_tr_b16 a[106:107], v132 offset:10752
    ds_read_b64_tr_b16 a[108:109], v133 offset:10240
    ds_read_b64_tr_b16 a[110:111], v133 offset:10752
    ds_read_b64_tr_b16 a[112:113], v132 offset:12288
    ds_read_b64_tr_b16 a[114:115], v132 offset:12800
    ds_read_b64_tr_b16 a[116:117], v133 offset:12288
    ds_read_b64_tr_b16 a[118:119], v133 offset:12800
    ds_read_b64_tr_b16 a[120:121], v132 offset:14336
    ds_read_b64_tr_b16 a[122:123], v132 offset:14848
    ds_read_b64_tr_b16 a[124:125], v133 offset:14336
    ds_read_b64_tr_b16 a[126:127], v133 offset:14848
    s_waitcnt lgkmcnt(0)
    s_add_u32 m0, s88, 8192
    s_mov_b32 s54, 8
L_w1dma_20:
    s_mul_i32 s53, s89, 3584
    s_add_u32 s53, s53, s87
    buffer_load_dwordx4 v117, s[16:19], s53 offen  lds
    s_add_u32 m0, m0, 1024
    s_add_u32 s89, s89, 1
    s_and_b32 s89, s89, 63
    s_sub_u32 s54, s54, 1
    s_cmp_lg_u32 s54, 0
    s_cbranch_scc1 L_w1dma_20
    s_waitcnt vmcnt(24)
    s_nop 0
    ds_read_b64_tr_b16 a[128:129], v132 offset:16384
    ds_read_b64_tr_b16 a[130:131], v132 offset:16896
    ds_read_b64_tr_b16 a[132:133], v133 offset:16384
    ds_read_b64_tr_b16 a[134:135], v133 offset:16896
    ds_read_b64_tr_b16 a[136:137], v132 offset:18432
    ds_read_b64_tr_b16 a[138:139], v132 offset:18944
    ds_read_b64_tr_b16 a[140:141], v133 offset:18432
    ds_read_b64_tr_b16 a[142:143], v133 offset:18944
    ds_read_b64_tr_b16 a[144:145], v132 offset:20480
    ds_read_b64_tr_b16 a[146:147], v132 offset:20992
    ds_read_b64_tr_b16 a[148:149], v133 offset:20480
    ds_read_b64_tr_b16 a[150:151], v133 offset:20992
    ds_read_b64_tr_b16 a[152:153], v132 offset:22528
    ds_read_b64_tr_b16 a[154:155], v132 offset:23040
    ds_read_b64_tr_b16 a[156:157], v133 offset:22528
    ds_read_b64_tr_b16 a[158:159], v133 offset:23040
    s_waitcnt vmcnt(16)
    s_nop 0
    ds_read_b64_tr_b16 a[160:161], v132 offset:24576
    ds_read_b64_tr_b16 a[162:163], v132 offset:25088
    ds_read_b64_tr_b16 a[164:165], v133 offset:24576
    ds_read_b64_tr_b16 a[166:167], v133 offset:25088
    ds_read_b64_tr_b16 a[168:169], v132 offset:26624
    ds_read_b64_tr_b16 a[170:171], v132 offset:27136
    ds_read_b64_tr_b16 a[172:173], v133 offset:26624
    ds_read_b64_tr_b16 a[174:175], v133 offset:27136
    ds_read_b64_tr_b16 a[176:177], v132 offset:28672
    ds_read_b64_tr_b16 a[178:179], v132 offset:29184
    ds_read_b64_tr_b16 a[180:181], v133 offset:28672
    ds_read_b64_tr_b16 a[182:183], v133 offset:29184
    ds_read_b64_tr_b16 a[184:185], v132 offset:30720
    ds_read_b64_tr_b16 a[186:187], v132 offset:31232
    ds_read_b64_tr_b16 a[188:189], v133 offset:30720
    ds_read_b64_tr_b16 a[190:191], v133 offset:31232
    s_waitcnt vmcnt(8)
    s_nop 0
    ds_read_b64_tr_b16 a[192:193], v132 offset:0
    ds_read_b64_tr_b16 a[194:195], v132 offset:512
    ds_read_b64_tr_b16 a[196:197], v133 offset:0
    ds_read_b64_tr_b16 a[198:199], v133 offset:512
    ds_read_b64_tr_b16 a[200:201], v132 offset:2048
    ds_read_b64_tr_b16 a[202:203], v132 offset:2560
    ds_read_b64_tr_b16 a[204:205], v133 offset:2048
    ds_read_b64_tr_b16 a[206:207], v133 offset:2560
    ds_read_b64_tr_b16 a[208:209], v132 offset:4096
    ds_read_b64_tr_b16 a[210:211], v132 offset:4608
    ds_read_b64_tr_b16 a[212:213], v133 offset:4096
    ds_read_b64_tr_b16 a[214:215], v133 offset:4608
    ds_read_b64_tr_b16 a[216:217], v132 offset:6144
    ds_read_b64_tr_b16 a[218:219], v132 offset:6656
    ds_read_b64_tr_b16 a[220:221], v133 offset:6144
    ds_read_b64_tr_b16 a[222:223], v133 offset:6656
    s_waitcnt vmcnt(0)
    s_nop 0
    ds_read_b64_tr_b16 a[224:225], v132 offset:8192
    ds_read_b64_tr_b16 a[226:227], v132 offset:8704
    ds_read_b64_tr_b16 a[228:229], v133 offset:8192
    ds_read_b64_tr_b16 a[230:231], v133 offset:8704
    ds_read_b64_tr_b16 a[232:233], v132 offset:10240
    ds_read_b64_tr_b16 a[234:235], v132 offset:10752
    ds_read_b64_tr_b16 a[236:237], v133 offset:10240
    ds_read_b64_tr_b16 a[238:239], v133 offset:10752
    ds_read_b64_tr_b16 a[240:241], v132 offset:12288
    ds_read_b64_tr_b16 a[242:243], v132 offset:12800
    ds_read_b64_tr_b16 a[244:245], v133 offset:12288
    ds_read_b64_tr_b16 a[246:247], v133 offset:12800
    ds_read_b64_tr_b16 a[248:249], v132 offset:14336
    ds_read_b64_tr_b16 a[250:251], v132 offset:14848
    ds_read_b64_tr_b16 a[252:253], v133 offset:14336
    ds_read_b64_tr_b16 a[254:255], v133 offset:14848
    s_waitcnt lgkmcnt(0)
    v_lshlrev_b32 v108, 16, v112
    v_and_b32 v109, 0xffff0000, v112
    v_lshlrev_b32_e64 v110, 16, v113
    v_and_b32 v111, 0xffff0000, v113
    v_lshlrev_b32_e64 v112, 16, v114
    v_and_b32 v113, 0xffff0000, v114
    v_lshlrev_b32_e64 v114, 16, v115
    v_and_b32 v115, 0xffff0000, v115
    s_barrier
    v_lshrrev_b32 v120, 3, v1
    v_lshl_add_u32 v120, v120, 12, v92
    s_mul_i32 s53, s3, 24576
    s_add_u32 m0, s53, 65536
    s_lshl_b32 s52, s83, 2
    s_mov_b32 s54, 8
L_w2a_21:
    s_lshl_b32 s53, s52, 15
    s_add_u32 s53, s53, s90
    buffer_load_dwordx4 v120, s[20:23], s53 offen  lds
    s_add_u32 m0, m0, 1024
    s_add_u32 s52, s52, 1
    s_cmp_eq_u32 s52, 56
    s_cselect_b32 s52, 0, s52
    s_sub_u32 s54, s54, 1
    s_cmp_lg_u32 s54, 0
    s_cbranch_scc1 L_w2a_21
L_l0_12:
    s_cmp_lg_u32 s64, 0
    s_cbranch_scc1 L_p2skip_22
    s_cmp_lg_u32 s70, 0
    s_cbranch_scc1 L_p2skip_22
    v_accvgpr_read_b32 v152, a64
    v_accvgpr_read_b32 v153, a65
    v_accvgpr_read_b32 v154, a66
    v_accvgpr_read_b32 v155, a67
    v_accvgpr_read_b32 v156, a68
    v_accvgpr_read_b32 v157, a69
    v_accvgpr_read_b32 v158, a70
    v_accvgpr_read_b32 v159, a71
    v_accvgpr_read_b32 v160, a72
    v_accvgpr_read_b32 v161, a73
    v_accvgpr_read_b32 v162, a74
    v_accvgpr_read_b32 v163, a75
    v_accvgpr_read_b32 v164, a76
    v_accvgpr_read_b32 v165, a77
    v_accvgpr_read_b32 v166, a78
    v_accvgpr_read_b32 v167, a79
    v_accvgpr_read_b32 v108, a80
    v_accvgpr_read_b32 v112, a84
    v_accvgpr_read_b32 v109, a81
    v_accvgpr_read_b32 v113, a85
    v_accvgpr_read_b32 v110, a82
    v_accvgpr_read_b32 v114, a86
    v_accvgpr_read_b32 v111, a83
    v_accvgpr_read_b32 v115, a87
    v_lshrrev_b32 v208, 3, v1
    v_and_b32 v209, 7, v1
    v_lshlrev_b32_e64 v117, 15, v208
    v_lshl_add_u32 v117, v209, 4, v117
    s_lshl_b32 s52, s78, 8
    s_lshl_b32 s53, s3, 2
    s_add_u32 s52, s52, s53
    s_lshl_b32 s52, s52, 11
    s_lshl_b32 s53, s79, 7
    s_add_u32 s52, s52, s53
    s_add_u32 s55, s52, s65
    s_add_u32 s51, s52, 0
    v_and_b32 v210, 3, v208
    v_lshrrev_b32 v211, 2, v208
    v_lshlrev_b32_e64 v211, 8, v211
    v_lshl_add_u32 v210, v210, 2, v211
    v_lshl_add_u32 v210, v209, 12, v210
    s_lshr_b32 s53, s3, 1
    s_lshl_b32 s53, s53, 7
    v_add_u32 v210, s53, v210
    s_and_b32 s53, s3, 1
    s_lshl_b32 s53, s53, 2
    s_add_u32 s54, s53, 0
    v_xor_b32_e64 v211, s54, v209
    v_lshl_add_u32 v168, v211, 4, v210
    s_add_u32 s54, s53, 1
    v_xor_b32 v211, s54, v209
    v_lshl_add_u32 v169, v211, 4, v210
    s_add_u32 s54, s53, 2
    v_xor_b32 v211, s54, v209
    v_lshl_add_u32 v170, v211, 4, v210
    s_add_u32 s54, s53, 3
    v_xor_b32 v211, s54, v209
    v_lshl_add_u32 v171, v211, 4, v210
    v_xor_b32 v208, s3, v1
    s_lshl_b32 s54, s3, 12
    v_lshl_add_u32 v172, v208, 4, s54
    v_xor_b32 v173, 64, v172
    s_sleep 16
    s_mov_b32 s66, 0
L_fw_25:
    s_mov_b32 s48, 25247744
    v_lshlrev_b32 v175, 3, v0
    buffer_load_dword v174, v175, s[4:7], s48 offen sc1
L_fwc_27:
    s_waitcnt vmcnt(0)
    v_cmp_ne_u32 vcc, s68, v174
    s_cbranch_vccz L_fwd_26
    s_add_u32 s66, s66, 1
    s_cmp_lt_u32 s66, s67
    s_sleep 2
    s_cbranch_scc1 L_fw_25
    s_mov_b32 s67, 1
L_fwd_26:
    s_barrier
    s_add_u32 s48, s51, 0
    buffer_load_dwordx4 v[176:179], v117, s[4:7], s48 offen sc1
    s_add_u32 s48, s51, 262144
    buffer_load_dwordx4 v[180:183], v117, s[4:7], s48 offen sc1
    s_add_u32 s48, s51, 2048
    buffer_load_dwordx4 v[184:187], v117, s[4:7], s48 offen sc1
    s_add_u32 s48, s51, 264192
    buffer_load_dwordx4 v[188:191], v117, s[4:7], s48 offen sc1
    s_add_u32 s48, s51, 4096
    buffer_load_dwordx4 v[192:195], v117, s[4:7], s48 offen sc1
    s_add_u32 s48, s51, 266240
    buffer_load_dwordx4 v[196:199], v117, s[4:7], s48 offen sc1
    s_add_u32 s48, s51, 6144
    buffer_load_dwordx4 v[200:203], v117, s[4:7], s48 offen sc1
    s_add_u32 s48, s51, 268288
    buffer_load_dwordx4 v[204:207], v117, s[4:7], s48 offen sc1
    s_add_u32 s48, s52, 10485760
    buffer_load_dwordx4 v[120:123], v117, s[4:7], s48 offen sc1
    s_add_u32 s48, s52, 10747904
    buffer_load_dwordx4 v[124:127], v117, s[4:7], s48 offen sc1
    s_add_u32 s48, s52, 10487808
    buffer_load_dwordx4 v[128:131], v117, s[4:7], s48 offen sc1
    s_add_u32 s48, s52, 10749952
    buffer_load_dwordx4 v[132:135], v117, s[4:7], s48 offen sc1
    s_add_u32 s48, s52, 10489856
    buffer_load_dwordx4 v[136:139], v117, s[4:7], s48 offen sc1
    s_add_u32 s48, s52, 10752000
    buffer_load_dwordx4 v[140:143], v117, s[4:7], s48 offen sc1
    s_add_u32 s48, s52, 10491904
    buffer_load_dwordx4 v[144:147], v117, s[4:7], s48 offen sc1
    s_add_u32 s48, s52, 10754048
    buffer_load_dwordx4 v[148:151], v117, s[4:7], s48 offen sc1
    s_waitcnt vmcnt(8)
    s_nop 0
    ds_write2st64_b32 v168, v176, v180 offset0:128 offset1:130
    ds_write2st64_b32 v168, v177, v181 offset0:132 offset1:134
    ds_write2st64_b32 v168, v178, v182 offset0:136 offset1:138
    ds_write2st64_b32 v168, v179, v183 offset0:140 offset1:142
    ds_write2st64_b32 v169, v184, v188 offset0:128 offset1:130
    ds_write2st64_b32 v169, v185, v189 offset0:132 offset1:134
    ds_write2st64_b32 v169, v186, v190 offset0:136 offset1:138
    ds_write2st64_b32 v169, v187, v191 offset0:140 offset1:142
    ds_write2st64_b32 v170, v192, v196 offset0:128 offset1:130
    ds_write2st64_b32 v170, v193, v197 offset0:132 offset1:134
    ds_write2st64_b32 v170, v194, v198 offset0:136 offset1:138
    ds_write2st64_b32 v170, v195, v199 offset0:140 offset1:142
    ds_write2st64_b32 v171, v200, v204 offset0:128 offset1:130
    ds_write2st64_b32 v171, v201, v205 offset0:132 offset1:134
    ds_write2st64_b32 v171, v202, v206 offset0:136 offset1:138
    ds_write2st64_b32 v171, v203, v207 offset0:140 offset1:142
    s_waitcnt vmcnt(0)
    s_nop 0
    ds_write2st64_b32 v168, v120, v124 offset0:0 offset1:2
    ds_write2st64_b32 v168, v121, v125 offset0:4 offset1:6
    ds_write2st64_b32 v168, v122, v126 offset0:8 offset1:10
    ds_write2st64_b32 v168, v123, v127 offset0:12 offset1:14
    ds_write2st64_b32 v169, v128, v132 offset0:0 offset1:2
    ds_write2st64_b32 v169, v129, v133 offset0:4 offset1:6
    ds_write2st64_b32 v169, v130, v134 offset0:8 offset1:10
    ds_write2st64_b32 v169, v131, v135 offset0:12 offset1:14
    ds_write2st64_b32 v170, v136, v140 offset0:0 offset1:2
    ds_write2st64_b32 v170, v137, v141 offset0:4 offset1:6
    ds_write2st64_b32 v170, v138, v142 offset0:8 offset1:10
    ds_write2st64_b32 v170, v139, v143 offset0:12 offset1:14
    ds_write2st64_b32 v171, v144, v148 offset0:0 offset1:2
    ds_write2st64_b32 v171, v145, v149 offset0:4 offset1:6
    ds_write2st64_b32 v171, v146, v150 offset0:8 offset1:10
    ds_write2st64_b32 v171, v147, v151 offset0:12 offset1:14
    s_waitcnt lgkmcnt(0)
    s_barrier
    ds_read_b128 a[0:3], v172 offset:0
    ds_read_b128 a[4:7], v172 offset:1024
    ds_read_b128 a[8:11], v172 offset:2048
    ds_read_b128 a[12:15], v172 offset:3072
    ds_read_b128 a[16:19], v173 offset:16384
    ds_read_b128 a[20:23], v173 offset:17408
    ds_read_b128 a[24:27], v173 offset:18432
    ds_read_b128 a[28:31], v173 offset:19456
    s_waitcnt lgkmcnt(0)
    v_accvgpr_read_b32 v216, a0
    v_lshlrev_b32 v120, 16, v216
    v_and_b32 v124, 0xffff0000, v216
    v_accvgpr_read_b32 v217, a1
    v_lshlrev_b32_e64 v121, 16, v217
    v_and_b32 v125, 0xffff0000, v217
    v_accvgpr_read_b32 v218, a2
    v_lshlrev_b32_e64 v122, 16, v218
    v_and_b32 v126, 0xffff0000, v218
    v_accvgpr_read_b32 v219, a3
    v_lshlrev_b32_e64 v123, 16, v219
    v_and_b32 v127, 0xffff0000, v219
    v_accvgpr_read_b32 v216, a4
    v_lshlrev_b32_e64 v128, 16, v216
    v_and_b32 v132, 0xffff0000, v216
    v_accvgpr_read_b32 v217, a5
    v_lshlrev_b32_e64 v129, 16, v217
    v_and_b32 v133, 0xffff0000, v217
    v_accvgpr_read_b32 v218, a6
    v_lshlrev_b32_e64 v130, 16, v218
    v_and_b32 v134, 0xffff0000, v218
    v_accvgpr_read_b32 v219, a7
    v_lshlrev_b32_e64 v131, 16, v219
    v_and_b32 v135, 0xffff0000, v219
    v_accvgpr_read_b32 v216, a8
    v_lshlrev_b32_e64 v136, 16, v216
    v_and_b32 v140, 0xffff0000, v216
    v_accvgpr_read_b32 v217, a9
    v_lshlrev_b32_e64 v137, 16, v217
    v_and_b32 v141, 0xffff0000, v217
    v_accvgpr_read_b32 v218, a10
    v_lshlrev_b32_e64 v138, 16, v218
    v_and_b32 v142, 0xffff0000, v218
    v_accvgpr_read_b32 v219, a11
    v_lshlrev_b32_e64 v139, 16, v219
    v_and_b32 v143, 0xffff0000, v219
    v_accvgpr_read_b32 v216, a12
    v_lshlrev_b32_e64 v144, 16, v216
    v_and_b32 v148, 0xffff0000, v216
    v_accvgpr_read_b32 v217, a13
    v_lshlrev_b32_e64 v145, 16, v217
    v_and_b32 v149, 0xffff0000, v217
    v_accvgpr_read_b32 v218, a14
    v_lshlrev_b32_e64 v146, 16, v218
    v_and_b32 v150, 0xffff0000, v218
    v_accvgpr_read_b32 v219, a15
    v_lshlrev_b32_e64 v147, 16, v219
    v_and_b32 v151, 0xffff0000, v219
    s_mov_b32 s48, 25198592
    s_lshl_b32 s49, s64, 14
    s_add_u32 s48, s48, s49
    v_lshlrev_b32_e64 v175, 6, v0
    v_min_u32 v175, 12480, v175
    buffer_load_dword v174, v175, s[4:7], s48 offen sc1
    ds_read_b128 v[176:179], v172 offset:32768
    ds_read_b128 v[180:183], v172 offset:33792
    ds_read_b128 v[184:187], v172 offset:34816
    ds_read_b128 v[188:191], v172 offset:35840
    ds_read_b128 v[192:195], v173 offset:49152
    ds_read_b128 v[196:199], v173 offset:50176
    ds_read_b128 v[200:203], v173 offset:51200
    ds_read_b128 v[204:207], v173 offset:52224
    v_accvgpr_read_b32 v219, a19
    v_accvgpr_read_b32 v216, a16
    v_accvgpr_read_b32 v217, a17
    v_accvgpr_read_b32 v218, a18
    s_waitcnt lgkmcnt(7)
    v_mfma_f32_16x16x32_bf16 v[220:223], v[176:179], v[152:155], 0
    v_mfma_f32_16x16x32_bf16 v[224:227], v[176:179], v[156:159], 0
    s_waitcnt lgkmcnt(6)
    v_mfma_f32_16x16x32_bf16 v[228:231], v[180:183], v[152:155], 0
    v_mfma_f32_16x16x32_bf16 v[232:235], v[180:183], v[156:159], 0
    s_waitcnt lgkmcnt(5)
    v_mfma_f32_16x16x32_bf16 v[236:239], v[184:187], v[152:155], 0
    v_mfma_f32_16x16x32_bf16 v[240:243], v[184:187], v[156:159], 0
    s_waitcnt lgkmcnt(4)
    v_mfma_f32_16x16x32_bf16 v[244:247], v[188:191], v[152:155], 0
    v_mfma_f32_16x16x32_bf16 v[248:251], v[188:191], v[156:159], 0
    v_pk_mul_f32 v[210:211], v[222:223], v[114:115]
    v_pk_mul_f32 v[214:215], v[230:231], v[114:115]
    v_pk_mul_f32 v[208:209], v[220:221], v[112:113]
    v_pk_mul_f32 v[222:223], v[222:223], v[110:111]
    v_pk_mul_f32 v[230:231], v[230:231], v[110:111]
    v_pk_mul_f32 v[220:221], v[220:221], v[108:109]
    v_pk_fma_f32 v[230:231], v[234:235], v[114:115], v[230:231]
    v_pk_fma_f32 v[220:221], v[224:225], v[112:113], v[220:221]
    v_pk_fma_f32 v[224:225], v[224:225], v[108:109], v[208:209] neg_lo:[0,0,1] neg_hi:[0,0,1]
    v_pk_fma_f32 v[222:223], v[226:227], v[114:115], v[222:223]
    v_pk_fma_f32 v[226:227], v[226:227], v[110:111], v[210:211] neg_lo:[0,0,1] neg_hi:[0,0,1]
    v_pk_mul_f32 v[210:211], v[238:239], v[114:115]
    v_pk_mul_f32 v[212:213], v[228:229], v[112:113]
    v_pk_mul_f32 v[228:229], v[228:229], v[108:109]
    v_pk_fma_f32 v[234:235], v[234:235], v[110:111], v[214:215] neg_lo:[0,0,1] neg_hi:[0,0,1]
    v_pk_fma_f32 v[228:229], v[232:233], v[112:113], v[228:229]
    v_pk_fma_f32 v[232:233], v[232:233], v[108:109], v[212:213] neg_lo:[0,0,1] neg_hi:[0,0,1]
    v_pk_mul_f32 v[238:239], v[238:239], v[110:111]
    v_pk_mul_f32 v[208:209], v[236:237], v[112:113]
    v_pk_mul_f32 v[236:237], v[236:237], v[108:109]
    v_pk_fma_f32 v[238:239], v[242:243], v[114:115], v[238:239]
    v_pk_fma_f32 v[242:243], v[242:243], v[110:111], v[210:211] neg_lo:[0,0,1] neg_hi:[0,0,1]
    v_pk_fma_f32 v[236:237], v[240:241], v[112:113], v[236:237]
    v_pk_fma_f32 v[240:241], v[240:241], v[108:109], v[208:209] neg_lo:[0,0,1] neg_hi:[0,0,1]
    v_pk_mul_f32 v[214:215], v[246:247], v[114:115]
    v_pk_mul_f32 v[212:213], v[244:245], v[112:113]
    v_pk_mul_f32 v[244:245], v[244:245], v[108:109]
    v_pk_mul_f32 v[246:247], v[246:247], v[110:111]
    v_pk_fma_f32 v[244:245], v[248:249], v[112:113], v[244:245]
    v_pk_fma_f32 v[246:247], v[250:251], v[114:115], v[246:247]
    v_pk_fma_f32 v[250:251], v[250:251], v[110:111], v[214:215] neg_lo:[0,0,1] neg_hi:[0,0,1]
    v_pk_fma_f32 v[248:249], v[248:249], v[108:109], v[212:213] neg_lo:[0,0,1] neg_hi:[0,0,1]
    v_cvt_pk_bf16_f32 v179, v223, v227
    v_cvt_pk_bf16_f32 v178, v222, v226
    v_cvt_pk_bf16_f32 v176, v220, v224
    v_cvt_pk_bf16_f32 v177, v221, v225
    v_cvt_pk_bf16_f32 v184, v236, v240
    v_cvt_pk_bf16_f32 v183, v231, v235
    v_mfma_f32_16x16x32_bf16 v[220:223], v[152:155], v[176:179], 0
    v_cvt_pk_bf16_f32 v186, v238, v242
    v_cvt_pk_bf16_f32 v185, v237, v241
    v_mfma_f32_16x16x32_bf16 v[224:227], v[156:159], v[176:179], 0
    v_cvt_pk_bf16_f32 v180, v228, v232
    v_cvt_pk_bf16_f32 v181, v229, v233
    v_cvt_pk_bf16_f32 v182, v230, v234
    v_cvt_pk_bf16_f32 v187, v239, v243
    v_cvt_pk_bf16_f32 v190, v246, v250
    v_pk_mul_f32 v[208:209], v[220:221], v[124:125]
    v_pk_mul_f32 v[220:221], v[220:221], v[120:121]
    v_pk_mul_f32 v[210:211], v[222:223], v[126:127]
    v_pk_mul_f32 v[222:223], v[222:223], v[122:123]
    v_pk_fma_f32 v[220:221], v[224:225], v[124:125], v[220:221] neg_lo:[1,0,0] neg_hi:[1,0,0]
    v_pk_fma_f32 v[224:225], v[224:225], v[120:121], v[208:209]
    v_pk_fma_f32 v[222:223], v[226:227], v[126:127], v[222:223] neg_lo:[1,0,0] neg_hi:[1,0,0]
    v_pk_fma_f32 v[226:227], v[226:227], v[122:123], v[210:211]
    v_mfma_f32_16x16x32_bf16 v[228:231], v[152:155], v[180:183], 0
    v_cvt_pk_bf16_f32 v191, v247, v251
    v_cvt_pk_bf16_f32 v189, v245, v249
    v_mfma_f32_16x16x32_bf16 v[232:235], v[156:159], v[180:183], 0
    v_cvt_pk_bf16_f32 v188, v244, v248
    v_cvt_pk_bf16_f32 v178, v222, v226
    v_mfma_f32_16x16x32_bf16 v[240:243], v[156:159], v[184:187], 0
    v_cvt_pk_bf16_f32 v179, v223, v227
    v_cvt_pk_bf16_f32 v177, v221, v225
    v_mfma_f32_16x16x32_bf16 v[236:239], v[152:155], v[184:187], 0
    v_cvt_pk_bf16_f32 v176, v220, v224
    v_and_b32 v125, 0xffff0000, v217
    v_mfma_f32_16x16x32_bf16 v[244:247], v[152:155], v[188:191], 0
    v_lshlrev_b32_e64 v123, 16, v219
    v_and_b32 v127, 0xffff0000, v219
    v_mfma_f32_16x16x32_bf16 v[248:251], v[156:159], v[188:191], 0
    v_accvgpr_read_b32 v219, a23
    v_and_b32 v124, 0xffff0000, v216
    v_mfma_f32_16x16x32_bf16 v[224:227], v[176:179], v[164:167], 0
    v_lshlrev_b32_e64 v121, 16, v217
    v_accvgpr_read_b32 v217, a21
    v_mfma_f32_16x16x32_bf16 v[220:223], v[176:179], v[160:163], 0
    v_lshlrev_b32_e64 v120, 16, v216
    v_accvgpr_read_b32 v216, a20
    v_and_b32 v126, 0xffff0000, v218
    v_lshlrev_b32_e64 v122, 16, v218
    v_accvgpr_read_b32 v218, a22
    v_pk_mul_f32 v[210:211], v[238:239], v[142:143]
    v_pk_mul_f32 v[214:215], v[230:231], v[134:135]
    v_pk_mul_f32 v[230:231], v[230:231], v[130:131]
    v_pk_mul_f32 v[212:213], v[228:229], v[132:133]
    v_pk_mul_f32 v[228:229], v[228:229], v[128:129]
    v_pk_mul_f32 v[238:239], v[238:239], v[138:139]
    v_pk_fma_f32 v[228:229], v[232:233], v[132:133], v[228:229] neg_lo:[1,0,0] neg_hi:[1,0,0]
    v_pk_fma_f32 v[238:239], v[242:243], v[142:143], v[238:239] neg_lo:[1,0,0] neg_hi:[1,0,0]
    v_pk_mul_f32 v[208:209], v[236:237], v[140:141]
    v_pk_fma_f32 v[230:231], v[234:235], v[134:135], v[230:231] neg_lo:[1,0,0] neg_hi:[1,0,0]
    v_pk_fma_f32 v[234:235], v[234:235], v[130:131], v[214:215]
    v_pk_fma_f32 v[232:233], v[232:233], v[128:129], v[212:213]
    v_pk_mul_f32 v[212:213], v[244:245], v[148:149]
    v_pk_mul_f32 v[214:215], v[246:247], v[150:151]
    v_pk_mul_f32 v[236:237], v[236:237], v[136:137]
    v_pk_mul_f32 v[246:247], v[246:247], v[146:147]
    v_pk_fma_f32 v[236:237], v[240:241], v[140:141], v[236:237] neg_lo:[1,0,0] neg_hi:[1,0,0]
    v_pk_fma_f32 v[242:243], v[242:243], v[138:139], v[210:211]
    v_pk_mul_f32 v[210:211], v[222:223], v[114:115]
    v_pk_fma_f32 v[240:241], v[240:241], v[136:137], v[208:209]
    v_pk_mul_f32 v[244:245], v[244:245], v[144:145]
    v_pk_fma_f32 v[246:247], v[250:251], v[150:151], v[246:247] neg_lo:[1,0,0] neg_hi:[1,0,0]
    v_pk_fma_f32 v[244:245], v[248:249], v[148:149], v[244:245] neg_lo:[1,0,0] neg_hi:[1,0,0]
    v_pk_fma_f32 v[250:251], v[250:251], v[146:147], v[214:215]
    v_pk_fma_f32 v[248:249], v[248:249], v[144:145], v[212:213]
    v_pk_mul_f32 v[222:223], v[222:223], v[110:111]
    v_pk_mul_f32 v[208:209], v[220:221], v[112:113]
    v_pk_fma_f32 v[222:223], v[226:227], v[114:115], v[222:223] neg_lo:[1,0,0] neg_hi:[1,0,0]
    v_pk_fma_f32 v[226:227], v[226:227], v[110:111], v[210:211]
    v_pk_mul_f32 v[220:221], v[220:221], v[108:109]
    v_cvt_pk_bf16_f32 v183, v231, v235
    v_pk_fma_f32 v[220:221], v[224:225], v[112:113], v[220:221] neg_lo:[1,0,0] neg_hi:[1,0,0]
    v_pk_fma_f32 v[224:225], v[224:225], v[108:109], v[208:209]
    v_cvt_pk_bf16_f32 v181, v229, v233
    v_cvt_pk_bf16_f32 v182, v230, v234
    v_cvt_pk_bf16_f32 v180, v228, v232
    v_cvt_pk_bf16_f32 v186, v238, v242
    v_cvt_pk_bf16_f32 v184, v236, v240
    v_mfma_f32_16x16x32_bf16 v[228:231], v[180:183], v[160:163], 0
    v_cvt_pk_bf16_f32 v187, v239, v243
    v_cvt_pk_bf16_f32 v190, v246, v250
    v_mfma_f32_16x16x32_bf16 v[232:235], v[180:183], v[164:167], 0
    v_cvt_pk_bf16_f32 v185, v237, v241
    v_cvt_pk_bf16_f32 v191, v247, v251
    v_cvt_pk_bf16_f32 v188, v244, v248
    v_mfma_f32_16x16x32_bf16 v[236:239], v[184:187], v[160:163], 0
    v_cvt_pk_bf16_f32 v189, v245, v249
    v_cvt_pk_bf16_f32 v179, v223, v227
    v_mfma_f32_16x16x32_bf16 v[240:243], v[184:187], v[164:167], 0
    v_cvt_pk_bf16_f32 v176, v220, v224
    v_cvt_pk_bf16_f32 v177, v221, v225
    v_mfma_f32_16x16x32_bf16 v[244:247], v[188:191], v[160:163], 0
    v_cvt_pk_bf16_f32 v178, v222, v226
    v_and_b32 v134, 0xffff0000, v218
    v_mfma_f32_16x16x32_bf16 v[248:251], v[188:191], v[164:167], 0
    v_lshlrev_b32_e64 v130, 16, v218
    v_and_b32 v132, 0xffff0000, v216
    v_mfma_f32_16x16x32_bf16 v[224:227], v[164:167], v[176:179], 0
    v_and_b32 v135, 0xffff0000, v219
    v_lshlrev_b32_e64 v131, 16, v219
    v_mfma_f32_16x16x32_bf16 v[220:223], v[160:163], v[176:179], 0
    v_lshlrev_b32 v128, 16, v216
    v_lshlrev_b32 v129, 16, v217
    v_and_b32 v133, 0xffff0000, v217
    v_accvgpr_read_b32 v219, a27
    v_accvgpr_read_b32 v216, a24
    v_pk_mul_f32 v[214:215], v[230:231], v[114:115]
    v_pk_mul_f32 v[212:213], v[228:229], v[112:113]
    v_pk_mul_f32 v[228:229], v[228:229], v[108:109]
    v_pk_mul_f32 v[210:211], v[238:239], v[114:115]
    v_pk_mul_f32 v[230:231], v[230:231], v[110:111]
    v_pk_mul_f32 v[238:239], v[238:239], v[110:111]
    v_pk_fma_f32 v[230:231], v[234:235], v[114:115], v[230:231] neg_lo:[1,0,0] neg_hi:[1,0,0]
    v_pk_fma_f32 v[234:235], v[234:235], v[110:111], v[214:215]
    v_pk_fma_f32 v[228:229], v[232:233], v[112:113], v[228:229] neg_lo:[1,0,0] neg_hi:[1,0,0]
    v_pk_fma_f32 v[232:233], v[232:233], v[108:109], v[212:213]
    v_pk_mul_f32 v[212:213], v[244:245], v[112:113]
    v_pk_mul_f32 v[208:209], v[236:237], v[112:113]
    v_pk_mul_f32 v[236:237], v[236:237], v[108:109]
    v_pk_mul_f32 v[214:215], v[246:247], v[114:115]
    v_pk_fma_f32 v[236:237], v[240:241], v[112:113], v[236:237] neg_lo:[1,0,0] neg_hi:[1,0,0]
    v_pk_fma_f32 v[240:241], v[240:241], v[108:109], v[208:209]
    v_pk_fma_f32 v[238:239], v[242:243], v[114:115], v[238:239] neg_lo:[1,0,0] neg_hi:[1,0,0]
    v_pk_mul_f32 v[244:245], v[244:245], v[108:109]
    v_pk_fma_f32 v[242:243], v[242:243], v[110:111], v[210:211]
    v_pk_mul_f32 v[246:247], v[246:247], v[110:111]
    v_pk_fma_f32 v[244:245], v[248:249], v[112:113], v[244:245] neg_lo:[1,0,0] neg_hi:[1,0,0]
    v_pk_fma_f32 v[248:249], v[248:249], v[108:109], v[212:213]
    v_pk_fma_f32 v[246:247], v[250:251], v[114:115], v[246:247] neg_lo:[1,0,0] neg_hi:[1,0,0]
    v_pk_fma_f32 v[250:251], v[250:251], v[110:111], v[214:215]
    v_cvt_pk_bf16_f32 v180, v228, v232
    v_cvt_pk_bf16_f32 v184, v236, v240
    v_cvt_pk_bf16_f32 v181, v229, v233
    v_cvt_pk_bf16_f32 v182, v230, v234
    v_cvt_pk_bf16_f32 v183, v231, v235
    v_cvt_pk_bf16_f32 v186, v238, v242
    v_cvt_pk_bf16_f32 v190, v246, v250
    v_mfma_f32_16x16x32_bf16 v[228:231], v[160:163], v[180:183], 0
    v_cvt_pk_bf16_f32 v187, v239, v243
    v_cvt_pk_bf16_f32 v185, v237, v241
    v_mfma_f32_16x16x32_bf16 v[232:235], v[164:167], v[180:183], 0
    v_cvt_pk_bf16_f32 v188, v244, v248
    v_cvt_pk_bf16_f32 v176, v220, v224
    v_mfma_f32_16x16x32_bf16 v[240:243], v[164:167], v[184:187], 0
    v_cvt_pk_bf16_f32 v191, v247, v251
    v_cvt_pk_bf16_f32 v189, v245, v249
    v_mfma_f32_16x16x32_bf16 v[236:239], v[160:163], v[184:187], 0
    v_cvt_pk_bf16_f32 v179, v223, v227
    v_cvt_pk_bf16_f32 v178, v222, v226
    v_mfma_f32_16x16x32_bf16 v[248:251], v[164:167], v[188:191], 0
    v_cvt_pk_bf16_f32 v177, v221, v225
    v_cvt_pk_bf16_f32 v183, v231, v235
    v_mfma_f32_16x16x32_bf16 v[244:247], v[160:163], v[188:191], 0
    v_cvt_pk_bf16_f32 v180, v228, v232
    v_cvt_pk_bf16_f32 v182, v230, v234
    s_waitcnt lgkmcnt(3)
    v_mfma_f32_16x16x32_bf16 v[220:223], v[192:195], v[152:155], 0
    v_cvt_pk_bf16_f32 v181, v229, v233
    v_cvt_pk_bf16_f32 v185, v237, v241
    s_waitcnt lgkmcnt(2)
    v_mfma_f32_16x16x32_bf16 v[228:231], v[196:199], v[152:155], 0
    v_cvt_pk_bf16_f32 v187, v239, v243
    v_cvt_pk_bf16_f32 v189, v245, v249
    v_mfma_f32_16x16x32_bf16 v[224:227], v[192:195], v[156:159], 0
    v_cvt_pk_bf16_f32 v184, v236, v240
    v_cvt_pk_bf16_f32 v188, v244, v248
    v_mfma_f32_16x16x32_bf16 v[232:235], v[196:199], v[156:159], 0
    v_cvt_pk_bf16_f32 v186, v238, v242
    v_cvt_pk_bf16_f32 v190, v246, v250
    s_waitcnt lgkmcnt(1)
    s_nop 0
    v_mfma_f32_16x16x32_bf16 v[236:239], v[200:203], v[152:155], 0
    v_cvt_pk_bf16_f32 v191, v247, v251
    v_and_b32 v143, 0xffff0000, v219
    v_mfma_f32_16x16x32_bf16 v[240:243], v[200:203], v[156:159], 0
    v_lshlrev_b32_e64 v136, 16, v216
    v_and_b32 v140, 0xffff0000, v216
    s_waitcnt lgkmcnt(0)
    v_mfma_f32_16x16x32_bf16 v[244:247], v[204:207], v[152:155], 0
    v_accvgpr_read_b32 v216, a28
    v_lshlrev_b32 v139, 16, v219
    v_mfma_f32_16x16x32_bf16 v[248:251], v[204:207], v[156:159], 0
    v_and_b32 v148, 0xffff0000, v216
    v_accvgpr_read_b32 v218, a26
    v_accvgpr_read_b32 v217, a25
    v_lshlrev_b32_e64 v138, 16, v218
    v_and_b32 v142, 0xffff0000, v218
    v_pk_mul_f32 v[208:209], v[220:221], v[112:113]
    v_pk_mul_f32 v[220:221], v[220:221], v[108:109]
    v_pk_mul_f32 v[212:213], v[228:229], v[112:113]
    v_pk_mul_f32 v[210:211], v[222:223], v[114:115]
    v_pk_mul_f32 v[222:223], v[222:223], v[110:111]
    v_pk_mul_f32 v[214:215], v[230:231], v[114:115]
    v_pk_fma_f32 v[220:221], v[224:225], v[112:113], v[220:221]
    v_pk_fma_f32 v[224:225], v[224:225], v[108:109], v[208:209] neg_lo:[0,0,1] neg_hi:[0,0,1]
    v_pk_fma_f32 v[222:223], v[226:227], v[114:115], v[222:223]
    v_pk_fma_f32 v[226:227], v[226:227], v[110:111], v[210:211] neg_lo:[0,0,1] neg_hi:[0,0,1]
    v_pk_mul_f32 v[228:229], v[228:229], v[108:109]
    v_pk_mul_f32 v[230:231], v[230:231], v[110:111]
    v_pk_fma_f32 v[228:229], v[232:233], v[112:113], v[228:229]
    v_pk_fma_f32 v[232:233], v[232:233], v[108:109], v[212:213] neg_lo:[0,0,1] neg_hi:[0,0,1]
    v_pk_fma_f32 v[230:231], v[234:235], v[114:115], v[230:231]
    v_pk_fma_f32 v[234:235], v[234:235], v[110:111], v[214:215] neg_lo:[0,0,1] neg_hi:[0,0,1]
    v_pk_mul_f32 v[212:213], v[244:245], v[112:113]
    v_pk_mul_f32 v[214:215], v[246:247], v[114:115]
    v_pk_mul_f32 v[210:211], v[238:239], v[114:115]
    v_pk_mul_f32 v[238:239], v[238:239], v[110:111]
    v_pk_mul_f32 v[208:209], v[236:237], v[112:113]
    v_pk_mul_f32 v[236:237], v[236:237], v[108:109]
    v_pk_mul_f32 v[246:247], v[246:247], v[110:111]
    v_pk_fma_f32 v[236:237], v[240:241], v[112:113], v[236:237]
    v_pk_fma_f32 v[246:247], v[250:251], v[114:115], v[246:247]
    v_pk_fma_f32 v[240:241], v[240:241], v[108:109], v[208:209] neg_lo:[0,0,1] neg_hi:[0,0,1]
    v_pk_fma_f32 v[238:239], v[242:243], v[114:115], v[238:239]
    v_pk_fma_f32 v[242:243], v[242:243], v[110:111], v[210:211] neg_lo:[0,0,1] neg_hi:[0,0,1]
    v_pk_fma_f32 v[250:251], v[250:251], v[110:111], v[214:215] neg_lo:[0,0,1] neg_hi:[0,0,1]
    v_pk_mul_f32 v[244:245], v[244:245], v[108:109]
    v_cvt_pk_bf16_f32 v193, v221, v225
    v_pk_fma_f32 v[244:245], v[248:249], v[112:113], v[244:245]
    v_pk_fma_f32 v[248:249], v[248:249], v[108:109], v[212:213] neg_lo:[0,0,1] neg_hi:[0,0,1]
    v_cvt_pk_bf16_f32 v198, v230, v234
    v_cvt_pk_bf16_f32 v192, v220, v224
    v_cvt_pk_bf16_f32 v199, v231, v235
    v_cvt_pk_bf16_f32 v196, v228, v232
    v_cvt_pk_bf16_f32 v195, v223, v227
    v_cvt_pk_bf16_f32 v194, v222, v226
    v_cvt_pk_bf16_f32 v197, v229, v233
    v_cvt_pk_bf16_f32 v202, v238, v242
    v_mfma_f32_16x16x32_bf16 v[224:227], v[156:159], v[192:195], 0
    v_cvt_pk_bf16_f32 v200, v236, v240
    v_cvt_pk_bf16_f32 v201, v237, v241
    v_mfma_f32_16x16x32_bf16 v[228:231], v[152:155], v[196:199], 0
    v_cvt_pk_bf16_f32 v207, v247, v251
    v_cvt_pk_bf16_f32 v203, v239, v243
    v_mfma_f32_16x16x32_bf16 v[220:223], v[152:155], v[192:195], 0
    v_cvt_pk_bf16_f32 v206, v246, v250
    v_cvt_pk_bf16_f32 v205, v245, v249
    v_mfma_f32_16x16x32_bf16 v[236:239], v[152:155], v[200:203], 0
    v_cvt_pk_bf16_f32 v204, v244, v248
    v_and_b32 v141, 0xffff0000, v217
    v_mfma_f32_16x16x32_bf16 v[240:243], v[156:159], v[200:203], 0
    v_lshlrev_b32_e64 v137, 16, v217
    v_accvgpr_read_b32 v217, a29
    v_mfma_f32_16x16x32_bf16 v[232:235], v[156:159], v[196:199], 0
    v_and_b32 v149, 0xffff0000, v217
    v_accvgpr_read_b32 v219, a31
    v_mfma_f32_16x16x32_bf16 v[244:247], v[152:155], v[204:207], 0
    v_and_b32 v151, 0xffff0000, v219
    v_lshlrev_b32_e64 v147, 16, v219
    v_mfma_f32_16x16x32_bf16 v[248:251], v[156:159], v[204:207], 0
    v_accvgpr_read_b32 v218, a30
    v_lshlrev_b32_e64 v145, 16, v217
    v_and_b32 v150, 0xffff0000, v218
    v_lshlrev_b32 v146, 16, v218
    v_lshlrev_b32 v144, 16, v216
    v_pk_mul_f32 v[214:215], v[230:231], v[134:135]
    v_pk_mul_f32 v[210:211], v[222:223], v[126:127]
    v_pk_mul_f32 v[222:223], v[222:223], v[122:123]
    v_pk_mul_f32 v[212:213], v[228:229], v[132:133]
    v_pk_mul_f32 v[208:209], v[220:221], v[124:125]
    v_pk_mul_f32 v[220:221], v[220:221], v[120:121]
    v_pk_mul_f32 v[228:229], v[228:229], v[128:129]
    v_pk_fma_f32 v[220:221], v[224:225], v[124:125], v[220:221] neg_lo:[1,0,0] neg_hi:[1,0,0]
    v_pk_fma_f32 v[222:223], v[226:227], v[126:127], v[222:223] neg_lo:[1,0,0] neg_hi:[1,0,0]
    v_pk_fma_f32 v[226:227], v[226:227], v[122:123], v[210:211]
    v_pk_fma_f32 v[224:225], v[224:225], v[120:121], v[208:209]
    v_pk_mul_f32 v[230:231], v[230:231], v[130:131]
    v_pk_mul_f32 v[210:211], v[238:239], v[142:143]
    v_pk_fma_f32 v[230:231], v[234:235], v[134:135], v[230:231] neg_lo:[1,0,0] neg_hi:[1,0,0]
    v_pk_fma_f32 v[234:235], v[234:235], v[130:131], v[214:215]
    v_pk_mul_f32 v[214:215], v[246:247], v[150:151]
    v_pk_fma_f32 v[228:229], v[232:233], v[132:133], v[228:229] neg_lo:[1,0,0] neg_hi:[1,0,0]
    v_pk_fma_f32 v[232:233], v[232:233], v[128:129], v[212:213]
    v_pk_mul_f32 v[208:209], v[236:237], v[140:141]
    v_pk_mul_f32 v[236:237], v[236:237], v[136:137]
    v_pk_mul_f32 v[246:247], v[246:247], v[146:147]
    v_pk_fma_f32 v[236:237], v[240:241], v[140:141], v[236:237] neg_lo:[1,0,0] neg_hi:[1,0,0]
    v_pk_mul_f32 v[238:239], v[238:239], v[138:139]
    v_pk_fma_f32 v[240:241], v[240:241], v[136:137], v[208:209]
    v_pk_fma_f32 v[238:239], v[242:243], v[142:143], v[238:239] neg_lo:[1,0,0] neg_hi:[1,0,0]
    v_pk_fma_f32 v[242:243], v[242:243], v[138:139], v[210:211]
    v_pk_mul_f32 v[212:213], v[244:245], v[148:149]
    v_pk_fma_f32 v[246:247], v[250:251], v[150:151], v[246:247] neg_lo:[1,0,0] neg_hi:[1,0,0]
    v_pk_fma_f32 v[250:251], v[250:251], v[146:147], v[214:215]
    v_pk_mul_f32 v[244:245], v[244:245], v[144:145]
    v_cvt_pk_bf16_f32 v193, v221, v225
    v_pk_fma_f32 v[244:245], v[248:249], v[148:149], v[244:245] neg_lo:[1,0,0] neg_hi:[1,0,0]
    v_pk_fma_f32 v[248:249], v[248:249], v[144:145], v[212:213]
    v_cvt_pk_bf16_f32 v192, v220, v224
    v_cvt_pk_bf16_f32 v195, v223, v227
    v_cvt_pk_bf16_f32 v194, v222, v226
    v_cvt_pk_bf16_f32 v198, v230, v234
    v_cvt_pk_bf16_f32 v202, v238, v242
    v_mfma_f32_16x16x32_bf16 v[220:223], v[192:195], v[160:163], 0
    v_cvt_pk_bf16_f32 v197, v229, v233
    v_cvt_pk_bf16_f32 v196, v228, v232
    v_mfma_f32_16x16x32_bf16 v[224:227], v[192:195], v[164:167], 0
    v_cvt_pk_bf16_f32 v199, v231, v235
    v_cvt_pk_bf16_f32 v201, v237, v241
    v_cvt_pk_bf16_f32 v200, v236, v240
    v_mfma_f32_16x16x32_bf16 v[232:235], v[196:199], v[164:167], 0
    v_cvt_pk_bf16_f32 v204, v244, v248
    v_cvt_pk_bf16_f32 v203, v239, v243
    v_mfma_f32_16x16x32_bf16 v[228:231], v[196:199], v[160:163], 0
    v_cvt_pk_bf16_f32 v205, v245, v249
    v_cvt_pk_bf16_f32 v207, v247, v251
    v_mfma_f32_16x16x32_bf16 v[236:239], v[200:203], v[160:163], 0
    v_cvt_pk_bf16_f32 v206, v246, v250
    v_min_u32_e64 v178, -2, v178
    v_mfma_f32_16x16x32_bf16 v[240:243], v[200:203], v[164:167], 0
    v_min_u32 v177, -2, v177
    v_min_u32 v181, -2, v181
    v_mfma_f32_16x16x32_bf16 v[248:251], v[204:207], v[164:167], 0
    v_min_u32 v176, -2, v176
    v_min_u32 v179, -2, v179
    v_mfma_f32_16x16x32_bf16 v[244:247], v[204:207], v[160:163], 0
    ds_write_b128 v172, v[176:179] offset:32768
    v_min_u32_e64 v180, -2, v180
    v_pk_mul_f32 v[210:211], v[222:223], v[114:115]
    v_pk_mul_f32 v[208:209], v[220:221], v[112:113]
    v_pk_mul_f32 v[220:221], v[220:221], v[108:109]
    v_pk_mul_f32 v[222:223], v[222:223], v[110:111]
    v_pk_fma_f32 v[220:221], v[224:225], v[112:113], v[220:221] neg_lo:[1,0,0] neg_hi:[1,0,0]
    v_pk_fma_f32 v[224:225], v[224:225], v[108:109], v[208:209]
    v_pk_fma_f32 v[222:223], v[226:227], v[114:115], v[222:223] neg_lo:[1,0,0] neg_hi:[1,0,0]
    v_pk_fma_f32 v[226:227], v[226:227], v[110:111], v[210:211]
    v_pk_mul_f32 v[212:213], v[228:229], v[112:113]
    v_pk_mul_f32 v[228:229], v[228:229], v[108:109]
    v_pk_mul_f32 v[214:215], v[230:231], v[114:115]
    v_pk_mul_f32 v[230:231], v[230:231], v[110:111]
    v_pk_fma_f32 v[228:229], v[232:233], v[112:113], v[228:229] neg_lo:[1,0,0] neg_hi:[1,0,0]
    v_pk_mul_f32 v[210:211], v[238:239], v[114:115]
    v_pk_fma_f32 v[230:231], v[234:235], v[114:115], v[230:231] neg_lo:[1,0,0] neg_hi:[1,0,0]
    v_pk_fma_f32 v[234:235], v[234:235], v[110:111], v[214:215]
    v_pk_fma_f32 v[232:233], v[232:233], v[108:109], v[212:213]
    v_pk_mul_f32 v[212:213], v[244:245], v[112:113]
    v_pk_mul_f32 v[238:239], v[238:239], v[110:111]
    v_pk_mul_f32 v[214:215], v[246:247], v[114:115]
    v_pk_mul_f32 v[208:209], v[236:237], v[112:113]
    v_pk_mul_f32 v[236:237], v[236:237], v[108:109]
    v_pk_fma_f32 v[238:239], v[242:243], v[114:115], v[238:239] neg_lo:[1,0,0] neg_hi:[1,0,0]
    v_pk_fma_f32 v[236:237], v[240:241], v[112:113], v[236:237] neg_lo:[1,0,0] neg_hi:[1,0,0]
    v_pk_fma_f32 v[240:241], v[240:241], v[108:109], v[208:209]
    v_pk_mul_f32 v[246:247], v[246:247], v[110:111]
    v_pk_fma_f32 v[242:243], v[242:243], v[110:111], v[210:211]
    v_pk_fma_f32 v[246:247], v[250:251], v[114:115], v[246:247] neg_lo:[1,0,0] neg_hi:[1,0,0]
    v_pk_fma_f32 v[250:251], v[250:251], v[110:111], v[214:215]
    v_pk_mul_f32 v[244:245], v[244:245], v[108:109]
    v_cvt_pk_bf16_f32 v195, v223, v227
    v_pk_fma_f32 v[244:245], v[248:249], v[112:113], v[244:245] neg_lo:[1,0,0] neg_hi:[1,0,0]
    v_pk_fma_f32 v[248:249], v[248:249], v[108:109], v[212:213]
    v_cvt_pk_bf16_f32 v192, v220, v224
    v_cvt_pk_bf16_f32 v194, v222, v226
    v_cvt_pk_bf16_f32 v196, v228, v232
    v_cvt_pk_bf16_f32 v193, v221, v225
    v_min_u32 v183, -2, v183
    v_min_u32 v186, -2, v186
    v_mfma_f32_16x16x32_bf16 v[224:227], v[164:167], v[192:195], 0
    v_min_u32_e64 v184, -2, v184
    v_cvt_pk_bf16_f32 v203, v239, v243
    v_mfma_f32_16x16x32_bf16 v[220:223], v[160:163], v[192:195], 0
    v_min_u32 v182, -2, v182
    v_min_u32 v187, -2, v187
    ds_write_b128 v172, v[180:183] offset:33792
    v_cvt_pk_bf16_f32 v197, v229, v233
    v_cvt_pk_bf16_f32 v198, v230, v234
    v_cvt_pk_bf16_f32 v199, v231, v235
    v_min_u32_e64 v191, -2, v191
    v_cvt_pk_bf16_f32 v202, v238, v242
    v_mfma_f32_16x16x32_bf16 v[232:235], v[164:167], v[196:199], 0
    v_cvt_pk_bf16_f32 v201, v237, v241
    v_min_u32_e64 v185, -2, v185
    v_mfma_f32_16x16x32_bf16 v[228:231], v[160:163], v[196:199], 0
    ds_write_b128 v172, v[184:187] offset:34816
    v_min_u32 v189, -2, v189
    v_min_u32 v190, -2, v190
    v_cvt_pk_bf16_f32 v200, v236, v240
    v_min_u32_e64 v188, -2, v188
    v_cvt_pk_bf16_f32 v206, v246, v250
    v_mfma_f32_16x16x32_bf16 v[240:243], v[164:167], v[200:203], 0
    v_cvt_pk_bf16_f32 v195, v223, v227
    ds_write_b128 v172, v[188:191] offset:35840
    v_mfma_f32_16x16x32_bf16 v[236:239], v[160:163], v[200:203], 0
    v_cvt_pk_bf16_f32 v207, v247, v251
    v_cvt_pk_bf16_f32 v204, v244, v248
    v_cvt_pk_bf16_f32 v205, v245, v249
    v_cvt_pk_bf16_f32 v196, v228, v232
    v_cvt_pk_bf16_f32 v194, v222, v226
    v_mfma_f32_16x16x32_bf16 v[244:247], v[160:163], v[204:207], 0
    v_min_u32_e64 v194, -2, v194
    v_cvt_pk_bf16_f32 v199, v231, v235
    v_mfma_f32_16x16x32_bf16 v[248:251], v[164:167], v[204:207], 0
    v_cvt_pk_bf16_f32 v192, v220, v224
    v_cvt_pk_bf16_f32 v193, v221, v225
    v_min_u32 v199, -2, v199
    v_min_u32 v193, -2, v193
    v_min_u32 v195, -2, v195
    v_min_u32 v192, -2, v192
    v_cvt_pk_bf16_f32 v197, v229, v233
    ds_write_b128 v173, v[192:195] offset:49152
    v_min_u32_e64 v197, -2, v197
    v_cvt_pk_bf16_f32 v198, v230, v234
    v_min_u32 v196, -2, v196
    v_min_u32 v198, -2, v198
    v_cvt_pk_bf16_f32 v203, v239, v243
    ds_write_b128 v173, v[196:199] offset:50176
    v_cvt_pk_bf16_f32 v202, v238, v242
    v_min_u32 v203, -2, v203
    v_min_u32 v202, -2, v202
    v_cvt_pk_bf16_f32 v200, v236, v240
    v_cvt_pk_bf16_f32 v204, v244, v248
    v_cvt_pk_bf16_f32 v201, v237, v241
    v_cvt_pk_bf16_f32 v205, v245, v249
    v_min_u32_e64 v201, -2, v201
    v_cvt_pk_bf16_f32 v206, v246, v250
    v_min_u32_e64 v200, -2, v200
    v_cvt_pk_bf16_f32 v207, v247, v251
    ds_write_b128 v173, v[200:203] offset:51200
    v_min_u32 v207, -2, v207
    v_min_u32 v205, -2, v205
    v_min_u32 v206, -2, v206
    v_min_u32 v204, -2, v204
    ds_write_b128 v173, v[204:207] offset:52224
    s_mov_b32 s66, 0
    s_branch L_fwc_30
L_fw_28:
    s_mov_b32 s48, 25198592
    s_lshl_b32 s49, s64, 14
    s_add_u32 s48, s48, s49
    v_lshlrev_b32_e64 v175, 6, v0
    v_min_u32 v175, 12480, v175
    buffer_load_dword v174, v175, s[4:7], s48 offen sc1
L_fwc_30:
    s_waitcnt vmcnt(0)
    v_cmp_ne_u32 vcc, s68, v174
    s_cbranch_vccz L_fwd_29
    s_add_u32 s66, s66, 1
    s_cmp_lt_u32 s66, s67
    s_sleep 2
    s_cbranch_scc1 L_fw_28
    s_mov_b32 s67, 1
L_fwd_29:
    s_waitcnt lgkmcnt(0)
    s_barrier
    ds_read_b32 v120, v168 offset:32768
    ds_read_b32 v121, v168 offset:33792
    ds_read_b32 v122, v168 offset:34816
    ds_read_b32 v123, v168 offset:35840
    ds_read_b32 v124, v168 offset:33280
    ds_read_b32 v125, v168 offset:34304
    ds_read_b32 v126, v168 offset:35328
    ds_read_b32 v127, v168 offset:36352
    ds_read_b32 v128, v169 offset:32768
    ds_read_b32 v129, v169 offset:33792
    ds_read_b32 v130, v169 offset:34816
    ds_read_b32 v131, v169 offset:35840
    ds_read_b32 v132, v169 offset:33280
    ds_read_b32 v133, v169 offset:34304
    ds_read_b32 v134, v169 offset:35328
    ds_read_b32 v135, v169 offset:36352
    ds_read_b32 v136, v170 offset:32768
    ds_read_b32 v137, v170 offset:33792
    ds_read_b32 v138, v170 offset:34816
    ds_read_b32 v139, v170 offset:35840
    ds_read_b32 v140, v170 offset:33280
    ds_read_b32 v141, v170 offset:34304
    ds_read_b32 v142, v170 offset:35328
    ds_read_b32 v143, v170 offset:36352
    ds_read_b32 v144, v171 offset:32768
    ds_read_b32 v145, v171 offset:33792
    ds_read_b32 v146, v171 offset:34816
    ds_read_b32 v147, v171 offset:35840
    ds_read_b32 v148, v171 offset:33280
    ds_read_b32 v149, v171 offset:34304
    ds_read_b32 v150, v171 offset:35328
    ds_read_b32 v151, v171 offset:36352
    s_add_u32 s48, s55, 2097152
    s_waitcnt lgkmcnt(15)
    s_nop 0
    buffer_store_dwordx4 v[120:123], v117, s[4:7], s48 offen sc1
    s_add_u32 s49, s55, 2359296
    buffer_store_dwordx4 v[124:127], v117, s[4:7], s49 offen sc1
    s_add_u32 s48, s55, 2099200
    buffer_store_dwordx4 v[128:131], v117, s[4:7], s48 offen sc1
    s_add_u32 s49, s55, 2361344
    buffer_store_dwordx4 v[132:135], v117, s[4:7], s49 offen sc1
    s_add_u32 s48, s55, 2101248
    s_waitcnt lgkmcnt(12)
    buffer_store_dwordx4 v[136:139], v117, s[4:7], s48 offen sc1
    s_add_u32 s49, s55, 2363392
    s_waitcnt lgkmcnt(8)
    buffer_store_dwordx4 v[140:143], v117, s[4:7], s49 offen sc1
    s_add_u32 s48, s55, 2103296
    s_waitcnt lgkmcnt(4)
    buffer_store_dwordx4 v[144:147], v117, s[4:7], s48 offen sc1
    s_add_u32 s49, s55, 2365440
    s_waitcnt lgkmcnt(0)
    buffer_store_dwordx4 v[148:151], v117, s[4:7], s49 offen sc1
L_p2skip_22:
    s_cmp_eq_u32 s64, 0
    s_cbranch_scc1 L_p2hskip_31
    s_cmp_eq_u32 s73, 2
    s_cbranch_scc1 L_p2hskip_31
    s_getpc_b64 s[48:49]
L_pc_32:
    s_add_u32 s52, s48, L_table-L_pc_32+23552
    s_addc_u32 s49, s49, 0
    s_and_b32 s53, s49, 0xffff
    s_mov_b32 s54, 6144
    s_mov_b32 s55, 0x00020000
    s_mov_b32 s48, 4096
    buffer_load_dwordx4 v[152:155], v45, s[52:55], 0 offen offset:0
    buffer_load_dwordx4 v[156:159], v45, s[52:55], 0 offen offset:1024
    buffer_load_dwordx4 v[160:163], v45, s[52:55], 0 offen offset:2048
    buffer_load_dwordx4 v[164:167], v45, s[52:55], 0 offen offset:3072
    buffer_load_dwordx4 v[168:171], v45, s[52:55], s48 offen offset:0
    buffer_load_dwordx4 v[172:175], v45, s[52:55], s48 offen offset:1024
    v_bfe_u32 v200, v1, 4, 1
    s_lshl_b32 s50, s3, 1
    v_or_b32 v200, s50, v200
    v_xor_b32 v200, v200, v1
    s_lshl_b32 s51, s3, 12
    v_lshl_add_u32 v180, v200, 4, s51
    ds_read_b128 v[208:211], v180 offset:49152
    ds_read_b128 v[212:215], v180 offset:50176
    ds_read_b128 v[216:219], v180 offset:51200
    ds_read_b128 v[220:223], v180 offset:52224
    v_and_b32_e64 v201, 3, v1
    v_bfe_u32 v200, v1, 3, 2
    v_lshlrev_b32 v200, 2, v200
    v_lshrrev_b32 v202, 5, v1
    v_lshl_add_u32 v200, v202, 8, v200
    v_bfe_u32 v203, v1, 2, 1
    v_lshl_add_u32 v200, v203, 7, v200
    v_lshl_add_u32 v200, v201, 12, v200
    v_lshl_or_b32 v202, v201, 1, v202
    v_xor_b32_e64 v202, s50, v202
    v_lshl_add_u32 v182, v202, 4, v200
    v_xor_b32 v183, 16, v182
    s_lshl_b32 s25, s78, 19
    s_lshl_b32 s51, s3, 13
    s_add_u32 s25, s25, s51
    s_lshl_b32 s50, s79, 1
    s_add_u32 s50, s50, s73
    s_lshl_b32 s51, s50, 7
    s_add_u32 s25, s25, s51
    s_add_u32 s25, s25, 14680064
    v_lshrrev_b32 v200, 2, v1
    v_and_b32 v201, 3, v1
    v_lshlrev_b32_e64 v117, 15, v200
    v_lshl_add_u32 v117, v201, 4, v117
    s_lshl_b32 s24, s78, 8
    s_lshl_b32 s50, s3, 2
    s_add_u32 s24, s24, s50
    s_lshl_b32 s24, s24, 11
    s_lshl_b32 s50, s79, 1
    s_add_u32 s50, s50, s73
    s_lshl_b32 s51, s50, 6
    s_add_u32 s24, s24, s51
    v_and_b32 v202, 3, v200
    v_lshrrev_b32 v203, 2, v200
    v_lshlrev_b32_e64 v204, 8, v203
    v_lshl_add_u32 v202, v202, 2, v204
    v_lshl_add_u32 v202, v201, 12, v202
    s_lshr_b32 s50, s3, 1
    s_lshl_b32 s50, s50, 7
    v_add_u32 v202, s50, v202
    v_and_b32 v203, 1, v203
    v_lshl_or_b32 v203, v201, 1, v203
    s_and_b32 s50, s3, 1
    s_lshl_b32 s50, s50, 2
    s_add_u32 s51, s50, 0
    v_xor_b32 v204, s51, v203
    v_lshl_add_u32 v176, v204, 4, v202
    s_add_u32 s51, s50, 1
    v_xor_b32 v204, s51, v203
    v_lshl_add_u32 v177, v204, 4, v202
    s_add_u32 s51, s50, 2
    v_xor_b32 v204, s51, v203
    v_lshl_add_u32 v178, v204, 4, v202
    s_add_u32 s51, s50, 3
    v_xor_b32 v204, s51, v203
    v_lshl_add_u32 v179, v204, 4, v202
    s_waitcnt lgkmcnt(0)
    v_lshlrev_b32 v120, 16, v208
    v_and_b32 v124, 0xffff0000, v208
    v_lshlrev_b32_e64 v121, 16, v209
    v_and_b32 v125, 0xffff0000, v209
    v_lshlrev_b32_e64 v122, 16, v210
    v_and_b32 v126, 0xffff0000, v210
    v_lshlrev_b32_e64 v123, 16, v211
    v_and_b32 v127, 0xffff0000, v211
    v_lshlrev_b32_e64 v128, 16, v212
    v_and_b32 v132, 0xffff0000, v212
    v_lshlrev_b32_e64 v129, 16, v213
    v_and_b32 v133, 0xffff0000, v213
    v_lshlrev_b32_e64 v130, 16, v214
    v_and_b32 v134, 0xffff0000, v214
    v_lshlrev_b32_e64 v131, 16, v215
    v_and_b32 v135, 0xffff0000, v215
    v_lshlrev_b32_e64 v136, 16, v216
    v_and_b32 v140, 0xffff0000, v216
    v_lshlrev_b32_e64 v137, 16, v217
    v_and_b32 v141, 0xffff0000, v217
    v_lshlrev_b32_e64 v138, 16, v218
    v_and_b32 v142, 0xffff0000, v218
    v_lshlrev_b32_e64 v139, 16, v219
    v_and_b32 v143, 0xffff0000, v219
    v_lshlrev_b32_e64 v144, 16, v220
    v_and_b32 v148, 0xffff0000, v220
    v_lshlrev_b32_e64 v145, 16, v221
    v_and_b32 v149, 0xffff0000, v221
    v_lshlrev_b32_e64 v146, 16, v222
    v_and_b32 v150, 0xffff0000, v222
    v_lshlrev_b32_e64 v147, 16, v223
    v_and_b32 v151, 0xffff0000, v223
    s_waitcnt vmcnt(0)
    s_sleep 5
    s_mov_b32 s66, 0
L_p2hpoll_33:
    s_add_u32 s48, s24, 0
    buffer_load_dwordx4 v[184:187], v117, s[4:7], s48 offen sc1
    s_add_u32 s48, s24, 2048
    buffer_load_dwordx4 v[188:191], v117, s[4:7], s48 offen sc1
    s_add_u32 s48, s24, 4096
    buffer_load_dwordx4 v[192:195], v117, s[4:7], s48 offen sc1
    s_add_u32 s48, s24, 6144
    buffer_load_dwordx4 v[196:199], v117, s[4:7], s48 offen sc1
    s_waitcnt vmcnt(0)
    s_nop 0
    v_max3_u32 v200, v184, v185, v186
    v_max3_u32 v200, v200, v187, v188
    v_max3_u32 v200, v200, v189, v190
    v_max3_u32 v200, v200, v191, v192
    v_max3_u32 v200, v200, v193, v194
    v_max3_u32 v200, v200, v195, v196
    v_max3_u32 v200, v200, v197, v198
    v_max_u32 v200, v200, v199
    v_cmp_eq_u32 vcc, -1, v200
    s_cbranch_vccz L_p2hpolld_34
    s_add_u32 s66, s66, 1
    s_cmp_lt_u32 s66, s67
    s_sleep 2
    s_cbranch_scc1 L_p2hpoll_33
    s_mov_b32 s67, 1
L_p2hpolld_34:
    ds_write2st64_b32 v176, v184, v185 offset0:128 offset1:132
    ds_write2st64_b32 v176, v186, v187 offset0:136 offset1:140
    ds_write2st64_b32 v177, v188, v189 offset0:128 offset1:132
    ds_write2st64_b32 v177, v190, v191 offset0:136 offset1:140
    ds_write2st64_b32 v178, v192, v193 offset0:128 offset1:132
    ds_write2st64_b32 v178, v194, v195 offset0:136 offset1:140
    ds_write2st64_b32 v179, v196, v197 offset0:128 offset1:132
    ds_write2st64_b32 v179, v198, v199 offset0:136 offset1:140
    s_mov_b32 s48, 25198592
    s_lshl_b32 s49, s64, 14
    s_add_u32 s48, s48, s49
    v_lshlrev_b32_e64 v241, 6, v0
    v_min_u32 v241, 12480, v241
    buffer_load_dword v240, v241, s[4:7], s48 offen sc1
    v_lshrrev_b32 v117, 3, v1
    v_and_b32 v200, 7, v1
    v_lshlrev_b32_e64 v117, 15, v117
    v_lshl_add_u32 v117, v200, 4, v117
    s_waitcnt lgkmcnt(0)
    s_barrier
    ds_read_b128 v[184:187], v180 offset:32768
    ds_read_b128 v[188:191], v180 offset:33792
    ds_read_b128 v[192:195], v180 offset:34816
    ds_read_b128 v[196:199], v180 offset:35840
    s_waitcnt lgkmcnt(3)
    v_mfma_f32_16x16x32_bf16 v[208:211], v[184:187], v[152:155], 0
    v_mfma_f32_16x16x32_bf16 v[212:215], v[184:187], v[156:159], 0
    s_waitcnt lgkmcnt(2)
    v_mfma_f32_16x16x32_bf16 v[216:219], v[188:191], v[152:155], 0
    v_mfma_f32_16x16x32_bf16 v[220:223], v[188:191], v[156:159], 0
    s_waitcnt lgkmcnt(1)
    v_mfma_f32_16x16x32_bf16 v[224:227], v[192:195], v[152:155], 0
    v_mfma_f32_16x16x32_bf16 v[228:231], v[192:195], v[156:159], 0
    s_waitcnt lgkmcnt(0)
    v_mfma_f32_16x16x32_bf16 v[232:235], v[196:199], v[152:155], 0
    v_mfma_f32_16x16x32_bf16 v[236:239], v[196:199], v[156:159], 0
    v_pk_mul_f32 v[200:201], v[208:209], v[172:173]
    v_pk_mul_f32 v[202:203], v[210:211], v[174:175]
    v_pk_mul_f32 v[208:209], v[208:209], v[168:169]
    v_pk_mul_f32 v[210:211], v[210:211], v[170:171]
    v_pk_fma_f32 v[208:209], v[212:213], v[172:173], v[208:209]
    v_pk_fma_f32 v[210:211], v[214:215], v[174:175], v[210:211]
    v_pk_fma_f32 v[212:213], v[212:213], v[168:169], v[200:201] neg_lo:[0,0,1] neg_hi:[0,0,1]
    v_pk_fma_f32 v[214:215], v[214:215], v[170:171], v[202:203] neg_lo:[0,0,1] neg_hi:[0,0,1]
    v_pk_mul_f32 v[204:205], v[216:217], v[172:173]
    v_pk_mul_f32 v[206:207], v[218:219], v[174:175]
    v_pk_mul_f32 v[216:217], v[216:217], v[168:169]
    v_pk_mul_f32 v[218:219], v[218:219], v[170:171]
    v_pk_fma_f32 v[216:217], v[220:221], v[172:173], v[216:217]
    v_pk_fma_f32 v[218:219], v[222:223], v[174:175], v[218:219]
    v_pk_fma_f32 v[220:221], v[220:221], v[168:169], v[204:205] neg_lo:[0,0,1] neg_hi:[0,0,1]
    v_pk_fma_f32 v[222:223], v[222:223], v[170:171], v[206:207] neg_lo:[0,0,1] neg_hi:[0,0,1]
    v_pk_mul_f32 v[200:201], v[224:225], v[172:173]
    v_pk_mul_f32 v[202:203], v[226:227], v[174:175]
    v_pk_mul_f32 v[224:225], v[224:225], v[168:169]
    v_pk_mul_f32 v[226:227], v[226:227], v[170:171]
    v_pk_fma_f32 v[224:225], v[228:229], v[172:173], v[224:225]
    v_pk_fma_f32 v[226:227], v[230:231], v[174:175], v[226:227]
    v_pk_fma_f32 v[228:229], v[228:229], v[168:169], v[200:201] neg_lo:[0,0,1] neg_hi:[0,0,1]
    v_pk_fma_f32 v[230:231], v[230:231], v[170:171], v[202:203] neg_lo:[0,0,1] neg_hi:[0,0,1]
    v_pk_mul_f32 v[204:205], v[232:233], v[172:173]
    v_pk_mul_f32 v[206:207], v[234:235], v[174:175]
    v_pk_mul_f32 v[232:233], v[232:233], v[168:169]
    v_pk_mul_f32 v[234:235], v[234:235], v[170:171]
    v_pk_fma_f32 v[232:233], v[236:237], v[172:173], v[232:233]
    v_pk_fma_f32 v[234:235], v[238:239], v[174:175], v[234:235]
    v_pk_fma_f32 v[236:237], v[236:237], v[168:169], v[204:205] neg_lo:[0,0,1] neg_hi:[0,0,1]
    v_pk_fma_f32 v[238:239], v[238:239], v[170:171], v[206:207] neg_lo:[0,0,1] neg_hi:[0,0,1]
    v_cvt_pk_bf16_f32 v184, v208, v212
    v_cvt_pk_bf16_f32 v185, v209, v213
    v_cvt_pk_bf16_f32 v186, v210, v214
    v_cvt_pk_bf16_f32 v187, v211, v215
    v_cvt_pk_bf16_f32 v188, v216, v220
    v_cvt_pk_bf16_f32 v189, v217, v221
    v_mfma_f32_16x16x32_bf16 v[208:211], v[152:155], v[184:187], 0
    v_cvt_pk_bf16_f32 v190, v218, v222
    v_cvt_pk_bf16_f32 v191, v219, v223
    v_mfma_f32_16x16x32_bf16 v[212:215], v[156:159], v[184:187], 0
    v_cvt_pk_bf16_f32 v192, v224, v228
    v_cvt_pk_bf16_f32 v193, v225, v229
    v_mfma_f32_16x16x32_bf16 v[216:219], v[152:155], v[188:191], 0
    v_cvt_pk_bf16_f32 v194, v226, v230
    v_cvt_pk_bf16_f32 v195, v227, v231
    v_mfma_f32_16x16x32_bf16 v[220:223], v[156:159], v[188:191], 0
    v_cvt_pk_bf16_f32 v196, v232, v236
    v_cvt_pk_bf16_f32 v197, v233, v237
    v_mfma_f32_16x16x32_bf16 v[224:227], v[152:155], v[192:195], 0
    v_cvt_pk_bf16_f32 v198, v234, v238
    v_cvt_pk_bf16_f32 v199, v235, v239
    v_mfma_f32_16x16x32_bf16 v[228:231], v[156:159], v[192:195], 0
    s_nop 0
    s_nop 0
    v_mfma_f32_16x16x32_bf16 v[232:235], v[152:155], v[196:199], 0
    v_mfma_f32_16x16x32_bf16 v[236:239], v[156:159], v[196:199], 0
    v_pk_mul_f32 v[200:201], v[208:209], v[124:125]
    v_pk_mul_f32 v[202:203], v[210:211], v[126:127]
    v_pk_mul_f32 v[208:209], v[208:209], v[120:121]
    v_pk_mul_f32 v[210:211], v[210:211], v[122:123]
    v_pk_fma_f32 v[208:209], v[212:213], v[124:125], v[208:209] neg_lo:[1,0,0] neg_hi:[1,0,0]
    v_pk_fma_f32 v[210:211], v[214:215], v[126:127], v[210:211] neg_lo:[1,0,0] neg_hi:[1,0,0]
    v_pk_fma_f32 v[212:213], v[212:213], v[120:121], v[200:201]
    v_pk_fma_f32 v[214:215], v[214:215], v[122:123], v[202:203]
    v_pk_mul_f32 v[204:205], v[216:217], v[132:133]
    v_pk_mul_f32 v[206:207], v[218:219], v[134:135]
    v_pk_mul_f32 v[216:217], v[216:217], v[128:129]
    v_pk_mul_f32 v[218:219], v[218:219], v[130:131]
    v_pk_fma_f32 v[216:217], v[220:221], v[132:133], v[216:217] neg_lo:[1,0,0] neg_hi:[1,0,0]
    v_pk_fma_f32 v[218:219], v[222:223], v[134:135], v[218:219] neg_lo:[1,0,0] neg_hi:[1,0,0]
    v_pk_fma_f32 v[220:221], v[220:221], v[128:129], v[204:205]
    v_pk_fma_f32 v[222:223], v[222:223], v[130:131], v[206:207]
    v_pk_mul_f32 v[200:201], v[224:225], v[140:141]
    v_pk_mul_f32 v[202:203], v[226:227], v[142:143]
    v_pk_mul_f32 v[224:225], v[224:225], v[136:137]
    v_pk_mul_f32 v[226:227], v[226:227], v[138:139]
    v_pk_fma_f32 v[224:225], v[228:229], v[140:141], v[224:225] neg_lo:[1,0,0] neg_hi:[1,0,0]
    v_pk_fma_f32 v[226:227], v[230:231], v[142:143], v[226:227] neg_lo:[1,0,0] neg_hi:[1,0,0]
    v_pk_fma_f32 v[228:229], v[228:229], v[136:137], v[200:201]
    v_pk_fma_f32 v[230:231], v[230:231], v[138:139], v[202:203]
    v_pk_mul_f32 v[204:205], v[232:233], v[148:149]
    v_pk_mul_f32 v[206:207], v[234:235], v[150:151]
    v_pk_mul_f32 v[232:233], v[232:233], v[144:145]
    v_pk_mul_f32 v[234:235], v[234:235], v[146:147]
    v_pk_fma_f32 v[232:233], v[236:237], v[148:149], v[232:233] neg_lo:[1,0,0] neg_hi:[1,0,0]
    v_pk_fma_f32 v[234:235], v[238:239], v[150:151], v[234:235] neg_lo:[1,0,0] neg_hi:[1,0,0]
    v_pk_fma_f32 v[236:237], v[236:237], v[144:145], v[204:205]
    v_pk_fma_f32 v[238:239], v[238:239], v[146:147], v[206:207]
    v_cvt_pk_bf16_f32 v184, v208, v212
    v_cvt_pk_bf16_f32 v185, v209, v213
    v_cvt_pk_bf16_f32 v186, v210, v214
    v_cvt_pk_bf16_f32 v187, v211, v215
    v_cvt_pk_bf16_f32 v188, v216, v220
    v_cvt_pk_bf16_f32 v189, v217, v221
    v_mfma_f32_16x16x32_bf16 v[208:211], v[184:187], v[160:163], 0
    v_cvt_pk_bf16_f32 v190, v218, v222
    v_cvt_pk_bf16_f32 v191, v219, v223
    v_mfma_f32_16x16x32_bf16 v[212:215], v[184:187], v[164:167], 0
    v_cvt_pk_bf16_f32 v192, v224, v228
    v_cvt_pk_bf16_f32 v193, v225, v229
    v_mfma_f32_16x16x32_bf16 v[216:219], v[188:191], v[160:163], 0
    v_cvt_pk_bf16_f32 v194, v226, v230
    v_cvt_pk_bf16_f32 v195, v227, v231
    v_mfma_f32_16x16x32_bf16 v[220:223], v[188:191], v[164:167], 0
    v_cvt_pk_bf16_f32 v196, v232, v236
    v_cvt_pk_bf16_f32 v197, v233, v237
    v_mfma_f32_16x16x32_bf16 v[224:227], v[192:195], v[160:163], 0
    v_cvt_pk_bf16_f32 v198, v234, v238
    v_cvt_pk_bf16_f32 v199, v235, v239
    v_mfma_f32_16x16x32_bf16 v[228:231], v[192:195], v[164:167], 0
    s_nop 0
    s_nop 0
    v_mfma_f32_16x16x32_bf16 v[232:235], v[196:199], v[160:163], 0
    v_mfma_f32_16x16x32_bf16 v[236:239], v[196:199], v[164:167], 0
    v_pk_mul_f32 v[200:201], v[208:209], v[172:173]
    v_pk_mul_f32 v[202:203], v[210:211], v[174:175]
    v_pk_mul_f32 v[208:209], v[208:209], v[168:169]
    v_pk_mul_f32 v[210:211], v[210:211], v[170:171]
    v_pk_fma_f32 v[208:209], v[212:213], v[172:173], v[208:209] neg_lo:[1,0,0] neg_hi:[1,0,0]
    v_pk_fma_f32 v[210:211], v[214:215], v[174:175], v[210:211] neg_lo:[1,0,0] neg_hi:[1,0,0]
    v_pk_fma_f32 v[212:213], v[212:213], v[168:169], v[200:201]
    v_pk_fma_f32 v[214:215], v[214:215], v[170:171], v[202:203]
    v_pk_mul_f32 v[204:205], v[216:217], v[172:173]
    v_pk_mul_f32 v[206:207], v[218:219], v[174:175]
    v_pk_mul_f32 v[216:217], v[216:217], v[168:169]
    v_pk_mul_f32 v[218:219], v[218:219], v[170:171]
    v_pk_fma_f32 v[216:217], v[220:221], v[172:173], v[216:217] neg_lo:[1,0,0] neg_hi:[1,0,0]
    v_pk_fma_f32 v[218:219], v[222:223], v[174:175], v[218:219] neg_lo:[1,0,0] neg_hi:[1,0,0]
    v_pk_fma_f32 v[220:221], v[220:221], v[168:169], v[204:205]
    v_pk_fma_f32 v[222:223], v[222:223], v[170:171], v[206:207]
    v_pk_mul_f32 v[200:201], v[224:225], v[172:173]
    v_pk_mul_f32 v[202:203], v[226:227], v[174:175]
    v_pk_mul_f32 v[224:225], v[224:225], v[168:169]
    v_pk_mul_f32 v[226:227], v[226:227], v[170:171]
    v_pk_fma_f32 v[224:225], v[228:229], v[172:173], v[224:225] neg_lo:[1,0,0] neg_hi:[1,0,0]
    v_pk_fma_f32 v[226:227], v[230:231], v[174:175], v[226:227] neg_lo:[1,0,0] neg_hi:[1,0,0]
    v_pk_fma_f32 v[228:229], v[228:229], v[168:169], v[200:201]
    v_pk_fma_f32 v[230:231], v[230:231], v[170:171], v[202:203]
    v_pk_mul_f32 v[204:205], v[232:233], v[172:173]
    v_pk_mul_f32 v[206:207], v[234:235], v[174:175]
    v_pk_mul_f32 v[232:233], v[232:233], v[168:169]
    v_pk_mul_f32 v[234:235], v[234:235], v[170:171]
    v_pk_fma_f32 v[232:233], v[236:237], v[172:173], v[232:233] neg_lo:[1,0,0] neg_hi:[1,0,0]
    v_pk_fma_f32 v[234:235], v[238:239], v[174:175], v[234:235] neg_lo:[1,0,0] neg_hi:[1,0,0]
    v_pk_fma_f32 v[236:237], v[236:237], v[168:169], v[204:205]
    v_pk_fma_f32 v[238:239], v[238:239], v[170:171], v[206:207]
    v_cvt_pk_bf16_f32 v184, v208, v212
    v_cvt_pk_bf16_f32 v185, v209, v213
    v_cvt_pk_bf16_f32 v186, v210, v214
    v_cvt_pk_bf16_f32 v187, v211, v215
    v_cvt_pk_bf16_f32 v188, v216, v220
    v_cvt_pk_bf16_f32 v189, v217, v221
    v_mfma_f32_16x16x32_bf16 v[208:211], v[160:163], v[184:187], 0
    v_cvt_pk_bf16_f32 v190, v218, v222
    v_cvt_pk_bf16_f32 v191, v219, v223
    v_mfma_f32_16x16x32_bf16 v[212:215], v[164:167], v[184:187], 0
    v_cvt_pk_bf16_f32 v192, v224, v228
    v_cvt_pk_bf16_f32 v193, v225, v229
    v_mfma_f32_16x16x32_bf16 v[216:219], v[160:163], v[188:191], 0
    v_cvt_pk_bf16_f32 v194, v226, v230
    v_cvt_pk_bf16_f32 v195, v227, v231
    v_mfma_f32_16x16x32_bf16 v[220:223], v[164:167], v[188:191], 0
    v_cvt_pk_bf16_f32 v196, v232, v236
    v_cvt_pk_bf16_f32 v197, v233, v237
    v_mfma_f32_16x16x32_bf16 v[224:227], v[160:163], v[192:195], 0
    v_cvt_pk_bf16_f32 v198, v234, v238
    v_cvt_pk_bf16_f32 v199, v235, v239
    v_mfma_f32_16x16x32_bf16 v[228:231], v[164:167], v[192:195], 0
    v_cvt_pk_bf16_f32 v184, v208, v212
    v_cvt_pk_bf16_f32 v185, v209, v213
    v_mfma_f32_16x16x32_bf16 v[232:235], v[160:163], v[196:199], 0
    v_cvt_pk_bf16_f32 v186, v210, v214
    v_cvt_pk_bf16_f32 v187, v211, v215
    v_mfma_f32_16x16x32_bf16 v[236:239], v[164:167], v[196:199], 0
    v_min_u32 v184, -2, v184
    v_min_u32 v185, -2, v185
    v_min_u32 v186, -2, v186
    v_min_u32 v187, -2, v187
    v_cvt_pk_bf16_f32 v188, v216, v220
    ds_write_b128 v180, v[184:187] offset:32768
    v_cvt_pk_bf16_f32 v189, v217, v221
    v_cvt_pk_bf16_f32 v190, v218, v222
    v_cvt_pk_bf16_f32 v191, v219, v223
    v_min_u32 v188, -2, v188
    v_min_u32 v189, -2, v189
    v_min_u32 v190, -2, v190
    v_min_u32 v191, -2, v191
    v_cvt_pk_bf16_f32 v192, v224, v228
    ds_write_b128 v180, v[188:191] offset:33792
    v_cvt_pk_bf16_f32 v193, v225, v229
    v_cvt_pk_bf16_f32 v194, v226, v230
    v_cvt_pk_bf16_f32 v195, v227, v231
    v_min_u32 v192, -2, v192
    v_min_u32 v193, -2, v193
    v_min_u32 v194, -2, v194
    v_min_u32 v195, -2, v195
    v_cvt_pk_bf16_f32 v196, v232, v236
    ds_write_b128 v180, v[192:195] offset:34816
    v_cvt_pk_bf16_f32 v197, v233, v237
    v_cvt_pk_bf16_f32 v198, v234, v238
    v_cvt_pk_bf16_f32 v199, v235, v239
    v_min_u32 v196, -2, v196
    v_min_u32 v197, -2, v197
    v_min_u32 v198, -2, v198
    v_min_u32 v199, -2, v199
    ds_write_b128 v180, v[196:199] offset:35840
    s_mov_b32 s66, 0
    s_branch L_fwc_37
L_fw_35:
    s_mov_b32 s48, 25198592
    s_lshl_b32 s49, s64, 14
    s_add_u32 s48, s48, s49
    v_lshlrev_b32_e64 v241, 6, v0
    v_min_u32 v241, 12480, v241
    buffer_load_dword v240, v241, s[4:7], s48 offen sc1
L_fwc_37:
    s_waitcnt vmcnt(0)
    v_cmp_ne_u32 vcc, s68, v240
    s_cbranch_vccz L_fwd_36
    s_add_u32 s66, s66, 1
    s_cmp_lt_u32 s66, s67
    s_sleep 2
    s_cbranch_scc1 L_fw_35
    s_mov_b32 s67, 1
L_fwd_36:
    s_waitcnt lgkmcnt(0)
    s_barrier
    ds_read_b32 v120, v182 offset:32768
    ds_read_b32 v121, v182 offset:33792
    ds_read_b32 v122, v182 offset:34816
    ds_read_b32 v123, v182 offset:35840
    ds_read_b32 v124, v182 offset:33280
    ds_read_b32 v125, v182 offset:34304
    ds_read_b32 v126, v182 offset:35328
    ds_read_b32 v127, v182 offset:36352
    ds_read_b32 v128, v183 offset:32768
    ds_read_b32 v129, v183 offset:33792
    ds_read_b32 v130, v183 offset:34816
    ds_read_b32 v131, v183 offset:35840
    ds_read_b32 v132, v183 offset:33280
    ds_read_b32 v133, v183 offset:34304
    ds_read_b32 v134, v183 offset:35328
    ds_read_b32 v135, v183 offset:36352
    s_add_u32 s48, s25, 0
    s_add_u32 s49, s25, 262144
    s_waitcnt lgkmcnt(12)
    buffer_store_dwordx4 v[120:123], v117, s[4:7], s48 offen sc1
    s_add_u32 s48, s25, 4096
    s_waitcnt lgkmcnt(8)
    buffer_store_dwordx4 v[124:127], v117, s[4:7], s49 offen sc1
    s_add_u32 s49, s25, 266240
    s_waitcnt lgkmcnt(4)
    buffer_store_dwordx4 v[128:131], v117, s[4:7], s48 offen sc1
    s_waitcnt lgkmcnt(0)
    buffer_store_dwordx4 v[132:135], v117, s[4:7], s49 offen sc1
L_p2hskip_31:
    s_cmp_lg_u32 s64, 0
    s_cbranch_scc1 L_l0_38
    v_lshlrev_b32 v98, 16, v98
    v_lshlrev_b32_e64 v99, 16, v99
L_l0_38:
    s_mul_i32 s52, s3, 401408
    s_lshl_b32 s48, s72, 4
    s_add_u32 s52, s52, s48
    s_add_u32 s52, s52, s65
    s_add_u32 s52, s52, 6029312
    s_lshl_b32 s53, s3, 4
    s_add_u32 s53, s53, s77
    s_mul_i32 s53, s53, 896
    s_lshl_b32 s48, s72, 1
    s_add_u32 s46, s53, s48
    s_lshl_b32 s88, s3, 14
    s_add_u32 s32, s83, 0
    s_sub_u32 s51, s32, 14
    s_cselect_b32 s32, s32, s51
    s_mul_i32 s32, s32, 28672
    s_add_u32 s32, s32, s52
    s_add_u32 s33, s83, 1
    s_sub_u32 s51, s33, 14
    s_cselect_b32 s33, s33, s51
    s_mul_i32 s33, s33, 28672
    s_add_u32 s33, s33, s52
    s_add_u32 s34, s83, 2
    s_sub_u32 s51, s34, 14
    s_cselect_b32 s34, s34, s51
    s_mul_i32 s34, s34, 28672
    s_add_u32 s34, s34, s52
    s_add_u32 s35, s83, 3
    s_sub_u32 s51, s35, 14
    s_cselect_b32 s35, s35, s51
    s_mul_i32 s35, s35, 28672
    s_add_u32 s35, s35, s52
    s_add_u32 s36, s83, 4
    s_sub_u32 s51, s36, 14
    s_cselect_b32 s36, s36, s51
    s_mul_i32 s36, s36, 28672
    s_add_u32 s36, s36, s52
    s_add_u32 s37, s83, 5
    s_sub_u32 s51, s37, 14
    s_cselect_b32 s37, s37, s51
    s_mul_i32 s37, s37, 28672
    s_add_u32 s37, s37, s52
    s_add_u32 s38, s83, 6
    s_sub_u32 s51, s38, 14
    s_cselect_b32 s38, s38, s51
    s_lshl_b32 s60, s38, 17
    s_add_u32 s60, s60, s90
    s_mul_i32 s38, s38, 28672
    s_add_u32 s38, s38, s52
    s_add_u32 s39, s83, 7
    s_sub_u32 s51, s39, 14
    s_cselect_b32 s39, s39, s51
    s_lshl_b32 s61, s39, 17
    s_add_u32 s61, s61, s90
    s_mul_i32 s39, s39, 28672
    s_add_u32 s39, s39, s52
    s_add_u32 s40, s83, 8
    s_sub_u32 s51, s40, 14
    s_cselect_b32 s40, s40, s51
    s_lshl_b32 s62, s40, 17
    s_add_u32 s62, s62, s90
    s_mul_i32 s40, s40, 28672
    s_add_u32 s40, s40, s52
    s_add_u32 s41, s83, 9
    s_sub_u32 s51, s41, 14
    s_cselect_b32 s41, s41, s51
    s_lshl_b32 s63, s41, 17
    s_add_u32 s63, s63, s90
    s_mul_i32 s41, s41, 28672
    s_add_u32 s41, s41, s52
    s_add_u32 s42, s83, 10
    s_sub_u32 s51, s42, 14
    s_cselect_b32 s42, s42, s51
    s_lshl_b32 s28, s42, 17
    s_add_u32 s28, s28, s90
    s_mul_i32 s42, s42, 28672
    s_add_u32 s42, s42, s52
    s_add_u32 s43, s83, 11
    s_sub_u32 s51, s43, 14
    s_cselect_b32 s43, s43, s51
    s_lshl_b32 s29, s43, 17
    s_add_u32 s29, s29, s90
    s_mul_i32 s43, s43, 28672
    s_add_u32 s43, s43, s52
    s_add_u32 s44, s83, 12
    s_sub_u32 s51, s44, 14
    s_cselect_b32 s44, s44, s51
    s_lshl_b32 s30, s44, 17
    s_add_u32 s30, s30, s90
    s_mul_i32 s44, s44, 28672
    s_add_u32 s44, s44, s52
    s_add_u32 s45, s83, 13
    s_sub_u32 s51, s45, 14
    s_cselect_b32 s45, s45, s51
    s_lshl_b32 s31, s45, 17
    s_add_u32 s31, s31, s90
    s_mul_i32 s45, s45, 28672
    s_add_u32 s45, s45, s52
    s_mul_i32 s51, s3, 458752
    s_lshl_b32 s48, s76, 4
    s_add_u32 s51, s51, s48
    s_add_u32 s51, s51, s65
    s_add_u32 s51, s51, 4194304
    s_lshl_b32 s48, s3, 1
    s_lshr_b32 s52, s75, 3
    s_add_u32 s52, s52, s48
    s_mul_i32 s52, s52, 448
    s_add_u32 s52, s52, s76
    s_lshl_b32 s52, s52, 4
    s_add_u32 s52, s52, s65
    s_add_u32 s89, s52, 6029312
    s_add_u32 s24, s82, 0
    s_and_b32 s24, s24, 7
    s_mul_i32 s24, s24, 57344
    s_add_u32 s24, s24, s51
    s_add_u32 s25, s82, 1
    s_and_b32 s25, s25, 7
    s_mul_i32 s25, s25, 57344
    s_add_u32 s25, s25, s51
    s_add_u32 s26, s82, 2
    s_and_b32 s26, s26, 7
    s_mul_i32 s26, s26, 57344
    s_add_u32 s26, s26, s51
    s_add_u32 s27, s82, 3
    s_and_b32 s27, s27, 7
    s_mul_i32 s27, s27, 57344
    s_add_u32 s27, s27, s51
    s_add_u32 s56, s82, 4
    s_and_b32 s56, s56, 7
    s_mul_i32 s56, s56, 57344
    s_add_u32 s56, s56, s51
    s_add_u32 s57, s82, 5
    s_and_b32 s57, s57, 7
    s_mul_i32 s57, s57, 57344
    s_add_u32 s57, s57, s51
    s_add_u32 s58, s82, 6
    s_and_b32 s58, s58, 7
    s_mul_i32 s58, s58, 57344
    s_add_u32 s58, s58, s51
    s_add_u32 s59, s82, 7
    s_and_b32 s59, s59, 7
    s_mul_i32 s59, s59, 57344
    s_add_u32 s59, s59, s51
    v_lshlrev_b32 v142, 16, v100
    v_and_b32 v143, 0xffff0000, v100
    v_lshlrev_b32_e64 v144, 16, v101
    v_and_b32 v145, 0xffff0000, v101
    v_lshlrev_b32_e64 v146, 16, v102
    v_and_b32 v147, 0xffff0000, v102
    v_lshlrev_b32_e64 v148, 16, v103
    v_and_b32 v149, 0xffff0000, v103
    v_lshlrev_b32_e64 v150, 16, v104
    v_and_b32 v151, 0xffff0000, v104
    v_lshlrev_b32_e64 v152, 16, v105
    v_and_b32 v153, 0xffff0000, v105
    v_lshlrev_b32_e64 v154, 16, v106
    v_and_b32 v155, 0xffff0000, v106
    v_lshlrev_b32_e64 v156, 16, v107
    v_and_b32 v157, 0xffff0000, v107
    v_pk_add_f32 v[142:143], v[142:143], s[94:95] op_sel_hi:[1,0] neg_lo:[0,1] neg_hi:[0,1]
    v_pk_add_f32 v[150:151], v[150:151], s[94:95] op_sel:[0,1] op_sel_hi:[1,1] neg_lo:[0,1] neg_hi:[0,1]
    v_pk_add_f32 v[144:145], v[144:145], s[94:95] op_sel_hi:[1,0] neg_lo:[0,1] neg_hi:[0,1]
    v_pk_add_f32 v[152:153], v[152:153], s[94:95] op_sel:[0,1] op_sel_hi:[1,1] neg_lo:[0,1] neg_hi:[0,1]
    v_pk_add_f32 v[146:147], v[146:147], s[94:95] op_sel_hi:[1,0] neg_lo:[0,1] neg_hi:[0,1]
    v_pk_add_f32 v[154:155], v[154:155], s[94:95] op_sel:[0,1] op_sel_hi:[1,1] neg_lo:[0,1] neg_hi:[0,1]
    v_pk_add_f32 v[148:149], v[148:149], s[94:95] op_sel_hi:[1,0] neg_lo:[0,1] neg_hi:[0,1]
    v_pk_add_f32 v[156:157], v[156:157], s[94:95] op_sel:[0,1] op_sel_hi:[1,1] neg_lo:[0,1] neg_hi:[0,1]
    v_mov_b32 v128, v42
    v_mov_b32 v129, v95
    s_cmp_eq_u32 s64, 0
    s_cbranch_scc1 L_p3ea_39
    v_bfe_u32 v134, v1, 2, 2
    v_and_b32 v135, 3, v1
    v_lshlrev_b32 v135, 4, v135
    v_lshl_add_u32 v134, v134, 7, v135
    s_lshl_b32 s48, s3, 10
    v_add_u32 v128, s48, v134
    v_add_u32 v129, 512, v128
    v_min_u32 v129, 3584, v129
    v_lshrrev_b32 v134, 4, v1
    v_lshlrev_b32 v134, 19, v134
    s_lshr_b32 s48, s2, 4
    s_lshl_b32 s48, s48, 3
    s_and_b32 s49, s2, 7
    s_add_u32 s48, s48, s49
    s_lshl_b32 s48, s48, 12
    s_bfe_u32 s49, s2, 0x10003
    s_lshl_b32 s49, s49, 6
    s_add_u32 s48, s48, s49
    v_add3_u32 v128, v128, v134, s48
    v_add3_u32 v129, v129, v134, s48
L_p3ea_39:
    s_add_u32 s52, s65, 2097152
    s_waitcnt vmcnt(0)
    s_lshr_b32 s48, s73, 1
    s_cmp_eq_u32 s64, 0
    s_cselect_b32 s48, s70, s48
    s_cmp_lg_u32 s48, 0
    s_cbranch_scc1 L_p3a_40
    s_sleep 6
    s_branch L_p3b_41
L_p3a_40:
    s_mov_b32 s66, 0
L_fw_42:
    s_mov_b32 s48, 25198592
    s_lshl_b32 s49, s64, 14
    s_add_u32 s48, s48, s49
    v_lshlrev_b32_e64 v135, 6, v0
    v_min_u32 v135, 12480, v135
    buffer_load_dword v134, v135, s[4:7], s48 offen sc1
L_fwc_44:
    s_waitcnt vmcnt(0)
    v_cmp_ne_u32 vcc, s68, v134
    s_cbranch_vccz L_fwd_43
    s_add_u32 s66, s66, 1
    s_cmp_lt_u32 s66, s67
    s_sleep 4
    s_cbranch_scc1 L_fw_42
    s_mov_b32 s67, 1
L_fwd_43:
    s_barrier
    s_cmp_eq_u32 s64, 0
    s_cbranch_scc1 L_p3l0_45
    s_sleep 64
    s_branch L_p3b_41
L_p3l0_45:
L_p3b_41:
    s_mov_b32 s66, 0
L_p3poll_46:
    buffer_load_dwordx4 v[120:123], v128, s[4:7], s52 offen sc1
    buffer_load_dwordx4 v[124:127], v129, s[4:7], s52 offen sc1
    s_waitcnt vmcnt(0)
    v_max3_u32 v134, v120, v121, v122
    v_max3_u32 v134, v134, v123, v124
    v_max3_u32 v134, v134, v125, v126
    v_max_u32 v134, v134, v127
    v_cmp_eq_u32 vcc, -1, v134
    s_cbranch_vccz L_p3polld_47
    s_add_u32 s66, s66, 1
    s_cmp_lt_u32 s66, s67
    s_sleep 4
    s_cbranch_scc1 L_p3poll_46
    s_mov_b32 s67, 1
L_p3polld_47:
    v_mfma_f32_16x16x16_bf16 v[160:163], v[96:97], v[120:121], 0
    v_mfma_f32_16x16x16_bf16 v[164:167], v[96:97], v[122:123], 0
    v_mfma_f32_16x16x16_bf16 v[168:171], v[96:97], v[124:125], 0
    s_nop 5
    v_cvt_pk_bf16_f32 v120, v160, v161
    v_mfma_f32_16x16x16_bf16 v[172:175], v[96:97], v[126:127], 0
    v_cvt_pk_bf16_f32 v121, v162, v163
    v_cvt_pk_bf16_f32 v122, v164, v165
    v_cvt_pk_bf16_f32 v123, v166, v167
    v_cvt_pk_bf16_f32 v124, v168, v169
    v_cvt_pk_bf16_f32 v125, v170, v171
    s_nop 2
    s_nop 0
    v_cvt_pk_bf16_f32 v126, v172, v173
    v_cvt_pk_bf16_f32 v127, v174, v175
    ds_write_b128 v41, v[120:123]
    ds_write_b128 v41, v[124:127] offset:256
    s_waitcnt lgkmcnt(0)
    s_barrier
    ds_read2_b32 v[120:121], v86 offset0:0 offset1:28
    ds_read2_b32 v[122:123], v86 offset0:56 offset1:84
    ds_read2_b32 v[124:125], v86 offset0:1 offset1:29
    ds_read2_b32 v[126:127], v86 offset0:57 offset1:85
    s_mul_i32 s54, s2, 7168
    s_add_u32 s54, s54, s65
    s_add_u32 s54, s54, 4194304
    s_add_u32 s55, s54, 4096
    s_lshl_b32 s52, s3, 11
    s_add_u32 s52, s52, 32768
    s_add_u32 s53, s65, 8388608
    s_waitcnt lgkmcnt(3)
    v_and_b32 v121, v88, v121
    v_and_b32 v120, v87, v120
    s_waitcnt lgkmcnt(1)
    v_and_b32 v124, v87, v124
    v_and_b32 v123, v88, v123
    v_and_b32 v122, v88, v122
    s_waitcnt lgkmcnt(0)
    v_and_b32 v127, v88, v127
    v_and_b32 v126, v88, v126
    v_mfma_f32_16x16x32_bf16 v[164:167], v[120:123], v[52:55], 0
    v_and_b32_e64 v125, v88, v125
    v_mfma_f32_16x16x32_bf16 v[160:163], v[120:123], v[48:51], 0
    s_nop 0
    s_nop 0
    v_mfma_f32_16x16x32_bf16 v[176:179], v[124:127], v[48:51], 0
    v_mfma_f32_16x16x32_bf16 v[180:183], v[124:127], v[52:55], 0
    v_mfma_f32_16x16x32_bf16 v[168:171], v[120:123], v[56:59], 0
    v_mfma_f32_16x16x32_bf16 v[184:187], v[124:127], v[56:59], 0
    v_mfma_f32_16x16x32_bf16 v[172:175], v[120:123], v[60:63], 0
    v_mfma_f32_16x16x32_bf16 v[188:191], v[124:127], v[60:63], 0
    s_nop 2
    s_nop 0
    v_pk_mul_f32 v[138:139], v[176:177], v[72:73]
    v_pk_mul_f32 v[134:135], v[160:161], v[72:73]
    v_pk_mul_f32 v[160:161], v[160:161], v[64:65]
    v_pk_mul_f32 v[136:137], v[162:163], v[74:75]
    v_pk_mul_f32 v[162:163], v[162:163], v[66:67]
    v_pk_fma_f32 v[160:161], v[164:165], v[72:73], v[160:161] neg_lo:[1,0,0] neg_hi:[1,0,0]
    v_pk_mul_f32 v[176:177], v[176:177], v[64:65]
    v_pk_fma_f32 v[162:163], v[166:167], v[74:75], v[162:163] neg_lo:[1,0,0] neg_hi:[1,0,0]
    v_pk_fma_f32 v[176:177], v[180:181], v[72:73], v[176:177] neg_lo:[1,0,0] neg_hi:[1,0,0]
    v_pk_mul_f32 v[140:141], v[178:179], v[74:75]
    v_pk_mul_f32 v[178:179], v[178:179], v[66:67]
    v_pk_fma_f32 v[180:181], v[180:181], v[64:65], v[138:139]
    v_pk_fma_f32 v[178:179], v[182:183], v[74:75], v[178:179] neg_lo:[1,0,0] neg_hi:[1,0,0]
    v_pk_fma_f32 v[182:183], v[182:183], v[66:67], v[140:141]
    v_pk_mul_f32 v[140:141], v[186:187], v[78:79]
    v_pk_mul_f32 v[138:139], v[184:185], v[76:77]
    v_pk_fma_f32 v[166:167], v[166:167], v[66:67], v[136:137]
    v_pk_fma_f32 v[164:165], v[164:165], v[64:65], v[134:135]
    v_pk_mul_f32 v[136:137], v[170:171], v[78:79]
    v_pk_mul_f32 v[170:171], v[170:171], v[70:71]
    v_pk_mul_f32 v[184:185], v[184:185], v[68:69]
    v_pk_fma_f32 v[170:171], v[174:175], v[78:79], v[170:171] neg_lo:[1,0,0] neg_hi:[1,0,0]
    v_pk_fma_f32 v[174:175], v[174:175], v[70:71], v[136:137]
    v_pk_fma_f32 v[184:185], v[188:189], v[76:77], v[184:185] neg_lo:[1,0,0] neg_hi:[1,0,0]
    v_pk_fma_f32 v[188:189], v[188:189], v[68:69], v[138:139]
    v_pk_mul_f32 v[134:135], v[168:169], v[76:77]
    v_pk_mul_f32 v[168:169], v[168:169], v[68:69]
    v_pk_mul_f32 v[186:187], v[186:187], v[70:71]
    v_pk_fma_f32 v[168:169], v[172:173], v[76:77], v[168:169] neg_lo:[1,0,0] neg_hi:[1,0,0]
    v_pk_fma_f32 v[172:173], v[172:173], v[68:69], v[134:135]
    v_pk_fma_f32 v[186:187], v[190:191], v[78:79], v[186:187] neg_lo:[1,0,0] neg_hi:[1,0,0]
    v_pk_fma_f32 v[190:191], v[190:191], v[70:71], v[140:141]
    v_cvt_pk_bf16_f32 v193, v161, v165
    v_cvt_pk_bf16_f32 v203, v179, v183
    v_cvt_pk_bf16_f32 v192, v160, v164
    v_cvt_pk_bf16_f32 v194, v162, v166
    v_cvt_pk_bf16_f32 v201, v177, v181
    v_cvt_pk_bf16_f32 v197, v169, v173
    v_cvt_pk_bf16_f32 v202, v178, v182
    v_cvt_pk_bf16_f32 v196, v168, v172
    v_cvt_pk_bf16_f32 v200, v176, v180
    v_cvt_pk_bf16_f32 v195, v163, v167
    v_cvt_pk_bf16_f32 v199, v171, v175
    v_mfma_f32_16x16x32_bf16 v[216:219], v[80:83], v[200:203], v[150:153]
    v_cvt_pk_bf16_f32 v206, v186, v190
    v_cvt_pk_bf16_f32 v207, v187, v191
    v_mfma_f32_16x16x32_bf16 v[208:211], v[80:83], v[192:195], v[142:145]
    v_cvt_pk_bf16_f32 v198, v170, v174
    v_cvt_pk_bf16_f32 v205, v185, v189
    v_cvt_pk_bf16_f32 v204, v184, v188
    v_mfma_f32_16x16x32_bf16 v[212:215], v[80:83], v[196:199], v[146:149]
    v_lshlrev_b32 v135, 4, v0
    v_add_u32 v136, s52, v38
    v_mfma_f32_16x16x32_bf16 v[220:223], v[80:83], v[204:207], v[154:157]
    s_add_u32 s52, s53, s85
    s_add_u32 s53, s53, s86
    v_pk_mul_f32 v[228:229], v[208:209], v[208:209]
    v_pk_add_f32 v[224:225], v[208:209], v[210:211]
    v_pk_fma_f32 v[228:229], v[210:211], v[210:211], v[228:229]
    v_pk_mul_f32 v[230:231], v[216:217], v[216:217]
    v_pk_add_f32 v[224:225], v[224:225], v[212:213]
    v_pk_fma_f32 v[228:229], v[212:213], v[212:213], v[228:229]
    v_pk_fma_f32 v[230:231], v[218:219], v[218:219], v[230:231]
    v_pk_fma_f32 v[228:229], v[214:215], v[214:215], v[228:229]
    v_pk_fma_f32 v[230:231], v[220:221], v[220:221], v[230:231]
    v_pk_add_f32 v[226:227], v[216:217], v[218:219]
    v_pk_fma_f32 v[230:231], v[222:223], v[222:223], v[230:231]
    v_pk_add_f32 v[226:227], v[226:227], v[220:221]
    v_pk_add_f32 v[224:225], v[224:225], v[214:215]
    v_pk_add_f32 v[226:227], v[226:227], v[222:223]
    v_add_f32 v230, v230, v231
    v_add_f32 v226, v226, v227
    v_add_f32 v224, v224, v225
    v_add_f32 v228, v228, v229
    v_pk_add_f32 v[160:161], v[208:209], s[94:95] op_sel_hi:[1,0]
    v_permlane32_swap_b32 v224, v226
    v_permlane32_swap_b32 v228, v230
    v_add_f32 v224, v224, v226
    v_add_f32 v228, v228, v230
    v_pk_add_f32 v[176:177], v[216:217], s[94:95] op_sel:[0,1] op_sel_hi:[1,1]
    v_pk_add_f32 v[162:163], v[210:211], s[94:95] op_sel_hi:[1,0]
    v_permlane16_swap_b32 v224, v228
    v_add_f32 v224, v224, v228
    v_pk_add_f32 v[178:179], v[218:219], s[94:95] op_sel:[0,1] op_sel_hi:[1,1]
    v_pk_add_f32 v[164:165], v[212:213], s[94:95] op_sel_hi:[1,0]
    v_add_f32_dpp v224, v224, v224 row_ror:8 row_mask:0xf bank_mask:0xf
    v_pk_add_f32 v[180:181], v[220:221], s[94:95] op_sel:[0,1] op_sel_hi:[1,1]
    v_pk_add_f32 v[166:167], v[214:215], s[94:95] op_sel_hi:[1,0]
    v_add_f32_dpp v224, v224, v224 row_ror:4 row_mask:0xf bank_mask:0xf
    v_pk_add_f32 v[182:183], v[222:223], s[94:95] op_sel:[0,1] op_sel_hi:[1,1]
    v_cvt_pk_bf16_f32 v232, v160, v176
    v_add_f32_dpp v224, v224, v224 row_ror:2 row_mask:0xf bank_mask:0xf
    ds_write_b16 v94, v232 offset:0
    ds_write_b16_d16_hi v94, v232 offset:1024
    v_add_f32_dpp v224, v224, v224 row_ror:1 row_mask:0xf bank_mask:0xf
    v_cvt_pk_bf16_f32 v233, v161, v177
    v_readlane_b32 s48, v224, 0
    v_readlane_b32 s49, v224, 32
    v_readlane_b32 s51, v224, 48
    v_readlane_b32 s50, v224, 16
    v_pk_mul_f32 v[224:225], s[48:49], v[36:37] op_sel_hi:[1,0]
    ds_write_b16 v94, v233 offset:64
    v_pk_mul_f32 v[226:227], s[50:51], v[36:37] op_sel_hi:[1,0]
    v_pk_fma_f32 v[226:227], v[224:225], v[224:225], v[226:227] neg_lo:[1,0,0] neg_hi:[1,0,0]
    v_pk_fma_f32 v[226:227], v[226:227], v[46:47], v[46:47] op_sel:[0,0,1] op_sel_hi:[1,0,1]
    v_max_f32 v227, v47, v227
    v_max_f32 v226, v47, v226
    v_rsq_f32 v229, v227
    v_rsq_f32 v228, v226
    ds_write_b16_d16_hi v94, v233 offset:1088
    v_pk_mul_f32 v[230:231], v[224:225], v[228:229] neg_lo:[1,0] neg_hi:[1,0]
    v_pk_fma_f32 v[150:151], v[216:217], v[228:229], v[230:231] op_sel:[0,1,1] op_sel_hi:[1,1,1]
    v_pk_fma_f32 v[144:145], v[210:211], v[228:229], v[230:231] op_sel_hi:[1,0,0]
    v_pk_fma_f32 v[152:153], v[218:219], v[228:229], v[230:231] op_sel:[0,1,1] op_sel_hi:[1,1,1]
    v_pk_fma_f32 v[146:147], v[212:213], v[228:229], v[230:231] op_sel_hi:[1,0,0]
    v_pk_fma_f32 v[142:143], v[208:209], v[228:229], v[230:231] op_sel_hi:[1,0,0]
    v_pk_fma_f32 v[148:149], v[214:215], v[228:229], v[230:231] op_sel_hi:[1,0,0]
    v_pk_fma_f32 v[154:155], v[220:221], v[228:229], v[230:231] op_sel:[0,1,1] op_sel_hi:[1,1,1]
    v_pk_fma_f32 v[156:157], v[222:223], v[228:229], v[230:231] op_sel:[0,1,1] op_sel_hi:[1,1,1]
    v_cvt_pk_bf16_f32 v193, v143, v151
    v_cvt_pk_bf16_f32 v195, v145, v153
    v_cvt_pk_bf16_f32 v194, v144, v152
    v_cvt_pk_bf16_f32 v196, v146, v154
    v_min_u32 v195, -2, v195
    v_min_u32 v194, -2, v194
    v_cvt_pk_bf16_f32 v192, v142, v150
    v_min_u32 v193, -2, v193
    v_min_u32 v192, -2, v192
    v_cvt_pk_bf16_f32 v198, v148, v156
    ds_write_b32 v93, v192 offset:0
    ds_write_b32 v93, v193 offset:512
    ds_write_b32 v93, v194 offset:1024
    v_min_u32_e64 v198, -2, v198
    v_cvt_pk_bf16_f32 v197, v147, v155
    ds_write_b32 v93, v195 offset:1536
    v_min_u32 v197, -2, v197
    v_min_u32 v196, -2, v196
    v_cvt_pk_bf16_f32 v199, v149, v157
    ds_write_b32 v93, v196 offset:256
    v_min_u32_e64 v199, -2, v199
    ds_write_b32 v93, v197 offset:768
    ds_write_b32 v93, v198 offset:1280
    ds_write_b32 v93, v199 offset:1792
    s_waitcnt lgkmcnt(0)
    s_barrier
    ds_read_b128 v[120:123], v135 offset:20480
    ds_read_b128 v[124:127], v135 offset:24576
    s_cmp_eq_u32 s3, 3
    s_waitcnt lgkmcnt(1)
    buffer_store_dwordx4 v[120:123], v135, s[4:7], s54 offen sc1
    s_waitcnt lgkmcnt(0)
    s_cbranch_scc1 L_ht3_48
    buffer_store_dwordx4 v[124:127], v135, s[4:7], s55 offen sc1
L_ht3_48:
    v_cvt_pk_bf16_f32 v234, v162, v178
    ds_write_b16 v94, v234 offset:128
    ds_write_b16_d16_hi v94, v234 offset:1152
    v_cvt_pk_bf16_f32 v235, v163, v179
    ds_write_b16 v94, v235 offset:192
    ds_write_b16_d16_hi v94, v235 offset:1216
    v_cvt_pk_bf16_f32 v236, v164, v180
    ds_write_b16 v94, v236 offset:32
    ds_write_b16_d16_hi v94, v236 offset:1056
    v_cvt_pk_bf16_f32 v237, v165, v181
    ds_write_b16 v94, v237 offset:96
    ds_write_b16_d16_hi v94, v237 offset:1120
    v_cvt_pk_bf16_f32 v238, v166, v182
    ds_write_b16 v94, v238 offset:160
    ds_write_b16_d16_hi v94, v238 offset:1184
    v_cvt_pk_bf16_f32 v239, v167, v183
    ds_write_b16 v94, v239 offset:224
    ds_write_b16_d16_hi v94, v239 offset:1248
    ds_read_b128 v[142:145], v136
    ds_read_b128 v[146:149], v136 offset:1024
    s_waitcnt lgkmcnt(0)
    buffer_store_dwordx4 v[142:145], v38, s[4:7], s52 offen sc1
    buffer_store_dwordx4 v[146:149], v38, s[4:7], s53 offen sc1
    s_cmp_lg_u32 s64, 0
    s_cbranch_scc1 L_l0_49
    s_or_b32 s48, s2, s3
    s_cmp_lg_u32 s48, 0
    s_cbranch_scc1 L_l0_49
    s_add_u32 s48, s69, 1
    v_mov_b32 v118, s48
    v_mov_b32_e64 v119, 0
    s_mov_b32 s48, 25165824
    s_mov_b64 exec, 1
    buffer_store_dword v118, v119, s[4:7], s48 offen sc1
    s_mov_b64 exec, -1
L_l0_49:
    v_lshrrev_b32_e64 v117, 3, v1
    v_lshl_add_u32 v117, v117, 12, v92
    v_add_u32 v100, 14336, v89
    v_add_u32 v101, 28672, v89
    v_add_u32 v102, 43008, v89
    s_cmp_eq_u32 s70, 0
    s_cbranch_scc1 L_g1obs_50
    v_and_b32 v104, 15, v1
    v_lshrrev_b32 v105, 5, v1
    v_lshlrev_b32 v105, 3, v105
    v_xor_b32 v104, v104, v105
    v_lshlrev_b32 v104, 4, v104
    v_and_b32 v105, 31, v1
    v_lshl_add_u32 v104, v105, 8, v104
    s_lshl_b32 s48, s3, 14
    v_add_u32 v103, s48, v104
    v_and_b32 v106, 15, v1
    v_lshrrev_b32 v107, 5, v1
    s_lshl_b32 s48, s3, 1
    v_or_b32 v107, s48, v107
    v_xor_b32 v106, v107, v106
    v_lshlrev_b32 v106, 4, v106
    v_and_b32_e64 v107, 31, v1
    v_lshl_add_u32 v106, v107, 8, v106
    v_xor_b32 v107, 128, v106
    s_waitcnt vmcnt(0)
    s_barrier
    s_cmp_lg_u32 s3, 0
    s_cbranch_scc1 L_tok_52
    s_lshl_b32 s48, s2, 6
    s_lshl_b32 s49, s64, 14
    s_add_u32 s48, s48, s49
    s_add_u32 s48, s48, 25280512
    v_mov_b32 v104, s68
    v_mov_b32 v105, 0
    s_mov_b64 exec, 1
    buffer_store_dword v104, v105, s[4:7], s48 offen sc1
    s_mov_b64 exec, -1
L_tok_52:
    s_and_b32 s48, s2, 3
    s_mul_i32 s49, s64, 3
    s_or_b32 s48, s48, s49
L_bk_53:
    s_cmp_eq_u32 s48, 3
    s_cbranch_scc1 L_bk2_54
    s_sleep 4
    s_add_u32 s48, s48, 1
    s_branch L_bk_53
L_bk2_54:
    s_cmp_lg_u32 s64, 0
    s_cbranch_scc1 L_g1l1_55
    s_mul_i32 s52, s3, 24576
    s_add_u32 s52, s52, 65536
    s_lshl_b32 s54, s83, 2
    s_add_u32 s54, s54, 8
    s_sub_u32 s53, s54, 56
    s_cselect_b32 s54, s54, s53
    s_mov_b32 s66, 0
    buffer_load_dwordx4 v[184:187], v89, s[4:7], s24 offen offset:0 sc1
    buffer_load_dwordx4 v[188:191], v100, s[4:7], s24 offen offset:0 sc1
    buffer_load_dwordx4 v[192:195], v101, s[4:7], s24 offen offset:0 sc1
    buffer_load_dwordx4 v[196:199], v102, s[4:7], s24 offen offset:0 sc1
    s_barrier
    s_nop 0
    buffer_load_dwordx4 v[200:203], v89, s[4:7], s25 offen offset:0 sc1
    buffer_load_dwordx4 v[204:207], v100, s[4:7], s25 offen offset:0 sc1
    buffer_load_dwordx4 v[208:211], v101, s[4:7], s25 offen offset:0 sc1
    buffer_load_dwordx4 v[212:215], v102, s[4:7], s25 offen offset:0 sc1
    s_barrier
    s_nop 0
    buffer_load_dwordx4 v[216:219], v89, s[4:7], s26 offen offset:0 sc1
    buffer_load_dwordx4 v[220:223], v100, s[4:7], s26 offen offset:0 sc1
    buffer_load_dwordx4 v[224:227], v101, s[4:7], s26 offen offset:0 sc1
    buffer_load_dwordx4 v[228:231], v102, s[4:7], s26 offen offset:0 sc1
    buffer_load_dwordx4 v[232:235], v89, s[4:7], s27 offen offset:0 sc1
    buffer_load_dwordx4 v[236:239], v100, s[4:7], s27 offen offset:0 sc1
    buffer_load_dwordx4 v[240:243], v101, s[4:7], s27 offen offset:0 sc1
    buffer_load_dwordx4 v[244:247], v102, s[4:7], s27 offen offset:0 sc1
    s_waitcnt vmcnt(12)
    s_nop 0
    v_max3_u32 v248, v184, v185, v186
    v_max3_u32 v248, v248, v187, v188
    v_max3_u32 v248, v248, v189, v190
    v_max3_u32 v248, v248, v191, v192
    v_max3_u32 v248, v248, v193, v194
    v_max3_u32 v248, v248, v195, v196
    v_max3_u32 v248, v248, v197, v198
    v_max_u32 v248, v248, v199
    v_cmp_eq_u32 vcc, -1, v248
    s_cbranch_vccnz L_g1slow_57
L_g1back_58:
    s_nop 0
    v_mfma_f32_32x32x16_bf16 v[120:135], a[0:3], v[184:187], 0
    v_mfma_f32_32x32x16_bf16 v[152:167], a[4:7], v[184:187], 0
    buffer_load_dwordx4 v[184:187], v89, s[4:7], s56 offen offset:0 sc1
    v_mfma_f32_32x32x16_bf16 v[120:135], a[8:11], v[188:191], v[120:135]
    v_mfma_f32_32x32x16_bf16 v[152:167], a[12:15], v[188:191], v[152:167]
    buffer_load_dwordx4 v[188:191], v100, s[4:7], s56 offen offset:0 sc1
    v_mfma_f32_32x32x16_bf16 v[120:135], a[16:19], v[192:195], v[120:135]
    v_mfma_f32_32x32x16_bf16 v[152:167], a[20:23], v[192:195], v[152:167]
    s_waitcnt vmcnt(10)
    s_nop 0
    v_max3_u32 v248, v200, v201, v202
    v_max3_u32 v248, v248, v203, v204
    v_max3_u32 v248, v248, v205, v206
    v_max3_u32 v248, v248, v207, v208
    v_mfma_f32_32x32x16_bf16 v[120:135], a[24:27], v[196:199], v[120:135]
    v_max3_u32 v248, v248, v209, v210
    v_max3_u32 v248, v248, v211, v212
    v_max3_u32 v248, v248, v213, v214
    v_max_u32 v248, v248, v215
    v_cmp_eq_u32 vcc, -1, v248
    v_mfma_f32_32x32x16_bf16 v[152:167], a[28:31], v[196:199], v[152:167]
    buffer_load_dwordx4 v[192:195], v101, s[4:7], s56 offen offset:0 sc1
    s_cbranch_vccnz L_g1slow_59
L_g1back_60:
    s_nop 0
    v_mfma_f32_32x32x16_bf16 v[120:135], a[32:35], v[200:203], v[120:135]
    buffer_load_dwordx4 v[196:199], v102, s[4:7], s56 offen offset:0 sc1
    v_mfma_f32_32x32x16_bf16 v[152:167], a[36:39], v[200:203], v[152:167]
    buffer_load_dwordx4 v[200:203], v89, s[4:7], s57 offen offset:0 sc1
    v_mfma_f32_32x32x16_bf16 v[120:135], a[40:43], v[204:207], v[120:135]
    v_mfma_f32_32x32x16_bf16 v[152:167], a[44:47], v[204:207], v[152:167]
    buffer_load_dwordx4 v[204:207], v100, s[4:7], s57 offen offset:0 sc1
    v_mfma_f32_32x32x16_bf16 v[120:135], a[48:51], v[208:211], v[120:135]
    v_mfma_f32_32x32x16_bf16 v[152:167], a[52:55], v[208:211], v[152:167]
    s_waitcnt vmcnt(10)
    s_nop 0
    v_max3_u32 v248, v216, v217, v218
    v_max3_u32 v248, v248, v219, v220
    v_max3_u32 v248, v248, v221, v222
    v_max3_u32 v248, v248, v223, v224
    v_mfma_f32_32x32x16_bf16 v[120:135], a[56:59], v[212:215], v[120:135]
    v_max3_u32 v248, v248, v225, v226
    v_max3_u32 v248, v248, v227, v228
    v_max3_u32 v248, v248, v229, v230
    v_max_u32 v248, v248, v231
    v_cmp_eq_u32 vcc, -1, v248
    v_mfma_f32_32x32x16_bf16 v[152:167], a[60:63], v[212:215], v[152:167]
    buffer_load_dwordx4 v[208:211], v101, s[4:7], s57 offen offset:0 sc1
    s_cbranch_vccnz L_g1slow_61
L_g1back_62:
    s_nop 0
    v_mfma_f32_32x32x16_bf16 v[120:135], a[64:67], v[216:219], v[120:135]
    buffer_load_dwordx4 v[212:215], v102, s[4:7], s57 offen offset:0 sc1
    v_mfma_f32_32x32x16_bf16 v[152:167], a[68:71], v[216:219], v[152:167]
    buffer_load_dwordx4 v[216:219], v89, s[4:7], s58 offen offset:0 sc1
    v_mfma_f32_32x32x16_bf16 v[120:135], a[72:75], v[220:223], v[120:135]
    v_mfma_f32_32x32x16_bf16 v[152:167], a[76:79], v[220:223], v[152:167]
    buffer_load_dwordx4 v[220:223], v100, s[4:7], s58 offen offset:0 sc1
    v_mfma_f32_32x32x16_bf16 v[120:135], a[80:83], v[224:227], v[120:135]
    v_mfma_f32_32x32x16_bf16 v[152:167], a[84:87], v[224:227], v[152:167]
    s_waitcnt vmcnt(10)
    s_nop 0
    v_max3_u32 v248, v232, v233, v234
    v_max3_u32 v248, v248, v235, v236
    v_max3_u32 v248, v248, v237, v238
    v_max3_u32 v248, v248, v239, v240
    v_mfma_f32_32x32x16_bf16 v[120:135], a[88:91], v[228:231], v[120:135]
    v_max3_u32 v248, v248, v241, v242
    v_max3_u32 v248, v248, v243, v244
    v_max3_u32 v248, v248, v245, v246
    v_max_u32 v248, v248, v247
    v_cmp_eq_u32 vcc, -1, v248
    v_mfma_f32_32x32x16_bf16 v[152:167], a[92:95], v[228:231], v[152:167]
    buffer_load_dwordx4 v[224:227], v101, s[4:7], s58 offen offset:0 sc1
    s_cbranch_vccnz L_g1slow_63
L_g1back_64:
    s_nop 0
    v_mfma_f32_32x32x16_bf16 v[120:135], a[96:99], v[232:235], v[120:135]
    buffer_load_dwordx4 v[228:231], v102, s[4:7], s58 offen offset:0 sc1
    v_mfma_f32_32x32x16_bf16 v[152:167], a[100:103], v[232:235], v[152:167]
    buffer_load_dwordx4 v[232:235], v89, s[4:7], s59 offen offset:0 sc1
    v_mfma_f32_32x32x16_bf16 v[120:135], a[104:107], v[236:239], v[120:135]
    v_mfma_f32_32x32x16_bf16 v[152:167], a[108:111], v[236:239], v[152:167]
    buffer_load_dwordx4 v[236:239], v100, s[4:7], s59 offen offset:0 sc1
    v_mfma_f32_32x32x16_bf16 v[120:135], a[112:115], v[240:243], v[120:135]
    v_mfma_f32_32x32x16_bf16 v[152:167], a[116:119], v[240:243], v[152:167]
    s_waitcnt vmcnt(10)
    s_nop 0
    v_max3_u32 v248, v184, v185, v186
    v_max3_u32 v248, v248, v187, v188
    v_max3_u32 v248, v248, v189, v190
    v_max3_u32 v248, v248, v191, v192
    v_mfma_f32_32x32x16_bf16 v[120:135], a[120:123], v[244:247], v[120:135]
    v_max3_u32 v248, v248, v193, v194
    v_max3_u32 v248, v248, v195, v196
    v_max3_u32 v248, v248, v197, v198
    v_max_u32 v248, v248, v199
    v_cmp_eq_u32 vcc, -1, v248
    v_mfma_f32_32x32x16_bf16 v[152:167], a[124:127], v[244:247], v[152:167]
    buffer_load_dwordx4 v[240:243], v101, s[4:7], s59 offen offset:0 sc1
    s_cbranch_vccnz L_g1slow_65
L_g1back_66:
    s_nop 0
    v_mfma_f32_32x32x16_bf16 v[120:135], a[128:131], v[184:187], v[120:135]
    buffer_load_dwordx4 v[244:247], v102, s[4:7], s59 offen offset:0 sc1
    v_mfma_f32_32x32x16_bf16 v[152:167], a[132:135], v[184:187], v[152:167]
    buffer_load_dwordx4 v[184:187], v89, s[4:7], s24 offen offset:512 sc1
    v_mfma_f32_32x32x16_bf16 v[120:135], a[136:139], v[188:191], v[120:135]
    s_add_u32 m0, s88, 8192
    s_nop 0
    s_nop 0
    buffer_load_dwordx4 v117, s[20:23], s62 offen lds
    v_mfma_f32_32x32x16_bf16 v[152:167], a[140:143], v[188:191], v[152:167]
    buffer_load_dwordx4 v[188:191], v100, s[4:7], s24 offen offset:512 sc1
    v_mfma_f32_32x32x16_bf16 v[120:135], a[144:147], v[192:195], v[120:135]
    s_add_u32 m0, s88, 9216
    s_add_u32 s62, s62, 32768
    buffer_load_dwordx4 v117, s[20:23], s62 offen lds
    v_mfma_f32_32x32x16_bf16 v[152:167], a[148:151], v[192:195], v[152:167]
    s_waitcnt vmcnt(12)
    s_nop 0
    v_max3_u32 v248, v200, v201, v202
    v_max3_u32 v248, v248, v203, v204
    v_max3_u32 v248, v248, v205, v206
    v_max3_u32 v248, v248, v207, v208
    v_mfma_f32_32x32x16_bf16 v[120:135], a[152:155], v[196:199], v[120:135]
    v_max3_u32 v248, v248, v209, v210
    v_max3_u32 v248, v248, v211, v212
    v_max3_u32 v248, v248, v213, v214
    v_max_u32 v248, v248, v215
    v_cmp_eq_u32 vcc, -1, v248
    v_mfma_f32_32x32x16_bf16 v[152:167], a[156:159], v[196:199], v[152:167]
    buffer_load_dwordx4 v[192:195], v101, s[4:7], s24 offen offset:512 sc1
    s_cbranch_vccnz L_g1slow_67
L_g1back_68:
    s_nop 0
    v_mfma_f32_32x32x16_bf16 v[120:135], a[160:163], v[200:203], v[120:135]
    buffer_load_dwordx4 v[196:199], v102, s[4:7], s24 offen offset:512 sc1
    v_mfma_f32_32x32x16_bf16 v[152:167], a[164:167], v[200:203], v[152:167]
    buffer_load_dwordx4 v[200:203], v89, s[4:7], s25 offen offset:512 sc1
    v_mfma_f32_32x32x16_bf16 v[120:135], a[168:171], v[204:207], v[120:135]
    s_add_u32 m0, s88, 10240
    s_add_u32 s62, s62, 32768
    buffer_load_dwordx4 v117, s[20:23], s62 offen lds
    v_mfma_f32_32x32x16_bf16 v[152:167], a[172:175], v[204:207], v[152:167]
    buffer_load_dwordx4 v[204:207], v100, s[4:7], s25 offen offset:512 sc1
    v_mfma_f32_32x32x16_bf16 v[120:135], a[176:179], v[208:211], v[120:135]
    s_add_u32 m0, s88, 11264
    s_add_u32 s62, s62, 32768
    buffer_load_dwordx4 v117, s[20:23], s62 offen lds
    v_mfma_f32_32x32x16_bf16 v[152:167], a[180:183], v[208:211], v[152:167]
    s_waitcnt vmcnt(14)
    s_nop 0
    v_max3_u32 v248, v216, v217, v218
    v_max3_u32 v248, v248, v219, v220
    v_max3_u32 v248, v248, v221, v222
    v_max3_u32 v248, v248, v223, v224
    v_mfma_f32_32x32x16_bf16 v[120:135], a[184:187], v[212:215], v[120:135]
    v_max3_u32 v248, v248, v225, v226
    v_max3_u32 v248, v248, v227, v228
    v_max3_u32 v248, v248, v229, v230
    v_max_u32 v248, v248, v231
    v_cmp_eq_u32 vcc, -1, v248
    v_mfma_f32_32x32x16_bf16 v[152:167], a[188:191], v[212:215], v[152:167]
    buffer_load_dwordx4 v[208:211], v101, s[4:7], s25 offen offset:512 sc1
    s_cbranch_vccnz L_g1slow_69
L_g1back_70:
    s_nop 0
    v_mfma_f32_32x32x16_bf16 v[120:135], a[192:195], v[216:219], v[120:135]
    buffer_load_dwordx4 v[212:215], v102, s[4:7], s25 offen offset:512 sc1
    v_mfma_f32_32x32x16_bf16 v[152:167], a[196:199], v[216:219], v[152:167]
    buffer_load_dwordx4 v[216:219], v89, s[4:7], s26 offen offset:512 sc1
    v_mfma_f32_32x32x16_bf16 v[120:135], a[200:203], v[220:223], v[120:135]
    s_add_u32 m0, s88, 12288
    s_nop 0
    s_nop 0
    buffer_load_dwordx4 v117, s[20:23], s63 offen lds
    v_mfma_f32_32x32x16_bf16 v[152:167], a[204:207], v[220:223], v[152:167]
    buffer_load_dwordx4 v[220:223], v100, s[4:7], s26 offen offset:512 sc1
    v_mfma_f32_32x32x16_bf16 v[120:135], a[208:211], v[224:227], v[120:135]
    s_add_u32 m0, s88, 13312
    s_add_u32 s63, s63, 32768
    buffer_load_dwordx4 v117, s[20:23], s63 offen lds
    v_mfma_f32_32x32x16_bf16 v[152:167], a[212:215], v[224:227], v[152:167]
    s_waitcnt vmcnt(16)
    s_nop 0
    v_max3_u32 v248, v232, v233, v234
    v_max3_u32 v248, v248, v235, v236
    v_max3_u32 v248, v248, v237, v238
    v_max3_u32 v248, v248, v239, v240
    v_mfma_f32_32x32x16_bf16 v[120:135], a[216:219], v[228:231], v[120:135]
    v_max3_u32 v248, v248, v241, v242
    v_max3_u32 v248, v248, v243, v244
    v_max3_u32 v248, v248, v245, v246
    v_max_u32 v248, v248, v247
    v_cmp_eq_u32 vcc, -1, v248
    v_mfma_f32_32x32x16_bf16 v[152:167], a[220:223], v[228:231], v[152:167]
    buffer_load_dwordx4 v[224:227], v101, s[4:7], s26 offen offset:512 sc1
    s_cbranch_vccnz L_g1slow_71
L_g1back_72:
    s_nop 0
    v_mfma_f32_32x32x16_bf16 v[120:135], a[224:227], v[232:235], v[120:135]
    buffer_load_dwordx4 v[228:231], v102, s[4:7], s26 offen offset:512 sc1
    v_mfma_f32_32x32x16_bf16 v[152:167], a[228:231], v[232:235], v[152:167]
    buffer_load_dwordx4 v[232:235], v89, s[4:7], s27 offen offset:512 sc1
    v_mfma_f32_32x32x16_bf16 v[120:135], a[232:235], v[236:239], v[120:135]
    s_add_u32 m0, s88, 14336
    s_add_u32 s63, s63, 32768
    buffer_load_dwordx4 v117, s[20:23], s63 offen lds
    v_mfma_f32_32x32x16_bf16 v[152:167], a[236:239], v[236:239], v[152:167]
    buffer_load_dwordx4 v[236:239], v100, s[4:7], s27 offen offset:512 sc1
    v_mfma_f32_32x32x16_bf16 v[120:135], a[240:243], v[240:243], v[120:135]
    s_add_u32 m0, s88, 15360
    s_add_u32 s63, s63, 32768
    buffer_load_dwordx4 v117, s[20:23], s63 offen lds
    v_mfma_f32_32x32x16_bf16 v[152:167], a[244:247], v[240:243], v[152:167]
    s_waitcnt vmcnt(16)
    s_nop 0
    v_max3_u32 v248, v184, v185, v186
    v_max3_u32 v248, v248, v187, v188
    v_max3_u32 v248, v248, v189, v190
    v_max3_u32 v248, v248, v191, v192
    v_mfma_f32_32x32x16_bf16 v[120:135], a[248:251], v[244:247], v[120:135]
    v_max3_u32 v248, v248, v193, v194
    v_max3_u32 v248, v248, v195, v196
    v_max3_u32 v248, v248, v197, v198
    v_max_u32 v248, v248, v199
    v_cmp_eq_u32 vcc, -1, v248
    v_mfma_f32_32x32x16_bf16 v[152:167], a[252:255], v[244:247], v[152:167]
    buffer_load_dwordx4 v[240:243], v101, s[4:7], s27 offen offset:512 sc1
    s_cbranch_vccnz L_g1slow_73
L_g1back_74:
    v_mfma_f32_32x32x16_bf16 v[136:151], a[0:3], v[184:187], 0
    buffer_load_dwordx4 v[244:247], v102, s[4:7], s27 offen offset:512 sc1
    s_add_u32 m0, s52, 8192
    s_lshl_b32 s53, s54, 15
    s_add_u32 s53, s53, s90
    buffer_load_dwordx4 v117, s[20:23], s53 offen lds
    s_add_u32 s54, s54, 1
    s_cmp_eq_u32 s54, 56
    s_cselect_b32 s54, 0, s54
    v_mfma_f32_32x32x16_bf16 v[168:183], a[4:7], v[184:187], 0
    buffer_load_dwordx4 v[184:187], v89, s[4:7], s56 offen offset:512 sc1
    v_xor_b32_e64 v104, 0, v103
    ds_write_b128 v104, v[120:123]
    v_and_b32 v119, 31, v1
    v_lshlrev_b32 v119, 6, v119
    s_mov_b32 s48, 25264128
    buffer_load_dword v118, v119, s[4:7], s48 offen sc1
    v_mfma_f32_32x32x16_bf16 v[136:151], a[8:11], v[188:191], v[136:151]
    v_xor_b32_e64 v105, 16, v103
    ds_write_b128 v105, v[124:127]
    v_mfma_f32_32x32x16_bf16 v[168:183], a[12:15], v[188:191], v[168:183]
    buffer_load_dwordx4 v[188:191], v100, s[4:7], s56 offen offset:512 sc1
    v_xor_b32_e64 v104, 32, v103
    ds_write_b128 v104, v[128:131]
    s_cmp_lg_u32 s3, 0
    s_cbranch_scc1 L_tok_75
    s_lshl_b32 s48, s84, 6
    s_lshl_b32 s49, s64, 14
    s_add_u32 s48, s48, s49
    s_add_u32 s48, s48, 25346048
    v_mov_b32 v104, s68
    v_mov_b32 v105, 0
    s_mov_b64 exec, 1
    buffer_store_dword v104, v105, s[4:7], s48 offen sc1
    s_mov_b64 exec, -1
L_tok_75:
    s_add_u32 m0, s52, 9216
    s_lshl_b32 s53, s54, 15
    s_add_u32 s53, s53, s90
    buffer_load_dwordx4 v117, s[20:23], s53 offen lds
    s_add_u32 s54, s54, 1
    s_cmp_eq_u32 s54, 56
    s_cselect_b32 s54, 0, s54
    v_mfma_f32_32x32x16_bf16 v[136:151], a[16:19], v[192:195], v[136:151]
    v_xor_b32_e64 v105, 48, v103
    ds_write_b128 v105, v[132:135]
    v_mfma_f32_32x32x16_bf16 v[168:183], a[20:23], v[192:195], v[168:183]
    s_waitcnt vmcnt(17)
    s_nop 0
    v_max3_u32 v248, v200, v201, v202
    v_max3_u32 v248, v248, v203, v204
    v_max3_u32 v248, v248, v205, v206
    v_max3_u32 v248, v248, v207, v208
    v_mfma_f32_32x32x16_bf16 v[136:151], a[24:27], v[196:199], v[136:151]
    v_max3_u32 v248, v248, v209, v210
    v_max3_u32 v248, v248, v211, v212
    v_max3_u32 v248, v248, v213, v214
    v_max_u32 v248, v248, v215
    v_cmp_eq_u32 vcc, -1, v248
    v_mfma_f32_32x32x16_bf16 v[168:183], a[28:31], v[196:199], v[168:183]
    buffer_load_dwordx4 v[192:195], v101, s[4:7], s56 offen offset:512 sc1
    v_xor_b32_e64 v104, 64, v103
    ds_write_b128 v104, v[152:155]
    s_cbranch_vccnz L_g1slow_76
L_g1back_77:
    s_nop 0
    v_mfma_f32_32x32x16_bf16 v[136:151], a[32:35], v[200:203], v[136:151]
    buffer_load_dwordx4 v[196:199], v102, s[4:7], s56 offen offset:512 sc1
    v_xor_b32 v105, 80, v103
    ds_write_b128 v105, v[156:159]
    s_add_u32 m0, s52, 10240
    s_lshl_b32 s53, s54, 15
    s_add_u32 s53, s53, s90
    buffer_load_dwordx4 v117, s[20:23], s53 offen lds
    s_add_u32 s54, s54, 1
    s_cmp_eq_u32 s54, 56
    s_cselect_b32 s54, 0, s54
    s_nop 0
    v_mfma_f32_32x32x16_bf16 v[168:183], a[36:39], v[200:203], v[168:183]
    buffer_load_dwordx4 v[200:203], v89, s[4:7], s57 offen offset:512 sc1
    v_xor_b32 v104, 96, v103
    ds_write_b128 v104, v[160:163]
    v_mfma_f32_32x32x16_bf16 v[136:151], a[40:43], v[204:207], v[136:151]
    v_xor_b32 v105, 112, v103
    ds_write_b128 v105, v[164:167]
    v_mfma_f32_32x32x16_bf16 v[168:183], a[44:47], v[204:207], v[168:183]
    buffer_load_dwordx4 v[204:207], v100, s[4:7], s57 offen offset:512 sc1
    s_add_u32 m0, s52, 11264
    s_lshl_b32 s53, s54, 15
    s_add_u32 s53, s53, s90
    buffer_load_dwordx4 v117, s[20:23], s53 offen lds
    s_add_u32 s54, s54, 1
    s_cmp_eq_u32 s54, 56
    s_cselect_b32 s54, 0, s54
    v_mfma_f32_32x32x16_bf16 v[136:151], a[48:51], v[208:211], v[136:151]
    s_waitcnt lgkmcnt(0)
    s_barrier
    s_nop 0
    ds_read_b128 v[120:123], v106 offset:0
    ds_read_b128 v[124:127], v107 offset:0
    ds_read_b128 v[128:131], v106 offset:16384
    v_mfma_f32_32x32x16_bf16 v[168:183], a[52:55], v[208:211], v[168:183]
    s_waitcnt vmcnt(17)
    s_nop 0
    v_max3_u32 v248, v216, v217, v218
    v_max3_u32 v248, v248, v219, v220
    v_max3_u32 v248, v248, v221, v222
    v_max3_u32 v248, v248, v223, v224
    v_mfma_f32_32x32x16_bf16 v[136:151], a[56:59], v[212:215], v[136:151]
    v_max3_u32 v248, v248, v225, v226
    v_max3_u32 v248, v248, v227, v228
    v_max3_u32 v248, v248, v229, v230
    v_max_u32 v248, v248, v231
    v_cmp_eq_u32 vcc, -1, v248
    v_mfma_f32_32x32x16_bf16 v[168:183], a[60:63], v[212:215], v[168:183]
    buffer_load_dwordx4 v[208:211], v101, s[4:7], s57 offen offset:512 sc1
    ds_read_b128 v[132:135], v107 offset:16384
    ds_read_b128 v[152:155], v106 offset:32768
    ds_read_b128 v[156:159], v107 offset:32768
    s_cbranch_vccnz L_g1slow_78
L_g1back_79:
    s_nop 0
    v_mfma_f32_32x32x16_bf16 v[136:151], a[64:67], v[216:219], v[136:151]
    buffer_load_dwordx4 v[212:215], v102, s[4:7], s57 offen offset:512 sc1
    ds_read_b128 v[160:163], v106 offset:49152
    ds_read_b128 v[164:167], v107 offset:49152
    s_add_u32 m0, s52, 12288
    s_lshl_b32 s53, s54, 15
    s_add_u32 s53, s53, s90
    buffer_load_dwordx4 v117, s[20:23], s53 offen lds
    s_add_u32 s54, s54, 1
    s_cmp_eq_u32 s54, 56
    s_cselect_b32 s54, 0, s54
    v_mfma_f32_32x32x16_bf16 v[168:183], a[68:71], v[216:219], v[168:183]
    buffer_load_dwordx4 v[216:219], v89, s[4:7], s58 offen offset:512 sc1
    s_waitcnt lgkmcnt(4)
    v_add_f32 v120, v120, v108
    v_add_f32 v121, v121, v109
    v_add_f32 v122, v122, v110
    v_add_f32 v123, v123, v111
    v_mfma_f32_32x32x16_bf16 v[136:151], a[72:75], v[220:223], v[136:151]
    v_add_f32 v124, v124, v112
    v_add_f32 v125, v125, v113
    v_add_f32 v126, v126, v114
    v_add_f32 v127, v127, v115
    v_add_f32 v120, v120, v128
    v_add_f32 v121, v121, v129
    v_add_f32_e64 v122, v122, v130
    v_mfma_f32_32x32x16_bf16 v[168:183], a[76:79], v[220:223], v[168:183]
    buffer_load_dwordx4 v[220:223], v100, s[4:7], s58 offen offset:512 sc1
    v_add_f32 v123, v123, v131
    v_add_f32 v124, v124, v132
    v_add_f32 v125, v125, v133
    v_add_f32 v126, v126, v134
    v_add_f32_e64 v127, v127, v135
    s_add_u32 m0, s52, 13312
    s_lshl_b32 s53, s54, 15
    s_add_u32 s53, s53, s90
    buffer_load_dwordx4 v117, s[20:23], s53 offen lds
    s_add_u32 s54, s54, 1
    s_cmp_eq_u32 s54, 56
    s_cselect_b32 s54, 0, s54
    v_mfma_f32_32x32x16_bf16 v[136:151], a[80:83], v[224:227], v[136:151]
    s_waitcnt lgkmcnt(0)
    v_add_f32 v152, v152, v160
    v_add_f32 v153, v153, v161
    v_add_f32 v154, v154, v162
    v_add_f32 v155, v155, v163
    v_add_f32 v156, v156, v164
    v_add_f32 v157, v157, v165
    v_mfma_f32_32x32x16_bf16 v[168:183], a[84:87], v[224:227], v[168:183]
    s_waitcnt vmcnt(17)
    s_nop 0
    v_max3_u32 v248, v232, v233, v234
    v_max3_u32 v248, v248, v235, v236
    v_max3_u32 v248, v248, v237, v238
    v_max3_u32 v248, v248, v239, v240
    v_mfma_f32_32x32x16_bf16 v[136:151], a[88:91], v[228:231], v[136:151]
    v_max3_u32 v248, v248, v241, v242
    v_max3_u32 v248, v248, v243, v244
    v_max3_u32 v248, v248, v245, v246
    v_max_u32 v248, v248, v247
    v_cmp_eq_u32 vcc, -1, v248
    v_mfma_f32_32x32x16_bf16 v[168:183], a[92:95], v[228:231], v[168:183]
    buffer_load_dwordx4 v[224:227], v101, s[4:7], s58 offen offset:512 sc1
    v_add_f32 v158, v158, v166
    v_add_f32 v159, v159, v167
    v_add_f32 v120, v120, v152
    v_add_f32 v121, v121, v153
    v_add_f32 v122, v122, v154
    s_cbranch_vccnz L_g1slow_80
L_g1back_81:
    v_mfma_f32_32x32x16_bf16 v[136:151], a[96:99], v[232:235], v[136:151]
    buffer_load_dwordx4 v[228:231], v102, s[4:7], s58 offen offset:512 sc1
    v_add_f32 v123, v123, v155
    v_add_f32 v124, v124, v156
    v_add_f32 v125, v125, v157
    v_add_f32 v126, v126, v158
    v_add_f32_e64 v127, v127, v159
    s_add_u32 m0, s52, 14336
    s_lshl_b32 s53, s54, 15
    s_add_u32 s53, s53, s90
    buffer_load_dwordx4 v117, s[20:23], s53 offen lds
    s_add_u32 s54, s54, 1
    s_cmp_eq_u32 s54, 56
    s_cselect_b32 s54, 0, s54
    v_mfma_f32_32x32x16_bf16 v[168:183], a[100:103], v[232:235], v[168:183]
    buffer_load_dwordx4 v[232:235], v89, s[4:7], s59 offen offset:512 sc1
    v_mul_f32 v128, v120, v120
    v_mul_f32 v129, v121, v121
    v_mul_f32 v130, v122, v122
    v_mul_f32 v131, v123, v123
    v_mul_f32 v132, v124, v124
    v_mfma_f32_32x32x16_bf16 v[136:151], a[104:107], v[236:239], v[136:151]
    v_mul_f32 v133, v125, v125
    v_mul_f32 v134, v126, v126
    v_mul_f32_e64 v135, v127, v127
    v_fma_f32 v128, v128, v85, v84
    v_fma_f32 v129, v129, v85, v84
    v_fma_f32 v130, v130, v85, v84
    v_fma_f32 v131, v131, v85, v84
    v_mfma_f32_32x32x16_bf16 v[168:183], a[108:111], v[236:239], v[168:183]
    buffer_load_dwordx4 v[236:239], v100, s[4:7], s59 offen offset:512 sc1
    v_fma_f32 v132, v132, v85, v84
    v_fma_f32 v133, v133, v85, v84
    v_fma_f32 v134, v134, v85, v84
    v_fma_f32 v135, v135, v85, v84
    v_mul_f32_e64 v128, v128, v120
    s_add_u32 m0, s52, 15360
    s_lshl_b32 s53, s54, 15
    s_add_u32 s53, s53, s90
    buffer_load_dwordx4 v117, s[20:23], s53 offen lds
    s_add_u32 s54, s54, 1
    s_cmp_eq_u32 s54, 56
    s_cselect_b32 s54, 0, s54
    v_mfma_f32_32x32x16_bf16 v[136:151], a[112:115], v[240:243], v[136:151]
    v_mul_f32 v129, v129, v121
    v_mul_f32 v130, v130, v122
    v_mul_f32 v131, v131, v123
    v_mul_f32 v132, v132, v124
    v_mul_f32 v133, v133, v125
    v_mul_f32 v134, v134, v126
    v_mul_f32 v135, v135, v127
    v_mfma_f32_32x32x16_bf16 v[168:183], a[116:119], v[240:243], v[168:183]
    s_waitcnt vmcnt(16)
    s_nop 0
    v_max3_u32 v248, v184, v185, v186
    v_max3_u32 v248, v248, v187, v188
    v_max3_u32 v248, v248, v189, v190
    v_max3_u32 v248, v248, v191, v192
    v_mfma_f32_32x32x16_bf16 v[136:151], a[120:123], v[244:247], v[136:151]
    v_max3_u32 v248, v248, v193, v194
    v_max3_u32 v248, v248, v195, v196
    v_max3_u32 v248, v248, v197, v198
    v_max_u32 v248, v248, v199
    v_cmp_eq_u32 vcc, -1, v248
    v_mfma_f32_32x32x16_bf16 v[168:183], a[124:127], v[244:247], v[168:183]
    buffer_load_dwordx4 v[240:243], v101, s[4:7], s59 offen offset:512 sc1
    v_exp_f32 v128, v128
    v_exp_f32 v129, v129
    s_cbranch_vccnz L_g1slow_82
L_g1back_83:
    v_mfma_f32_32x32x16_bf16 v[136:151], a[128:131], v[184:187], v[136:151]
    buffer_load_dwordx4 v[244:247], v102, s[4:7], s59 offen offset:512 sc1
    v_exp_f32 v130, v130
    v_exp_f32 v131, v131
    v_exp_f32 v132, v132
    s_add_u32 m0, s52, 16384
    s_lshl_b32 s53, s54, 15
    s_add_u32 s53, s53, s90
    buffer_load_dwordx4 v117, s[20:23], s53 offen lds
    s_add_u32 s54, s54, 1
    s_cmp_eq_u32 s54, 56
    s_cselect_b32 s54, 0, s54
    v_mfma_f32_32x32x16_bf16 v[168:183], a[132:135], v[184:187], v[168:183]
    v_exp_f32 v133, v133
    v_exp_f32 v134, v134
    v_exp_f32 v135, v135
    v_add_f32_e64 v128, 1.0, v128
    v_mfma_f32_32x32x16_bf16 v[136:151], a[136:139], v[188:191], v[136:151]
    s_mov_b32 s66, 0
    v_cmp_ne_u32 vcc, s68, v118
    s_cbranch_vccz L_fwd_85
L_fw_84:
    v_and_b32 v119, 31, v1
    v_lshlrev_b32_e64 v119, 6, v119
    s_mov_b32 s48, 25264128
    buffer_load_dword v118, v119, s[4:7], s48 offen sc1
L_fwc_86:
    s_waitcnt vmcnt(0)
    v_cmp_ne_u32 vcc, s68, v118
    s_cbranch_vccz L_fwd_85
    s_add_u32 s66, s66, 1
    s_cmp_lt_u32 s66, s67
    s_sleep 2
    s_cbranch_scc1 L_fw_84
    s_mov_b32 s67, 1
L_fwd_85:
    v_add_f32 v129, 1.0, v129
    v_add_f32 v130, 1.0, v130
    v_add_f32 v131, 1.0, v131
    v_add_f32 v132, 1.0, v132
    v_add_f32 v133, 1.0, v133
    v_add_f32 v134, 1.0, v134
    v_add_f32_e64 v135, 1.0, v135
    v_mfma_f32_32x32x16_bf16 v[168:183], a[140:143], v[188:191], v[168:183]
    v_rcp_f32 v128, v128
    v_rcp_f32 v129, v129
    v_rcp_f32_e64 v130, v130
    s_add_u32 m0, s52, 17408
    s_lshl_b32 s53, s54, 15
    s_add_u32 s53, s53, s90
    buffer_load_dwordx4 v117, s[20:23], s53 offen lds
    s_add_u32 s54, s54, 1
    s_cmp_eq_u32 s54, 56
    s_cselect_b32 s54, 0, s54
    v_mfma_f32_32x32x16_bf16 v[136:151], a[144:147], v[192:195], v[136:151]
    s_barrier
    v_rcp_f32 v131, v131
    v_rcp_f32 v132, v132
    v_rcp_f32_e64 v133, v133
    v_mfma_f32_32x32x16_bf16 v[168:183], a[148:151], v[192:195], v[168:183]
    s_waitcnt vmcnt(14)
    s_nop 0
    v_max3_u32 v248, v200, v201, v202
    v_max3_u32 v248, v248, v203, v204
    v_max3_u32 v248, v248, v205, v206
    v_max3_u32 v248, v248, v207, v208
    v_mfma_f32_32x32x16_bf16 v[136:151], a[152:155], v[196:199], v[136:151]
    v_max3_u32 v248, v248, v209, v210
    v_max3_u32 v248, v248, v211, v212
    v_max3_u32 v248, v248, v213, v214
    v_max_u32 v248, v248, v215
    v_cmp_eq_u32 vcc, -1, v248
    v_mfma_f32_32x32x16_bf16 v[168:183], a[156:159], v[196:199], v[168:183]
    v_rcp_f32 v134, v134
    v_rcp_f32 v135, v135
    v_mul_f32 v120, v120, v128
    v_mul_f32 v121, v121, v129
    s_cbranch_vccnz L_g1slow_87
L_g1back_88:
    v_mfma_f32_32x32x16_bf16 v[136:151], a[160:163], v[200:203], v[136:151]
    v_mul_f32 v122, v122, v130
    v_mul_f32 v123, v123, v131
    v_mul_f32 v124, v124, v132
    v_mul_f32 v125, v125, v133
    v_mul_f32 v126, v126, v134
    v_mul_f32_e64 v127, v127, v135
    v_cvt_pk_bf16_f32 v160, v120, v121
    s_add_u32 m0, s52, 18432
    s_lshl_b32 s53, s54, 15
    s_add_u32 s53, s53, s90
    buffer_load_dwordx4 v117, s[20:23], s53 offen lds
    s_add_u32 s54, s54, 1
    s_cmp_eq_u32 s54, 56
    s_cselect_b32 s54, 0, s54
    s_nop 0
    v_mfma_f32_32x32x16_bf16 v[168:183], a[164:167], v[200:203], v[168:183]
    v_cvt_pk_bf16_f32 v161, v122, v123
    v_cvt_pk_bf16_f32 v162, v124, v125
    v_cvt_pk_bf16_f32 v163, v126, v127
    v_min_u32 v160, -2, v160
    v_min_u32 v161, -2, v161
    v_min_u32 v162, -2, v162
    v_min_u32 v163, -2, v163
    v_mfma_f32_32x32x16_bf16 v[136:151], a[168:171], v[204:207], v[136:151]
    buffer_store_dwordx4 v[160:163], v89, s[4:7], s89 offen sc1
    v_mfma_f32_32x32x16_bf16 v[168:183], a[172:175], v[204:207], v[168:183]
    s_add_u32 m0, s52, 19456
    s_lshl_b32 s53, s54, 15
    s_add_u32 s53, s53, s90
    buffer_load_dwordx4 v117, s[20:23], s53 offen lds
    s_add_u32 s54, s54, 1
    s_cmp_eq_u32 s54, 56
    s_cselect_b32 s54, 0, s54
    v_mfma_f32_32x32x16_bf16 v[136:151], a[176:179], v[208:211], v[136:151]
    v_mfma_f32_32x32x16_bf16 v[168:183], a[180:183], v[208:211], v[168:183]
    s_waitcnt vmcnt(11)
    v_max3_u32 v248, v216, v217, v218
    v_max3_u32 v248, v248, v219, v220
    v_max3_u32 v248, v248, v221, v222
    v_max3_u32 v248, v248, v223, v224
    v_mfma_f32_32x32x16_bf16 v[136:151], a[184:187], v[212:215], v[136:151]
    v_max3_u32 v248, v248, v225, v226
    v_max3_u32 v248, v248, v227, v228
    v_max3_u32 v248, v248, v229, v230
    v_max_u32 v248, v248, v231
    v_cmp_eq_u32 vcc, -1, v248
    v_mfma_f32_32x32x16_bf16 v[168:183], a[188:191], v[212:215], v[168:183]
    s_cbranch_vccnz L_g1slow_89
L_g1back_90:
    v_mfma_f32_32x32x16_bf16 v[136:151], a[192:195], v[216:219], v[136:151]
    s_add_u32 m0, s52, 20480
    s_lshl_b32 s53, s54, 15
    s_add_u32 s53, s53, s90
    buffer_load_dwordx4 v117, s[20:23], s53 offen lds
    s_add_u32 s54, s54, 1
    s_cmp_eq_u32 s54, 56
    s_cselect_b32 s54, 0, s54
    v_mfma_f32_32x32x16_bf16 v[168:183], a[196:199], v[216:219], v[168:183]
    v_mfma_f32_32x32x16_bf16 v[136:151], a[200:203], v[220:223], v[136:151]
    v_mfma_f32_32x32x16_bf16 v[168:183], a[204:207], v[220:223], v[168:183]
    s_add_u32 m0, s52, 21504
    s_lshl_b32 s53, s54, 15
    s_add_u32 s53, s53, s90
    buffer_load_dwordx4 v117, s[20:23], s53 offen lds
    s_add_u32 s54, s54, 1
    s_cmp_eq_u32 s54, 56
    s_cselect_b32 s54, 0, s54
    v_mfma_f32_32x32x16_bf16 v[136:151], a[208:211], v[224:227], v[136:151]
    v_mfma_f32_32x32x16_bf16 v[168:183], a[212:215], v[224:227], v[168:183]
    s_waitcnt vmcnt(7)
    v_max3_u32 v248, v232, v233, v234
    v_max3_u32 v248, v248, v235, v236
    v_max3_u32 v248, v248, v237, v238
    v_max3_u32 v248, v248, v239, v240
    v_mfma_f32_32x32x16_bf16 v[136:151], a[216:219], v[228:231], v[136:151]
    v_max3_u32 v248, v248, v241, v242
    v_max3_u32 v248, v248, v243, v244
    v_max3_u32 v248, v248, v245, v246
    v_max_u32 v248, v248, v247
    v_cmp_eq_u32 vcc, -1, v248
    v_mfma_f32_32x32x16_bf16 v[168:183], a[220:223], v[228:231], v[168:183]
    s_cbranch_vccnz L_g1slow_91
L_g1back_92:
    v_mfma_f32_32x32x16_bf16 v[136:151], a[224:227], v[232:235], v[136:151]
    s_add_u32 m0, s52, 22528
    s_lshl_b32 s53, s54, 15
    s_add_u32 s53, s53, s90
    buffer_load_dwordx4 v117, s[20:23], s53 offen lds
    s_add_u32 s54, s54, 1
    s_cmp_eq_u32 s54, 56
    s_cselect_b32 s54, 0, s54
    v_mfma_f32_32x32x16_bf16 v[168:183], a[228:231], v[232:235], v[168:183]
    v_mfma_f32_32x32x16_bf16 v[136:151], a[232:235], v[236:239], v[136:151]
    v_mfma_f32_32x32x16_bf16 v[168:183], a[236:239], v[236:239], v[168:183]
    s_add_u32 m0, s52, 23552
    s_lshl_b32 s53, s54, 15
    s_add_u32 s53, s53, s90
    buffer_load_dwordx4 v117, s[20:23], s53 offen lds
    s_add_u32 s54, s54, 1
    s_cmp_eq_u32 s54, 56
    s_cselect_b32 s54, 0, s54
    s_nop 0
    v_mfma_f32_32x32x16_bf16 v[136:151], a[240:243], v[240:243], v[136:151]
    v_mfma_f32_32x32x16_bf16 v[168:183], a[244:247], v[240:243], v[168:183]
    v_mfma_f32_32x32x16_bf16 v[136:151], a[248:251], v[244:247], v[136:151]
    v_mfma_f32_32x32x16_bf16 v[168:183], a[252:255], v[244:247], v[168:183]
    s_branch L_g1j_56
L_g1l1_55:
    s_mov_b32 s66, 0
    buffer_load_dwordx4 v[184:187], v89, s[4:7], s24 offen offset:0 sc1
    buffer_load_dwordx4 v[188:191], v100, s[4:7], s24 offen offset:0 sc1
    buffer_load_dwordx4 v[192:195], v101, s[4:7], s24 offen offset:0 sc1
    buffer_load_dwordx4 v[196:199], v102, s[4:7], s24 offen offset:0 sc1
    s_barrier
    s_nop 0
    buffer_load_dwordx4 v[200:203], v89, s[4:7], s25 offen offset:0 sc1
    buffer_load_dwordx4 v[204:207], v100, s[4:7], s25 offen offset:0 sc1
    buffer_load_dwordx4 v[208:211], v101, s[4:7], s25 offen offset:0 sc1
    buffer_load_dwordx4 v[212:215], v102, s[4:7], s25 offen offset:0 sc1
    s_barrier
    s_nop 0
    buffer_load_dwordx4 v[216:219], v89, s[4:7], s26 offen offset:0 sc1
    buffer_load_dwordx4 v[220:223], v100, s[4:7], s26 offen offset:0 sc1
    buffer_load_dwordx4 v[224:227], v101, s[4:7], s26 offen offset:0 sc1
    buffer_load_dwordx4 v[228:231], v102, s[4:7], s26 offen offset:0 sc1
    buffer_load_dwordx4 v[232:235], v89, s[4:7], s27 offen offset:0 sc1
    buffer_load_dwordx4 v[236:239], v100, s[4:7], s27 offen offset:0 sc1
    buffer_load_dwordx4 v[240:243], v101, s[4:7], s27 offen offset:0 sc1
    buffer_load_dwordx4 v[244:247], v102, s[4:7], s27 offen offset:0 sc1
    s_waitcnt vmcnt(12)
    s_nop 0
    v_max3_u32 v118, v184, v185, v186
    v_max3_u32 v118, v118, v187, v188
    v_max3_u32 v118, v118, v189, v190
    v_max3_u32 v118, v118, v191, v192
    v_max3_u32 v118, v118, v193, v194
    v_max3_u32 v118, v118, v195, v196
    v_max3_u32 v118, v118, v197, v198
    v_max_u32 v118, v118, v199
    v_cmp_eq_u32 vcc, -1, v118
    s_cbranch_vccnz L_g1slow_93
L_g1back_94:
    s_nop 0
    v_mfma_f32_32x32x16_bf16 v[120:135], a[0:3], v[184:187], 0
    v_mfma_f32_32x32x16_bf16 v[152:167], a[4:7], v[184:187], 0
    buffer_load_dwordx4 v[184:187], v89, s[4:7], s56 offen offset:0 sc1
    v_mfma_f32_32x32x16_bf16 v[120:135], a[8:11], v[188:191], v[120:135]
    v_mfma_f32_32x32x16_bf16 v[152:167], a[12:15], v[188:191], v[152:167]
    buffer_load_dwordx4 v[188:191], v100, s[4:7], s56 offen offset:0 sc1
    v_mfma_f32_32x32x16_bf16 v[120:135], a[16:19], v[192:195], v[120:135]
    v_mfma_f32_32x32x16_bf16 v[152:167], a[20:23], v[192:195], v[152:167]
    s_waitcnt vmcnt(10)
    s_nop 0
    v_max3_u32 v118, v200, v201, v202
    v_max3_u32 v118, v118, v203, v204
    v_max3_u32 v118, v118, v205, v206
    v_max3_u32 v118, v118, v207, v208
    v_mfma_f32_32x32x16_bf16 v[120:135], a[24:27], v[196:199], v[120:135]
    v_max3_u32 v118, v118, v209, v210
    v_max3_u32 v118, v118, v211, v212
    v_max3_u32 v118, v118, v213, v214
    v_max_u32 v118, v118, v215
    v_cmp_eq_u32 vcc, -1, v118
    v_mfma_f32_32x32x16_bf16 v[152:167], a[28:31], v[196:199], v[152:167]
    buffer_load_dwordx4 v[192:195], v101, s[4:7], s56 offen offset:0 sc1
    s_cbranch_vccnz L_g1slow_95
L_g1back_96:
    s_nop 0
    v_mfma_f32_32x32x16_bf16 v[120:135], a[32:35], v[200:203], v[120:135]
    buffer_load_dwordx4 v[196:199], v102, s[4:7], s56 offen offset:0 sc1
    v_mfma_f32_32x32x16_bf16 v[152:167], a[36:39], v[200:203], v[152:167]
    buffer_load_dwordx4 v[200:203], v89, s[4:7], s57 offen offset:0 sc1
    v_mfma_f32_32x32x16_bf16 v[120:135], a[40:43], v[204:207], v[120:135]
    v_mfma_f32_32x32x16_bf16 v[152:167], a[44:47], v[204:207], v[152:167]
    buffer_load_dwordx4 v[204:207], v100, s[4:7], s57 offen offset:0 sc1
    v_mfma_f32_32x32x16_bf16 v[120:135], a[48:51], v[208:211], v[120:135]
    v_mfma_f32_32x32x16_bf16 v[152:167], a[52:55], v[208:211], v[152:167]
    s_waitcnt vmcnt(10)
    s_nop 0
    v_max3_u32 v118, v216, v217, v218
    v_max3_u32 v118, v118, v219, v220
    v_max3_u32 v118, v118, v221, v222
    v_max3_u32 v118, v118, v223, v224
    v_mfma_f32_32x32x16_bf16 v[120:135], a[56:59], v[212:215], v[120:135]
    v_max3_u32 v118, v118, v225, v226
    v_max3_u32 v118, v118, v227, v228
    v_max3_u32 v118, v118, v229, v230
    v_max_u32 v118, v118, v231
    v_cmp_eq_u32 vcc, -1, v118
    v_mfma_f32_32x32x16_bf16 v[152:167], a[60:63], v[212:215], v[152:167]
    buffer_load_dwordx4 v[208:211], v101, s[4:7], s57 offen offset:0 sc1
    s_cbranch_vccnz L_g1slow_97
L_g1back_98:
    s_nop 0
    v_mfma_f32_32x32x16_bf16 v[120:135], a[64:67], v[216:219], v[120:135]
    buffer_load_dwordx4 v[212:215], v102, s[4:7], s57 offen offset:0 sc1
    v_mfma_f32_32x32x16_bf16 v[152:167], a[68:71], v[216:219], v[152:167]
    buffer_load_dwordx4 v[216:219], v89, s[4:7], s58 offen offset:0 sc1
    v_mfma_f32_32x32x16_bf16 v[120:135], a[72:75], v[220:223], v[120:135]
    v_mfma_f32_32x32x16_bf16 v[152:167], a[76:79], v[220:223], v[152:167]
    buffer_load_dwordx4 v[220:223], v100, s[4:7], s58 offen offset:0 sc1
    v_mfma_f32_32x32x16_bf16 v[120:135], a[80:83], v[224:227], v[120:135]
    v_mfma_f32_32x32x16_bf16 v[152:167], a[84:87], v[224:227], v[152:167]
    s_waitcnt vmcnt(10)
    s_nop 0
    v_max3_u32 v118, v232, v233, v234
    v_max3_u32 v118, v118, v235, v236
    v_max3_u32 v118, v118, v237, v238
    v_max3_u32 v118, v118, v239, v240
    v_mfma_f32_32x32x16_bf16 v[120:135], a[88:91], v[228:231], v[120:135]
    v_max3_u32 v118, v118, v241, v242
    v_max3_u32 v118, v118, v243, v244
    v_max3_u32 v118, v118, v245, v246
    v_max_u32 v118, v118, v247
    v_cmp_eq_u32 vcc, -1, v118
    v_mfma_f32_32x32x16_bf16 v[152:167], a[92:95], v[228:231], v[152:167]
    buffer_load_dwordx4 v[224:227], v101, s[4:7], s58 offen offset:0 sc1
    s_cbranch_vccnz L_g1slow_99
L_g1back_100:
    s_nop 0
    v_mfma_f32_32x32x16_bf16 v[120:135], a[96:99], v[232:235], v[120:135]
    buffer_load_dwordx4 v[228:231], v102, s[4:7], s58 offen offset:0 sc1
    v_mfma_f32_32x32x16_bf16 v[152:167], a[100:103], v[232:235], v[152:167]
    buffer_load_dwordx4 v[232:235], v89, s[4:7], s59 offen offset:0 sc1
    v_mfma_f32_32x32x16_bf16 v[120:135], a[104:107], v[236:239], v[120:135]
    v_mfma_f32_32x32x16_bf16 v[152:167], a[108:111], v[236:239], v[152:167]
    buffer_load_dwordx4 v[236:239], v100, s[4:7], s59 offen offset:0 sc1
    v_mfma_f32_32x32x16_bf16 v[120:135], a[112:115], v[240:243], v[120:135]
    v_mfma_f32_32x32x16_bf16 v[152:167], a[116:119], v[240:243], v[152:167]
    s_waitcnt vmcnt(10)
    s_nop 0
    v_max3_u32 v118, v184, v185, v186
    v_max3_u32 v118, v118, v187, v188
    v_max3_u32 v118, v118, v189, v190
    v_max3_u32 v118, v118, v191, v192
    v_mfma_f32_32x32x16_bf16 v[120:135], a[120:123], v[244:247], v[120:135]
    v_max3_u32 v118, v118, v193, v194
    v_max3_u32 v118, v118, v195, v196
    v_max3_u32 v118, v118, v197, v198
    v_max_u32 v118, v118, v199
    v_cmp_eq_u32 vcc, -1, v118
    v_mfma_f32_32x32x16_bf16 v[152:167], a[124:127], v[244:247], v[152:167]
    buffer_load_dwordx4 v[240:243], v101, s[4:7], s59 offen offset:0 sc1
    s_cbranch_vccnz L_g1slow_101
L_g1back_102:
    s_nop 0
    v_mfma_f32_32x32x16_bf16 v[120:135], a[128:131], v[184:187], v[120:135]
    buffer_load_dwordx4 v[244:247], v102, s[4:7], s59 offen offset:0 sc1
    v_mfma_f32_32x32x16_bf16 v[152:167], a[132:135], v[184:187], v[152:167]
    buffer_load_dwordx4 v[184:187], v89, s[4:7], s24 offen offset:512 sc1
    v_mfma_f32_32x32x16_bf16 v[120:135], a[136:139], v[188:191], v[120:135]
    s_add_u32 m0, s88, 8192
    s_nop 0
    s_nop 0
    buffer_load_dwordx4 v117, s[20:23], s62 offen lds
    v_mfma_f32_32x32x16_bf16 v[152:167], a[140:143], v[188:191], v[152:167]
    buffer_load_dwordx4 v[188:191], v100, s[4:7], s24 offen offset:512 sc1
    v_mfma_f32_32x32x16_bf16 v[120:135], a[144:147], v[192:195], v[120:135]
    s_add_u32 m0, s88, 9216
    s_add_u32 s62, s62, 32768
    buffer_load_dwordx4 v117, s[20:23], s62 offen lds
    v_mfma_f32_32x32x16_bf16 v[152:167], a[148:151], v[192:195], v[152:167]
    s_waitcnt vmcnt(12)
    s_nop 0
    v_max3_u32 v118, v200, v201, v202
    v_max3_u32 v118, v118, v203, v204
    v_max3_u32 v118, v118, v205, v206
    v_max3_u32 v118, v118, v207, v208
    v_mfma_f32_32x32x16_bf16 v[120:135], a[152:155], v[196:199], v[120:135]
    v_max3_u32 v118, v118, v209, v210
    v_max3_u32 v118, v118, v211, v212
    v_max3_u32 v118, v118, v213, v214
    v_max_u32 v118, v118, v215
    v_cmp_eq_u32 vcc, -1, v118
    v_mfma_f32_32x32x16_bf16 v[152:167], a[156:159], v[196:199], v[152:167]
    buffer_load_dwordx4 v[192:195], v101, s[4:7], s24 offen offset:512 sc1
    s_cbranch_vccnz L_g1slow_103
L_g1back_104:
    s_nop 0
    v_mfma_f32_32x32x16_bf16 v[120:135], a[160:163], v[200:203], v[120:135]
    buffer_load_dwordx4 v[196:199], v102, s[4:7], s24 offen offset:512 sc1
    v_mfma_f32_32x32x16_bf16 v[152:167], a[164:167], v[200:203], v[152:167]
    buffer_load_dwordx4 v[200:203], v89, s[4:7], s25 offen offset:512 sc1
    v_mfma_f32_32x32x16_bf16 v[120:135], a[168:171], v[204:207], v[120:135]
    s_add_u32 m0, s88, 10240
    s_add_u32 s62, s62, 32768
    buffer_load_dwordx4 v117, s[20:23], s62 offen lds
    v_mfma_f32_32x32x16_bf16 v[152:167], a[172:175], v[204:207], v[152:167]
    buffer_load_dwordx4 v[204:207], v100, s[4:7], s25 offen offset:512 sc1
    v_mfma_f32_32x32x16_bf16 v[120:135], a[176:179], v[208:211], v[120:135]
    s_add_u32 m0, s88, 11264
    s_add_u32 s62, s62, 32768
    buffer_load_dwordx4 v117, s[20:23], s62 offen lds
    v_mfma_f32_32x32x16_bf16 v[152:167], a[180:183], v[208:211], v[152:167]
    s_waitcnt vmcnt(14)
    s_nop 0
    v_max3_u32 v118, v216, v217, v218
    v_max3_u32 v118, v118, v219, v220
    v_max3_u32 v118, v118, v221, v222
    v_max3_u32 v118, v118, v223, v224
    v_mfma_f32_32x32x16_bf16 v[120:135], a[184:187], v[212:215], v[120:135]
    v_max3_u32 v118, v118, v225, v226
    v_max3_u32 v118, v118, v227, v228
    v_max3_u32 v118, v118, v229, v230
    v_max_u32 v118, v118, v231
    v_cmp_eq_u32 vcc, -1, v118
    v_mfma_f32_32x32x16_bf16 v[152:167], a[188:191], v[212:215], v[152:167]
    buffer_load_dwordx4 v[208:211], v101, s[4:7], s25 offen offset:512 sc1
    s_cbranch_vccnz L_g1slow_105
L_g1back_106:
    s_nop 0
    v_mfma_f32_32x32x16_bf16 v[120:135], a[192:195], v[216:219], v[120:135]
    buffer_load_dwordx4 v[212:215], v102, s[4:7], s25 offen offset:512 sc1
    v_mfma_f32_32x32x16_bf16 v[152:167], a[196:199], v[216:219], v[152:167]
    buffer_load_dwordx4 v[216:219], v89, s[4:7], s26 offen offset:512 sc1
    v_mfma_f32_32x32x16_bf16 v[120:135], a[200:203], v[220:223], v[120:135]
    s_add_u32 m0, s88, 12288
    s_nop 0
    s_nop 0
    buffer_load_dwordx4 v117, s[20:23], s63 offen lds
    v_mfma_f32_32x32x16_bf16 v[152:167], a[204:207], v[220:223], v[152:167]
    buffer_load_dwordx4 v[220:223], v100, s[4:7], s26 offen offset:512 sc1
    v_mfma_f32_32x32x16_bf16 v[120:135], a[208:211], v[224:227], v[120:135]
    s_add_u32 m0, s88, 13312
    s_add_u32 s63, s63, 32768
    buffer_load_dwordx4 v117, s[20:23], s63 offen lds
    v_mfma_f32_32x32x16_bf16 v[152:167], a[212:215], v[224:227], v[152:167]
    s_waitcnt vmcnt(16)
    s_nop 0
    v_max3_u32 v118, v232, v233, v234
    v_max3_u32 v118, v118, v235, v236
    v_max3_u32 v118, v118, v237, v238
    v_max3_u32 v118, v118, v239, v240
    v_mfma_f32_32x32x16_bf16 v[120:135], a[216:219], v[228:231], v[120:135]
    v_max3_u32 v118, v118, v241, v242
    v_max3_u32 v118, v118, v243, v244
    v_max3_u32 v118, v118, v245, v246
    v_max_u32 v118, v118, v247
    v_cmp_eq_u32 vcc, -1, v118
    v_mfma_f32_32x32x16_bf16 v[152:167], a[220:223], v[228:231], v[152:167]
    buffer_load_dwordx4 v[224:227], v101, s[4:7], s26 offen offset:512 sc1
    s_cbranch_vccnz L_g1slow_107
L_g1back_108:
    s_nop 0
    v_mfma_f32_32x32x16_bf16 v[120:135], a[224:227], v[232:235], v[120:135]
    buffer_load_dwordx4 v[228:231], v102, s[4:7], s26 offen offset:512 sc1
    v_mfma_f32_32x32x16_bf16 v[152:167], a[228:231], v[232:235], v[152:167]
    buffer_load_dwordx4 v[232:235], v89, s[4:7], s27 offen offset:512 sc1
    v_mfma_f32_32x32x16_bf16 v[120:135], a[232:235], v[236:239], v[120:135]
    s_add_u32 m0, s88, 14336
    s_add_u32 s63, s63, 32768
    buffer_load_dwordx4 v117, s[20:23], s63 offen lds
    v_mfma_f32_32x32x16_bf16 v[152:167], a[236:239], v[236:239], v[152:167]
    buffer_load_dwordx4 v[236:239], v100, s[4:7], s27 offen offset:512 sc1
    v_mfma_f32_32x32x16_bf16 v[120:135], a[240:243], v[240:243], v[120:135]
    s_add_u32 m0, s88, 15360
    s_add_u32 s63, s63, 32768
    buffer_load_dwordx4 v117, s[20:23], s63 offen lds
    v_mfma_f32_32x32x16_bf16 v[152:167], a[244:247], v[240:243], v[152:167]
    s_waitcnt vmcnt(16)
    s_nop 0
    v_max3_u32 v118, v184, v185, v186
    v_max3_u32 v118, v118, v187, v188
    v_max3_u32 v118, v118, v189, v190
    v_max3_u32 v118, v118, v191, v192
    v_mfma_f32_32x32x16_bf16 v[120:135], a[248:251], v[244:247], v[120:135]
    v_max3_u32 v118, v118, v193, v194
    v_max3_u32 v118, v118, v195, v196
    v_max3_u32 v118, v118, v197, v198
    v_max_u32 v118, v118, v199
    v_cmp_eq_u32 vcc, -1, v118
    v_mfma_f32_32x32x16_bf16 v[152:167], a[252:255], v[244:247], v[152:167]
    buffer_load_dwordx4 v[240:243], v101, s[4:7], s27 offen offset:512 sc1
    s_cbranch_vccnz L_g1slow_109
L_g1back_110:
    s_nop 0
    v_mfma_f32_32x32x16_bf16 v[136:151], a[0:3], v[184:187], 0
    buffer_load_dwordx4 v[244:247], v102, s[4:7], s27 offen offset:512 sc1
    v_mfma_f32_32x32x16_bf16 v[168:183], a[4:7], v[184:187], 0
    buffer_load_dwordx4 v[184:187], v89, s[4:7], s56 offen offset:512 sc1
    v_xor_b32_e64 v104, 0, v103
    ds_write_b128 v104, v[120:123]
    v_mfma_f32_32x32x16_bf16 v[136:151], a[8:11], v[188:191], v[136:151]
    v_xor_b32_e64 v105, 16, v103
    ds_write_b128 v105, v[124:127]
    v_mfma_f32_32x32x16_bf16 v[168:183], a[12:15], v[188:191], v[168:183]
    buffer_load_dwordx4 v[188:191], v100, s[4:7], s56 offen offset:512 sc1
    v_xor_b32_e64 v104, 32, v103
    ds_write_b128 v104, v[128:131]
    s_cmp_lg_u32 s3, 0
    s_cbranch_scc1 L_tok_111
    s_lshl_b32 s48, s84, 6
    s_lshl_b32 s49, s64, 14
    s_add_u32 s48, s48, s49
    s_add_u32 s48, s48, 25346048
    v_mov_b32 v104, s68
    v_mov_b32 v105, 0
    s_mov_b64 exec, 1
    buffer_store_dword v104, v105, s[4:7], s48 offen sc1
    s_mov_b64 exec, -1
L_tok_111:
    v_mfma_f32_32x32x16_bf16 v[136:151], a[16:19], v[192:195], v[136:151]
    v_xor_b32 v105, 48, v103
    ds_write_b128 v105, v[132:135]
    v_mfma_f32_32x32x16_bf16 v[168:183], a[20:23], v[192:195], v[168:183]
    s_waitcnt vmcnt(14)
    s_nop 0
    v_max3_u32 v118, v200, v201, v202
    v_max3_u32 v118, v118, v203, v204
    v_max3_u32 v118, v118, v205, v206
    v_max3_u32 v118, v118, v207, v208
    v_mfma_f32_32x32x16_bf16 v[136:151], a[24:27], v[196:199], v[136:151]
    v_max3_u32 v118, v118, v209, v210
    v_max3_u32 v118, v118, v211, v212
    v_max3_u32 v118, v118, v213, v214
    v_max_u32 v118, v118, v215
    v_cmp_eq_u32 vcc, -1, v118
    v_mfma_f32_32x32x16_bf16 v[168:183], a[28:31], v[196:199], v[168:183]
    buffer_load_dwordx4 v[192:195], v101, s[4:7], s56 offen offset:512 sc1
    v_xor_b32_e64 v104, 64, v103
    ds_write_b128 v104, v[152:155]
    s_cbranch_vccnz L_g1slow_112
L_g1back_113:
    s_nop 0
    v_mfma_f32_32x32x16_bf16 v[136:151], a[32:35], v[200:203], v[136:151]
    buffer_load_dwordx4 v[196:199], v102, s[4:7], s56 offen offset:512 sc1
    v_xor_b32 v105, 80, v103
    ds_write_b128 v105, v[156:159]
    v_mfma_f32_32x32x16_bf16 v[168:183], a[36:39], v[200:203], v[168:183]
    buffer_load_dwordx4 v[200:203], v89, s[4:7], s57 offen offset:512 sc1
    v_xor_b32 v104, 96, v103
    ds_write_b128 v104, v[160:163]
    v_mfma_f32_32x32x16_bf16 v[136:151], a[40:43], v[204:207], v[136:151]
    v_xor_b32 v105, 112, v103
    ds_write_b128 v105, v[164:167]
    v_mfma_f32_32x32x16_bf16 v[168:183], a[44:47], v[204:207], v[168:183]
    buffer_load_dwordx4 v[204:207], v100, s[4:7], s57 offen offset:512 sc1
    v_mfma_f32_32x32x16_bf16 v[136:151], a[48:51], v[208:211], v[136:151]
    s_waitcnt lgkmcnt(0)
    s_barrier
    ds_read_b128 v[120:123], v106 offset:0
    ds_read_b128 v[124:127], v107 offset:0
    ds_read_b128 v[128:131], v106 offset:16384
    v_mfma_f32_32x32x16_bf16 v[168:183], a[52:55], v[208:211], v[168:183]
    s_waitcnt vmcnt(12)
    s_nop 0
    v_max3_u32 v118, v216, v217, v218
    v_max3_u32 v118, v118, v219, v220
    v_max3_u32 v118, v118, v221, v222
    v_max3_u32 v118, v118, v223, v224
    v_mfma_f32_32x32x16_bf16 v[136:151], a[56:59], v[212:215], v[136:151]
    v_max3_u32 v118, v118, v225, v226
    v_max3_u32 v118, v118, v227, v228
    v_max3_u32 v118, v118, v229, v230
    v_max_u32 v118, v118, v231
    v_cmp_eq_u32 vcc, -1, v118
    v_mfma_f32_32x32x16_bf16 v[168:183], a[60:63], v[212:215], v[168:183]
    buffer_load_dwordx4 v[208:211], v101, s[4:7], s57 offen offset:512 sc1
    ds_read_b128 v[132:135], v107 offset:16384
    ds_read_b128 v[152:155], v106 offset:32768
    ds_read_b128 v[156:159], v107 offset:32768
    s_cbranch_vccnz L_g1slow_114
L_g1back_115:
    s_nop 0
    v_mfma_f32_32x32x16_bf16 v[136:151], a[64:67], v[216:219], v[136:151]
    buffer_load_dwordx4 v[212:215], v102, s[4:7], s57 offen offset:512 sc1
    ds_read_b128 v[160:163], v106 offset:49152
    ds_read_b128 v[164:167], v107 offset:49152
    v_mfma_f32_32x32x16_bf16 v[168:183], a[68:71], v[216:219], v[168:183]
    buffer_load_dwordx4 v[216:219], v89, s[4:7], s58 offen offset:512 sc1
    s_waitcnt lgkmcnt(4)
    v_add_f32 v120, v120, v108
    v_add_f32 v121, v121, v109
    v_add_f32 v122, v122, v110
    v_add_f32_e64 v123, v123, v111
    v_mfma_f32_32x32x16_bf16 v[136:151], a[72:75], v[220:223], v[136:151]
    v_add_f32 v124, v124, v112
    v_add_f32 v125, v125, v113
    v_add_f32 v126, v126, v114
    v_add_f32 v127, v127, v115
    v_add_f32 v120, v120, v128
    v_add_f32 v121, v121, v129
    v_add_f32_e64 v122, v122, v130
    v_mfma_f32_32x32x16_bf16 v[168:183], a[76:79], v[220:223], v[168:183]
    buffer_load_dwordx4 v[220:223], v100, s[4:7], s58 offen offset:512 sc1
    v_add_f32 v123, v123, v131
    v_add_f32 v124, v124, v132
    v_add_f32 v125, v125, v133
    v_add_f32 v126, v126, v134
    v_add_f32_e64 v127, v127, v135
    v_mfma_f32_32x32x16_bf16 v[136:151], a[80:83], v[224:227], v[136:151]
    s_waitcnt lgkmcnt(0)
    v_add_f32 v152, v152, v160
    v_add_f32 v153, v153, v161
    v_add_f32 v154, v154, v162
    v_add_f32 v155, v155, v163
    v_add_f32 v156, v156, v164
    v_add_f32_e64 v157, v157, v165
    v_mfma_f32_32x32x16_bf16 v[168:183], a[84:87], v[224:227], v[168:183]
    s_waitcnt vmcnt(10)
    s_nop 0
    v_max3_u32 v118, v232, v233, v234
    v_max3_u32 v118, v118, v235, v236
    v_max3_u32 v118, v118, v237, v238
    v_max3_u32 v118, v118, v239, v240
    v_mfma_f32_32x32x16_bf16 v[136:151], a[88:91], v[228:231], v[136:151]
    v_max3_u32 v118, v118, v241, v242
    v_max3_u32 v118, v118, v243, v244
    v_max3_u32 v118, v118, v245, v246
    v_max_u32 v118, v118, v247
    v_cmp_eq_u32 vcc, -1, v118
    v_mfma_f32_32x32x16_bf16 v[168:183], a[92:95], v[228:231], v[168:183]
    buffer_load_dwordx4 v[224:227], v101, s[4:7], s58 offen offset:512 sc1
    v_add_f32 v158, v158, v166
    v_add_f32 v159, v159, v167
    v_add_f32 v120, v120, v152
    v_add_f32 v121, v121, v153
    v_add_f32 v122, v122, v154
    s_cbranch_vccnz L_g1slow_116
L_g1back_117:
    v_mfma_f32_32x32x16_bf16 v[136:151], a[96:99], v[232:235], v[136:151]
    buffer_load_dwordx4 v[228:231], v102, s[4:7], s58 offen offset:512 sc1
    v_add_f32 v123, v123, v155
    v_add_f32 v124, v124, v156
    v_add_f32 v125, v125, v157
    v_add_f32 v126, v126, v158
    v_add_f32_e64 v127, v127, v159
    v_mfma_f32_32x32x16_bf16 v[168:183], a[100:103], v[232:235], v[168:183]
    buffer_load_dwordx4 v[232:235], v89, s[4:7], s59 offen offset:512 sc1
    v_mul_f32 v128, v120, v120
    v_mul_f32 v129, v121, v121
    v_mul_f32 v130, v122, v122
    v_mul_f32 v131, v123, v123
    v_mul_f32_e64 v132, v124, v124
    v_mfma_f32_32x32x16_bf16 v[136:151], a[104:107], v[236:239], v[136:151]
    v_mul_f32 v133, v125, v125
    v_mul_f32 v134, v126, v126
    v_mul_f32_e64 v135, v127, v127
    v_fma_f32 v128, v128, v85, v84
    v_fma_f32 v129, v129, v85, v84
    v_fma_f32 v130, v130, v85, v84
    v_fma_f32 v131, v131, v85, v84
    v_mfma_f32_32x32x16_bf16 v[168:183], a[108:111], v[236:239], v[168:183]
    buffer_load_dwordx4 v[236:239], v100, s[4:7], s59 offen offset:512 sc1
    v_fma_f32 v132, v132, v85, v84
    v_fma_f32 v133, v133, v85, v84
    v_fma_f32 v134, v134, v85, v84
    v_fma_f32 v135, v135, v85, v84
    v_mul_f32_e64 v128, v128, v120
    v_mfma_f32_32x32x16_bf16 v[136:151], a[112:115], v[240:243], v[136:151]
    v_mul_f32 v129, v129, v121
    v_mul_f32 v130, v130, v122
    v_mul_f32 v131, v131, v123
    v_mul_f32 v132, v132, v124
    v_mul_f32 v133, v133, v125
    v_mul_f32 v134, v134, v126
    v_mul_f32_e64 v135, v135, v127
    v_mfma_f32_32x32x16_bf16 v[168:183], a[116:119], v[240:243], v[168:183]
    s_waitcnt vmcnt(10)
    s_nop 0
    v_max3_u32 v118, v184, v185, v186
    v_max3_u32 v118, v118, v187, v188
    v_max3_u32 v118, v118, v189, v190
    v_max3_u32 v118, v118, v191, v192
    v_mfma_f32_32x32x16_bf16 v[136:151], a[120:123], v[244:247], v[136:151]
    v_max3_u32 v118, v118, v193, v194
    v_max3_u32 v118, v118, v195, v196
    v_max3_u32 v118, v118, v197, v198
    v_max_u32 v118, v118, v199
    v_cmp_eq_u32 vcc, -1, v118
    v_mfma_f32_32x32x16_bf16 v[168:183], a[124:127], v[244:247], v[168:183]
    buffer_load_dwordx4 v[240:243], v101, s[4:7], s59 offen offset:512 sc1
    v_exp_f32 v128, v128
    v_exp_f32 v129, v129
    s_cbranch_vccnz L_g1slow_118
L_g1back_119:
    v_mfma_f32_32x32x16_bf16 v[136:151], a[128:131], v[184:187], v[136:151]
    buffer_load_dwordx4 v[244:247], v102, s[4:7], s59 offen offset:512 sc1
    v_exp_f32 v130, v130
    v_exp_f32 v131, v131
    v_exp_f32 v132, v132
    v_mfma_f32_32x32x16_bf16 v[168:183], a[132:135], v[184:187], v[168:183]
    v_exp_f32 v133, v133
    v_exp_f32 v134, v134
    v_exp_f32 v135, v135
    v_add_f32 v128, 1.0, v128
    v_mfma_f32_32x32x16_bf16 v[136:151], a[136:139], v[188:191], v[136:151]
    v_add_f32 v129, 1.0, v129
    v_add_f32 v130, 1.0, v130
    v_add_f32 v131, 1.0, v131
    v_add_f32 v132, 1.0, v132
    v_add_f32 v133, 1.0, v133
    v_add_f32 v134, 1.0, v134
    v_add_f32_e64 v135, 1.0, v135
    v_mfma_f32_32x32x16_bf16 v[168:183], a[140:143], v[188:191], v[168:183]
    v_rcp_f32 v128, v128
    v_rcp_f32 v129, v129
    v_rcp_f32_e64 v130, v130
    v_mfma_f32_32x32x16_bf16 v[136:151], a[144:147], v[192:195], v[136:151]
    s_barrier
    v_rcp_f32 v131, v131
    v_rcp_f32 v132, v132
    v_rcp_f32 v133, v133
    v_mfma_f32_32x32x16_bf16 v[168:183], a[148:151], v[192:195], v[168:183]
    s_waitcnt vmcnt(8)
    s_nop 0
    v_max3_u32 v118, v200, v201, v202
    v_max3_u32 v118, v118, v203, v204
    v_max3_u32 v118, v118, v205, v206
    v_max3_u32 v118, v118, v207, v208
    v_mfma_f32_32x32x16_bf16 v[136:151], a[152:155], v[196:199], v[136:151]
    v_max3_u32 v118, v118, v209, v210
    v_max3_u32 v118, v118, v211, v212
    v_max3_u32 v118, v118, v213, v214
    v_max_u32 v118, v118, v215
    v_cmp_eq_u32 vcc, -1, v118
    v_mfma_f32_32x32x16_bf16 v[168:183], a[156:159], v[196:199], v[168:183]
    v_rcp_f32 v134, v134
    v_rcp_f32 v135, v135
    v_mul_f32 v120, v120, v128
    v_mul_f32 v121, v121, v129
    s_cbranch_vccnz L_g1slow_120
L_g1back_121:
    v_mfma_f32_32x32x16_bf16 v[136:151], a[160:163], v[200:203], v[136:151]
    v_mul_f32 v122, v122, v130
    v_mul_f32 v123, v123, v131
    v_mul_f32 v124, v124, v132
    v_mul_f32 v125, v125, v133
    v_mul_f32 v126, v126, v134
    v_mul_f32_e64 v127, v127, v135
    v_cvt_pk_bf16_f32 v160, v120, v121
    v_mfma_f32_32x32x16_bf16 v[168:183], a[164:167], v[200:203], v[168:183]
    v_cvt_pk_bf16_f32 v161, v122, v123
    v_cvt_pk_bf16_f32 v162, v124, v125
    v_cvt_pk_bf16_f32 v163, v126, v127
    v_min_u32 v160, -2, v160
    v_min_u32 v161, -2, v161
    v_min_u32 v162, -2, v162
    v_min_u32 v163, -2, v163
    v_mfma_f32_32x32x16_bf16 v[136:151], a[168:171], v[204:207], v[136:151]
    buffer_store_dwordx4 v[160:163], v89, s[4:7], s89 offen sc1
    v_mfma_f32_32x32x16_bf16 v[168:183], a[172:175], v[204:207], v[168:183]
    v_mfma_f32_32x32x16_bf16 v[136:151], a[176:179], v[208:211], v[136:151]
    v_mfma_f32_32x32x16_bf16 v[168:183], a[180:183], v[208:211], v[168:183]
    s_waitcnt vmcnt(5)
    s_nop 0
    v_max3_u32 v118, v216, v217, v218
    v_max3_u32 v118, v118, v219, v220
    v_max3_u32 v118, v118, v221, v222
    v_max3_u32 v118, v118, v223, v224
    v_mfma_f32_32x32x16_bf16 v[136:151], a[184:187], v[212:215], v[136:151]
    v_max3_u32 v118, v118, v225, v226
    v_max3_u32 v118, v118, v227, v228
    v_max3_u32 v118, v118, v229, v230
    v_max_u32 v118, v118, v231
    v_cmp_eq_u32 vcc, -1, v118
    v_mfma_f32_32x32x16_bf16 v[168:183], a[188:191], v[212:215], v[168:183]
    s_cbranch_vccnz L_g1slow_122
L_g1back_123:
    s_nop 0
    v_mfma_f32_32x32x16_bf16 v[136:151], a[192:195], v[216:219], v[136:151]
    v_mfma_f32_32x32x16_bf16 v[168:183], a[196:199], v[216:219], v[168:183]
    v_mfma_f32_32x32x16_bf16 v[136:151], a[200:203], v[220:223], v[136:151]
    v_mfma_f32_32x32x16_bf16 v[168:183], a[204:207], v[220:223], v[168:183]
    v_mfma_f32_32x32x16_bf16 v[136:151], a[208:211], v[224:227], v[136:151]
    v_mfma_f32_32x32x16_bf16 v[168:183], a[212:215], v[224:227], v[168:183]
    s_waitcnt vmcnt(1)
    s_nop 0
    v_max3_u32 v118, v232, v233, v234
    v_max3_u32 v118, v118, v235, v236
    v_max3_u32 v118, v118, v237, v238
    v_max3_u32 v118, v118, v239, v240
    v_mfma_f32_32x32x16_bf16 v[136:151], a[216:219], v[228:231], v[136:151]
    v_max3_u32 v118, v118, v241, v242
    v_max3_u32 v118, v118, v243, v244
    v_max3_u32 v118, v118, v245, v246
    v_max_u32 v118, v118, v247
    v_cmp_eq_u32 vcc, -1, v118
    v_mfma_f32_32x32x16_bf16 v[168:183], a[220:223], v[228:231], v[168:183]
    s_cbranch_vccnz L_g1slow_124
L_g1back_125:
    s_nop 0
    v_mfma_f32_32x32x16_bf16 v[136:151], a[224:227], v[232:235], v[136:151]
    v_mfma_f32_32x32x16_bf16 v[168:183], a[228:231], v[232:235], v[168:183]
    v_mfma_f32_32x32x16_bf16 v[136:151], a[232:235], v[236:239], v[136:151]
    v_mfma_f32_32x32x16_bf16 v[168:183], a[236:239], v[236:239], v[168:183]
    v_mfma_f32_32x32x16_bf16 v[136:151], a[240:243], v[240:243], v[136:151]
    v_mfma_f32_32x32x16_bf16 v[168:183], a[244:247], v[240:243], v[168:183]
    v_mfma_f32_32x32x16_bf16 v[136:151], a[248:251], v[244:247], v[136:151]
    v_mfma_f32_32x32x16_bf16 v[168:183], a[252:255], v[244:247], v[168:183]
L_g1j_56:
    v_xor_b32 v104, 0, v103
    s_nop 9
    ds_write_b128 v104, v[136:139]
    v_xor_b32_e64 v105, 16, v103
    ds_write_b128 v105, v[140:143]
    v_xor_b32_e64 v104, 32, v103
    ds_write_b128 v104, v[144:147]
    v_xor_b32_e64 v105, 48, v103
    ds_write_b128 v105, v[148:151]
    v_xor_b32_e64 v104, 64, v103
    ds_write_b128 v104, v[168:171]
    v_xor_b32 v105, 80, v103
    ds_write_b128 v105, v[172:175]
    v_xor_b32 v104, 96, v103
    ds_write_b128 v104, v[176:179]
    v_xor_b32 v105, 112, v103
    ds_write_b128 v105, v[180:183]
    s_waitcnt lgkmcnt(0)
    s_barrier
    buffer_load_dwordx4 v[184:187], v89, s[4:7], s32 offen offset:0 sc1
    buffer_load_dwordx4 v[188:191], v100, s[4:7], s32 offen offset:0 sc1
    buffer_load_dwordx4 v[192:195], v89, s[4:7], s33 offen offset:0 sc1
    buffer_load_dwordx4 v[196:199], v100, s[4:7], s33 offen offset:0 sc1
    buffer_load_dwordx4 v[200:203], v89, s[4:7], s34 offen offset:0 sc1
    buffer_load_dwordx4 v[204:207], v100, s[4:7], s34 offen offset:0 sc1
    buffer_load_dwordx4 v[208:211], v89, s[4:7], s35 offen offset:0 sc1
    buffer_load_dwordx4 v[212:215], v100, s[4:7], s35 offen offset:0 sc1
    ds_read_b128 v[136:139], v106 offset:0
    ds_read_b128 v[140:143], v107 offset:0
    ds_read_b128 v[144:147], v106 offset:16384
    ds_read_b128 v[148:151], v107 offset:16384
    ds_read_b128 v[168:171], v106 offset:32768
    ds_read_b128 v[172:175], v107 offset:32768
    ds_read_b128 v[176:179], v106 offset:49152
    ds_read_b128 v[180:183], v107 offset:49152
    s_waitcnt lgkmcnt(7)
    v_pk_add_f32 v[138:139], v[138:139], v[110:111]
    s_waitcnt lgkmcnt(6)
    v_pk_add_f32 v[140:141], v[140:141], v[112:113]
    s_waitcnt lgkmcnt(5)
    v_pk_add_f32 v[138:139], v[138:139], v[146:147]
    s_waitcnt lgkmcnt(4)
    v_pk_add_f32 v[140:141], v[140:141], v[148:149]
    v_pk_add_f32 v[142:143], v[142:143], v[114:115]
    v_pk_add_f32 v[136:137], v[136:137], v[108:109]
    v_pk_add_f32 v[142:143], v[142:143], v[150:151]
    v_pk_add_f32 v[136:137], v[136:137], v[144:145]
    s_waitcnt lgkmcnt(1)
    s_nop 0
    v_pk_add_f32 v[168:169], v[168:169], v[176:177]
    v_pk_add_f32 v[170:171], v[170:171], v[178:179]
    v_pk_add_f32 v[136:137], v[136:137], v[168:169]
    v_pk_add_f32 v[138:139], v[138:139], v[170:171]
    v_pk_mul_f32 v[144:145], v[136:137], v[136:137]
    s_waitcnt lgkmcnt(0)
    s_nop 0
    v_pk_add_f32 v[174:175], v[174:175], v[182:183]
    v_pk_fma_f32 v[144:145], v[144:145], v[84:85], v[84:85] op_sel:[0,1,0] op_sel_hi:[1,1,0]
    v_pk_add_f32 v[142:143], v[142:143], v[174:175]
    v_pk_mul_f32 v[144:145], v[144:145], v[136:137]
    v_pk_mul_f32 v[150:151], v[142:143], v[142:143]
    v_pk_add_f32 v[172:173], v[172:173], v[180:181]
    v_pk_mul_f32 v[146:147], v[138:139], v[138:139]
    v_pk_add_f32 v[140:141], v[140:141], v[172:173]
    v_pk_fma_f32 v[150:151], v[150:151], v[84:85], v[84:85] op_sel:[0,1,0] op_sel_hi:[1,1,0]
    v_pk_mul_f32 v[148:149], v[140:141], v[140:141]
    v_pk_mul_f32 v[150:151], v[150:151], v[142:143]
    v_pk_fma_f32 v[148:149], v[148:149], v[84:85], v[84:85] op_sel:[0,1,0] op_sel_hi:[1,1,0]
    v_pk_fma_f32 v[146:147], v[146:147], v[84:85], v[84:85] op_sel:[0,1,0] op_sel_hi:[1,1,0]
    v_pk_mul_f32 v[148:149], v[148:149], v[140:141]
    v_pk_mul_f32 v[146:147], v[146:147], v[138:139]
    v_exp_f32 v150, v150
    v_exp_f32 v147, v147
    v_exp_f32 v144, v144
    v_exp_f32 v151, v151
    v_exp_f32_e64 v145, v145
    v_pk_add_f32 v[150:151], v[150:151], 1.0 op_sel_hi:[1,0]
    v_pk_add_f32 v[144:145], v[144:145], 1.0 op_sel_hi:[1,0]
    v_exp_f32 v146, v146
    v_exp_f32 v149, v149
    v_pk_add_f32 v[146:147], v[146:147], 1.0 op_sel_hi:[1,0]
    v_rcp_f32 v145, v145
    v_rcp_f32 v150, v150
    v_exp_f32 v148, v148
    v_rcp_f32 v146, v146
    v_pk_add_f32 v[148:149], v[148:149], 1.0 op_sel_hi:[1,0]
    v_rcp_f32 v144, v144
    v_rcp_f32 v148, v148
    v_pk_mul_f32 v[136:137], v[136:137], v[144:145]
    v_rcp_f32 v149, v149
    v_rcp_f32 v151, v151
    v_pk_mul_f32 v[140:141], v[140:141], v[148:149]
    v_pk_mul_f32 v[142:143], v[142:143], v[150:151]
    v_rcp_f32_e64 v147, v147
    v_cvt_pk_bf16_f32 v179, v142, v143
    v_pk_mul_f32 v[138:139], v[138:139], v[146:147]
    v_cvt_pk_bf16_f32 v178, v140, v141
    v_cvt_pk_bf16_f32 v177, v138, v139
    v_min_u32 v178, -2, v178
    v_min_u32 v177, -2, v177
    v_cvt_pk_bf16_f32 v176, v136, v137
    v_min_u32 v179, -2, v179
    v_min_u32 v176, -2, v176
    buffer_store_dwordx4 v[176:179], v89, s[4:7], s89 offen offset:512 sc1
    s_branch L_g1end_51
L_g1obs_50:
    s_waitcnt vmcnt(0)
    s_barrier
    s_cmp_lg_u32 s3, 0
    s_cbranch_scc1 L_tok_126
    s_lshl_b32 s48, s2, 6
    s_lshl_b32 s49, s64, 14
    s_add_u32 s48, s48, s49
    s_add_u32 s48, s48, 25280512
    v_mov_b32 v104, s68
    v_mov_b32 v105, 0
    s_mov_b64 exec, 1
    buffer_store_dword v104, v105, s[4:7], s48 offen sc1
    s_mov_b64 exec, -1
L_tok_126:
    s_cmp_lg_u32 s64, 0
    s_cbranch_scc1 L_l0_127
    v_mov_b32 v120, -1
    v_mov_b32 v121, -1
    v_mov_b32 v122, -1
    v_mov_b32 v123, -1
    s_and_b32 s55, s74, 31
    s_and_b32 s53, s74, 1
    s_mul_i32 s53, s53, 11
    s_add_u32 s50, s80, s53
    s_sub_u32 s50, s50, 28
    s_mul_i32 s50, s50, 120
    s_add_u32 s50, s50, s3
    s_lshl_b32 s50, s50, 12
    s_lshl_b32 s53, s81, 10
    s_add_u32 s50, s50, s53
    s_lshl_b32 m0, s3, 10
    s_mov_b32 s54, 6
L_pf2_130:
    buffer_load_dwordx4 v45, s[20:23], s50 offen lds
    s_add_u32 s50, s50, 16384
    s_sub_u32 s54, s54, 1
    s_cmp_lg_u32 s54, 0
    s_cbranch_scc1 L_pf2_130
    s_cmp_lg_u32 s71, 0
    s_cbranch_scc1 L_pf20_128
    s_mul_i32 s52, s55, 53248
    s_add_u32 s52, s52, 6029312
    s_lshl_b32 s53, s3, 10
    s_add_u32 s52, s52, s53
    s_mov_b32 s54, 13
L_pois_131:
    buffer_store_dwordx4 v[120:123], v45, s[4:7], s52 offen sc1
    s_add_u32 s52, s52, 4096
    s_sub_u32 s54, s54, 1
    s_cmp_lg_u32 s54, 0
    s_cbranch_scc1 L_pois_131
    s_mov_b32 s54, 6
L_pf2_132:
    buffer_load_dwordx4 v45, s[20:23], s50 offen lds
    s_add_u32 s50, s50, 16384
    s_sub_u32 s54, s54, 1
    s_cmp_lg_u32 s54, 0
    s_cbranch_scc1 L_pf2_132
    s_waitcnt vmcnt(6)
    s_barrier
    s_cmp_lg_u32 s3, 0
    s_cbranch_scc1 L_tok_133
    s_lshl_b32 s48, s55, 6
    s_add_u32 s48, s48, 25264128
    v_mov_b32 v106, s68
    v_mov_b32 v107, 0
    s_mov_b64 exec, 1
    buffer_store_dword v106, v107, s[4:7], s48 offen sc1
    s_mov_b64 exec, -1
L_tok_133:
    s_mov_b32 s54, 18
L_pf2_134:
    buffer_load_dwordx4 v45, s[20:23], s50 offen lds
    s_add_u32 s50, s50, 16384
    s_sub_u32 s54, s54, 1
    s_cmp_lg_u32 s54, 0
    s_cbranch_scc1 L_pf2_134
    s_branch L_pf21_129
L_pf20_128:
    s_mov_b32 s54, 24
L_pf2_135:
    buffer_load_dwordx4 v45, s[20:23], s50 offen lds
    s_add_u32 s50, s50, 16384
    s_sub_u32 s54, s54, 1
    s_cmp_lg_u32 s54, 0
    s_cbranch_scc1 L_pf2_135
L_pf21_129:
    s_cmp_eq_u32 s71, 0
    s_cbranch_scc1 L_now2a_136
    v_lshrrev_b32_e64 v118, 3, v1
    v_lshl_add_u32 v118, v118, 12, v92
    s_mul_i32 s53, s3, 24576
    s_add_u32 m0, s53, 65536
    s_lshl_b32 s52, s83, 2
    s_mov_b32 s54, 24
L_w2a_137:
    s_lshl_b32 s53, s52, 15
    s_add_u32 s53, s53, s90
    buffer_load_dwordx4 v118, s[20:23], s53 offen  lds
    s_add_u32 m0, m0, 1024
    s_add_u32 s52, s52, 1
    s_cmp_eq_u32 s52, 56
    s_cselect_b32 s52, 0, s52
    s_sub_u32 s54, s54, 1
    s_cmp_lg_u32 s54, 0
    s_cbranch_scc1 L_w2a_137
    s_mov_b32 s66, 0
L_fw_138:
    v_and_b32 v107, 31, v1
    v_lshlrev_b32_e64 v107, 6, v107
    s_mov_b32 s48, 25264128
    buffer_load_dword v106, v107, s[4:7], s48 offen sc1
L_fwc_140:
    s_waitcnt vmcnt(0)
    v_cmp_ne_u32 vcc, s68, v106
    s_cbranch_vccz L_fwd_139
    s_add_u32 s66, s66, 1
    s_cmp_lt_u32 s66, s67
    s_sleep 8
    s_cbranch_scc1 L_fw_138
    s_mov_b32 s67, 1
L_fwd_139:
    s_branch L_l0_127
L_now2a_136:
    s_mov_b32 s66, 0
L_fw_141:
    s_mov_b32 s48, 25280512
    v_lshlrev_b32_e64 v107, 6, v0
    buffer_load_dword v106, v107, s[4:7], s48 offen sc1
L_fwc_143:
    s_waitcnt vmcnt(0)
    v_cmp_ne_u32 vcc, s68, v106
    s_cbranch_vccz L_fwd_142
    s_add_u32 s66, s66, 1
    s_cmp_lt_u32 s66, s67
    s_sleep 8
    s_cbranch_scc1 L_fw_141
    s_mov_b32 s67, 1
L_fwd_142:
    s_barrier
    s_mul_i32 s52, s55, 65536
    s_add_u32 s52, s52, 23068672
    s_lshl_b32 s53, s3, 10
    s_add_u32 s52, s52, s53
    s_mov_b32 s54, 16
L_pois_144:
    buffer_store_dwordx4 v[120:123], v45, s[4:7], s52 offen sc1
    s_add_u32 s52, s52, 4096
    s_sub_u32 s54, s54, 1
    s_cmp_lg_u32 s54, 0
    s_cbranch_scc1 L_pois_144
    s_mul_i32 s52, s55, 65536
    s_add_u32 s52, s52, 0
    s_lshl_b32 s53, s3, 10
    s_add_u32 s52, s52, s53
    s_mov_b32 s54, 16
L_pois_145:
    buffer_store_dwordx4 v[120:123], v45, s[4:7], s52 offen sc1
    s_add_u32 s52, s52, 4096
    s_sub_u32 s54, s54, 1
    s_cmp_lg_u32 s54, 0
    s_cbranch_scc1 L_pois_145
    s_waitcnt vmcnt(0)
    s_barrier
    s_cmp_lg_u32 s3, 0
    s_cbranch_scc1 L_tok_146
    s_lshl_b32 s48, s55, 6
    s_add_u32 s48, s48, 25231360
    v_mov_b32 v106, s68
    v_mov_b32 v107, 0
    s_mov_b64 exec, 1
    buffer_store_dword v106, v107, s[4:7], s48 offen sc1
    s_mov_b64 exec, -1
L_tok_146:
    s_mul_i32 s52, s55, 65536
    s_add_u32 s52, s52, 14680064
    s_lshl_b32 s53, s3, 10
    s_add_u32 s52, s52, s53
    s_mov_b32 s54, 16
L_pois_148:
    buffer_store_dwordx4 v[120:123], v45, s[4:7], s52 offen sc1
    s_add_u32 s52, s52, 4096
    s_sub_u32 s54, s54, 1
    s_cmp_lg_u32 s54, 0
    s_cbranch_scc1 L_pois_148
    s_waitcnt vmcnt(0)
    s_barrier
    s_cmp_lg_u32 s3, 0
    s_cbranch_scc1 L_pois3_147
    s_mul_i32 s48, s55, 448
    s_add_u32 s48, s48, 25214976
    v_mov_b32 v106, s68
    v_lshlrev_b32_e64 v107, 6, v1
    s_mov_b64 exec, 0x7f
    buffer_store_dword v106, v107, s[4:7], s48 offen sc1
    s_mov_b64 exec, -1
L_pois3_147:
    s_branch L_g1end_51
L_l0_127:
    s_cmp_eq_u32 s71, 0
    s_cbranch_scc1 L_g1end_51
    v_lshrrev_b32_e64 v104, 3, v1
    v_lshl_add_u32 v104, v104, 12, v92
    s_add_u32 m0, s88, 8192
    s_nop 0
    s_nop 0
    buffer_load_dwordx4 v104, s[20:23], s62 offen lds
    s_add_u32 m0, s88, 9216
    s_add_u32 s62, s62, 32768
    buffer_load_dwordx4 v104, s[20:23], s62 offen lds
    s_add_u32 m0, s88, 10240
    s_add_u32 s62, s62, 32768
    buffer_load_dwordx4 v104, s[20:23], s62 offen lds
    s_add_u32 m0, s88, 11264
    s_add_u32 s62, s62, 32768
    buffer_load_dwordx4 v104, s[20:23], s62 offen lds
    s_add_u32 m0, s88, 12288
    s_nop 0
    s_nop 0
    buffer_load_dwordx4 v104, s[20:23], s63 offen lds
    s_add_u32 m0, s88, 13312
    s_add_u32 s63, s63, 32768
    buffer_load_dwordx4 v104, s[20:23], s63 offen lds
    s_add_u32 m0, s88, 14336
    s_add_u32 s63, s63, 32768
    buffer_load_dwordx4 v104, s[20:23], s63 offen lds
    s_add_u32 m0, s88, 15360
    s_add_u32 s63, s63, 32768
    buffer_load_dwordx4 v104, s[20:23], s63 offen lds
    s_cmp_eq_u32 s64, 0
    s_cbranch_scc1 L_h10_149
    s_sleep 40
L_h10_149:
    s_mov_b32 s66, 0
L_fw_150:
    s_mov_b32 s48, 25346048
    s_lshl_b32 s49, s64, 14
    s_add_u32 s48, s48, s49
    v_lshlrev_b32_e64 v105, 6, v0
    v_min_u32 v105, 12480, v105
    buffer_load_dword v104, v105, s[4:7], s48 offen sc1
L_fwc_152:
    s_waitcnt vmcnt(0)
    v_cmp_ne_u32 vcc, s68, v104
    s_cbranch_vccz L_fwd_151
    s_add_u32 s66, s66, 1
    s_cmp_lt_u32 s66, s67
    s_sleep 4
    s_cbranch_scc1 L_fw_150
    s_mov_b32 s67, 1
L_fwd_151:
    s_barrier
    s_sleep 6
    buffer_load_dwordx4 v[184:187], v89, s[4:7], s32 offen offset:0 sc1
    buffer_load_dwordx4 v[188:191], v100, s[4:7], s32 offen offset:0 sc1
    buffer_load_dwordx4 v[192:195], v89, s[4:7], s33 offen offset:0 sc1
    buffer_load_dwordx4 v[196:199], v100, s[4:7], s33 offen offset:0 sc1
    buffer_load_dwordx4 v[200:203], v89, s[4:7], s34 offen offset:0 sc1
    buffer_load_dwordx4 v[204:207], v100, s[4:7], s34 offen offset:0 sc1
    buffer_load_dwordx4 v[208:211], v89, s[4:7], s35 offen offset:0 sc1
    buffer_load_dwordx4 v[212:215], v100, s[4:7], s35 offen offset:0 sc1
L_g1end_51:
    s_cmp_eq_u32 s71, 0
    s_cbranch_scc1 L_g2no_154
    s_mul_i32 s48, s3, 24576
    s_add_u32 s48, s48, 65536
    v_add_u32 v106, s48, v90
    v_add_u32 v107, s48, v91
    v_lshrrev_b32_e64 v103, 3, v1
    v_mul_u32_u24 v101, 896, v103
    v_lshl_add_u32 v103, v103, 12, v92
    v_add_u32 v118, s88, v90
    v_add_u32 v119, s88, v91
    s_mov_b32 s66, 0
    s_nop 0
    buffer_load_dwordx4 v[216:219], v89, s[4:7], s36 offen offset:0 sc1
    buffer_load_dwordx4 v[220:223], v100, s[4:7], s36 offen offset:0 sc1
    buffer_load_dwordx4 v[224:227], v89, s[4:7], s37 offen offset:0 sc1
    buffer_load_dwordx4 v[228:231], v100, s[4:7], s37 offen offset:0 sc1
    s_waitcnt vmcnt(12)
    s_nop 0
    ds_read_b64_tr_b16 v[232:233], v106 offset:0
    ds_read_b64_tr_b16 v[234:235], v106 offset:512
    ds_read_b64_tr_b16 v[236:237], v107 offset:0
    ds_read_b64_tr_b16 v[238:239], v107 offset:512
    s_barrier
    v_lshlrev_b32 v105, 6, v1
    s_and_b32 s48, s77, 255
    s_lshl_b32 s48, s48, 6
    s_lshl_b32 s49, s64, 14
    s_add_u32 s48, s48, s49
    s_add_u32 s48, s48, 25280512
    buffer_load_dword v104, v105, s[4:7], s48 offen sc1
    s_waitcnt vmcnt(9)
    v_max3_u32 v117, v184, v185, v186
    v_max3_u32 v117, v117, v187, v188
    v_max3_u32 v117, v117, v189, v190
    v_max3_u32 v117, v117, v191, v192
    v_max3_u32 v117, v117, v193, v194
    v_max3_u32 v117, v117, v195, v196
    v_max3_u32 v117, v117, v197, v198
    v_max_u32 v117, v117, v199
    v_cmp_eq_u32 vcc, -1, v117
    s_cbranch_vccnz L_g2slow_155
L_g2back_156:
    s_waitcnt lgkmcnt(0)
    v_mfma_f32_32x32x16_bf16 v[120:135], v[184:187], v[232:235], 0
    ds_read_b64_tr_b16 v[240:241], v106 offset:2048
    ds_read_b64_tr_b16 v[242:243], v106 offset:2560
    ds_read_b64_tr_b16 v[244:245], v107 offset:2048
    ds_read_b64_tr_b16 v[246:247], v107 offset:2560
    v_mfma_f32_32x32x16_bf16 v[136:151], v[184:187], v[236:239], 0
    buffer_load_dwordx4 v[184:187], v89, s[4:7], s40 offen offset:0 sc1
    s_add_u32 m0, s88, 0
    s_nop 0
    buffer_load_dwordx4 v103, s[20:23], s60 offen lds
    s_waitcnt lgkmcnt(0)
    s_nop 0
    v_mfma_f32_32x32x16_bf16 v[120:135], v[188:191], v[240:243], v[120:135]
    ds_read_b64_tr_b16 v[232:233], v106 offset:4096
    ds_read_b64_tr_b16 v[234:235], v106 offset:4608
    ds_read_b64_tr_b16 v[236:237], v107 offset:4096
    ds_read_b64_tr_b16 v[238:239], v107 offset:4608
    v_mfma_f32_32x32x16_bf16 v[136:151], v[188:191], v[244:247], v[136:151]
    buffer_load_dwordx4 v[188:191], v100, s[4:7], s40 offen offset:0 sc1
    s_add_u32 m0, s88, 1024
    s_add_u32 s60, s60, 32768
    buffer_load_dwordx4 v103, s[20:23], s60 offen lds
    s_waitcnt lgkmcnt(0)
    s_nop 0
    v_mfma_f32_32x32x16_bf16 v[120:135], v[192:195], v[232:235], v[120:135]
    ds_read_b64_tr_b16 v[240:241], v106 offset:6144
    ds_read_b64_tr_b16 v[242:243], v106 offset:6656
    ds_read_b64_tr_b16 v[244:245], v107 offset:6144
    ds_read_b64_tr_b16 v[246:247], v107 offset:6656
    v_mfma_f32_32x32x16_bf16 v[136:151], v[192:195], v[236:239], v[136:151]
    s_waitcnt vmcnt(9)
    s_nop 0
    v_max3_u32 v117, v200, v201, v202
    v_max3_u32 v117, v117, v203, v204
    v_max3_u32 v117, v117, v205, v206
    v_max3_u32 v117, v117, v207, v208
    s_add_u32 m0, s88, 2048
    s_add_u32 s60, s60, 32768
    buffer_load_dwordx4 v103, s[20:23], s60 offen lds
    s_waitcnt lgkmcnt(0)
    s_nop 0
    v_mfma_f32_32x32x16_bf16 v[120:135], v[196:199], v[240:243], v[120:135]
    v_max3_u32 v117, v117, v209, v210
    v_max3_u32 v117, v117, v211, v212
    v_max3_u32 v117, v117, v213, v214
    v_max_u32 v117, v117, v215
    v_cmp_eq_u32 vcc, -1, v117
    ds_read_b64_tr_b16 v[232:233], v106 offset:8192
    ds_read_b64_tr_b16 v[234:235], v106 offset:8704
    ds_read_b64_tr_b16 v[236:237], v107 offset:8192
    ds_read_b64_tr_b16 v[238:239], v107 offset:8704
    v_mfma_f32_32x32x16_bf16 v[136:151], v[196:199], v[244:247], v[136:151]
    buffer_load_dwordx4 v[192:195], v89, s[4:7], s41 offen offset:0 sc1
    s_add_u32 m0, s88, 3072
    s_add_u32 s60, s60, 32768
    buffer_load_dwordx4 v103, s[20:23], s60 offen lds
    s_cbranch_vccnz L_g2slow_157
L_g2back_158:
    s_waitcnt lgkmcnt(0)
    v_mfma_f32_32x32x16_bf16 v[120:135], v[200:203], v[232:235], v[120:135]
    buffer_load_dwordx4 v[196:199], v100, s[4:7], s41 offen offset:0 sc1
    ds_read_b64_tr_b16 v[240:241], v106 offset:10240
    ds_read_b64_tr_b16 v[242:243], v106 offset:10752
    ds_read_b64_tr_b16 v[244:245], v107 offset:10240
    ds_read_b64_tr_b16 v[246:247], v107 offset:10752
    v_mfma_f32_32x32x16_bf16 v[136:151], v[200:203], v[236:239], v[136:151]
    buffer_load_dwordx4 v[200:203], v89, s[4:7], s38 offen offset:0 sc1
    s_add_u32 m0, s88, 4096
    s_nop 0
    buffer_load_dwordx4 v103, s[20:23], s61 offen lds
    s_waitcnt lgkmcnt(0)
    v_mfma_f32_32x32x16_bf16 v[120:135], v[204:207], v[240:243], v[120:135]
    ds_read_b64_tr_b16 v[232:233], v106 offset:12288
    ds_read_b64_tr_b16 v[234:235], v106 offset:12800
    ds_read_b64_tr_b16 v[236:237], v107 offset:12288
    ds_read_b64_tr_b16 v[238:239], v107 offset:12800
    v_mfma_f32_32x32x16_bf16 v[136:151], v[204:207], v[244:247], v[136:151]
    buffer_load_dwordx4 v[204:207], v100, s[4:7], s38 offen offset:0 sc1
    s_add_u32 m0, s88, 5120
    s_add_u32 s61, s61, 32768
    buffer_load_dwordx4 v103, s[20:23], s61 offen lds
    s_waitcnt lgkmcnt(0)
    s_nop 0
    v_mfma_f32_32x32x16_bf16 v[120:135], v[208:211], v[232:235], v[120:135]
    ds_read_b64_tr_b16 v[240:241], v106 offset:14336
    ds_read_b64_tr_b16 v[242:243], v106 offset:14848
    ds_read_b64_tr_b16 v[244:245], v107 offset:14336
    ds_read_b64_tr_b16 v[246:247], v107 offset:14848
    v_mfma_f32_32x32x16_bf16 v[136:151], v[208:211], v[236:239], v[136:151]
    s_waitcnt vmcnt(13)
    s_nop 0
    v_max3_u32 v117, v216, v217, v218
    v_max3_u32 v117, v117, v219, v220
    v_max3_u32 v117, v117, v221, v222
    v_max3_u32 v117, v117, v223, v224
    s_add_u32 m0, s88, 6144
    s_add_u32 s61, s61, 32768
    buffer_load_dwordx4 v103, s[20:23], s61 offen lds
    s_waitcnt lgkmcnt(0)
    s_nop 0
    v_mfma_f32_32x32x16_bf16 v[120:135], v[212:215], v[240:243], v[120:135]
    v_max3_u32 v117, v117, v225, v226
    v_max3_u32 v117, v117, v227, v228
    v_max3_u32 v117, v117, v229, v230
    v_max_u32 v117, v117, v231
    v_cmp_eq_u32 vcc, -1, v117
    ds_read_b64_tr_b16 v[232:233], v106 offset:16384
    ds_read_b64_tr_b16 v[234:235], v106 offset:16896
    ds_read_b64_tr_b16 v[236:237], v107 offset:16384
    ds_read_b64_tr_b16 v[238:239], v107 offset:16896
    v_mfma_f32_32x32x16_bf16 v[136:151], v[212:215], v[244:247], v[136:151]
    buffer_load_dwordx4 v[208:211], v89, s[4:7], s39 offen offset:0 sc1
    s_add_u32 m0, s88, 7168
    s_add_u32 s61, s61, 32768
    buffer_load_dwordx4 v103, s[20:23], s61 offen lds
    s_cbranch_vccnz L_g2slow_159
L_g2back_160:
    s_waitcnt lgkmcnt(0)
    v_mfma_f32_32x32x16_bf16 v[120:135], v[216:219], v[232:235], v[120:135]
    buffer_load_dwordx4 v[212:215], v100, s[4:7], s39 offen offset:0 sc1
    ds_read_b64_tr_b16 v[240:241], v106 offset:18432
    ds_read_b64_tr_b16 v[242:243], v106 offset:18944
    ds_read_b64_tr_b16 v[244:245], v107 offset:18432
    ds_read_b64_tr_b16 v[246:247], v107 offset:18944
    v_mfma_f32_32x32x16_bf16 v[136:151], v[216:219], v[236:239], v[136:151]
    buffer_load_dwordx4 v[216:219], v89, s[4:7], s40 offen offset:512 sc1
    s_waitcnt lgkmcnt(0)
    s_nop 0
    v_mfma_f32_32x32x16_bf16 v[120:135], v[220:223], v[240:243], v[120:135]
    ds_read_b64_tr_b16 v[232:233], v106 offset:20480
    ds_read_b64_tr_b16 v[234:235], v106 offset:20992
    ds_read_b64_tr_b16 v[236:237], v107 offset:20480
    ds_read_b64_tr_b16 v[238:239], v107 offset:20992
    v_mfma_f32_32x32x16_bf16 v[136:151], v[220:223], v[244:247], v[136:151]
    buffer_load_dwordx4 v[220:223], v100, s[4:7], s40 offen offset:512 sc1
    s_waitcnt lgkmcnt(0)
    s_nop 0
    v_mfma_f32_32x32x16_bf16 v[120:135], v[224:227], v[232:235], v[120:135]
    ds_read_b64_tr_b16 v[240:241], v106 offset:22528
    ds_read_b64_tr_b16 v[242:243], v106 offset:23040
    ds_read_b64_tr_b16 v[244:245], v107 offset:22528
    ds_read_b64_tr_b16 v[246:247], v107 offset:23040
    v_mfma_f32_32x32x16_bf16 v[136:151], v[224:227], v[236:239], v[136:151]
    s_waitcnt vmcnt(10)
    s_nop 0
    v_max3_u32 v117, v184, v185, v186
    v_max3_u32 v117, v117, v187, v188
    v_max3_u32 v117, v117, v189, v190
    v_max3_u32 v117, v117, v191, v192
    s_waitcnt lgkmcnt(0)
    s_nop 0
    v_mfma_f32_32x32x16_bf16 v[120:135], v[228:231], v[240:243], v[120:135]
    v_max3_u32 v117, v117, v193, v194
    v_max3_u32 v117, v117, v195, v196
    v_max3_u32 v117, v117, v197, v198
    v_max_u32 v117, v117, v199
    v_cmp_eq_u32 vcc, -1, v117
    ds_read_b64_tr_b16 v[232:233], v118 offset:8192
    ds_read_b64_tr_b16 v[234:235], v118 offset:8704
    ds_read_b64_tr_b16 v[236:237], v119 offset:8192
    ds_read_b64_tr_b16 v[238:239], v119 offset:8704
    v_mfma_f32_32x32x16_bf16 v[136:151], v[228:231], v[244:247], v[136:151]
    buffer_load_dwordx4 v[224:227], v89, s[4:7], s41 offen offset:512 sc1
    s_cbranch_vccnz L_g2slow_161
L_g2back_162:
    s_waitcnt lgkmcnt(0)
    v_mfma_f32_32x32x16_bf16 v[120:135], v[184:187], v[232:235], v[120:135]
    buffer_load_dwordx4 v[228:231], v100, s[4:7], s41 offen offset:512 sc1
    ds_read_b64_tr_b16 v[240:241], v118 offset:10240
    ds_read_b64_tr_b16 v[242:243], v118 offset:10752
    ds_read_b64_tr_b16 v[244:245], v119 offset:10240
    ds_read_b64_tr_b16 v[246:247], v119 offset:10752
    v_mfma_f32_32x32x16_bf16 v[136:151], v[184:187], v[236:239], v[136:151]
    buffer_load_dwordx4 v[184:187], v89, s[4:7], s38 offen offset:512 sc1
    s_waitcnt lgkmcnt(0)
    s_nop 0
    v_mfma_f32_32x32x16_bf16 v[120:135], v[188:191], v[240:243], v[120:135]
    ds_read_b64_tr_b16 v[232:233], v118 offset:12288
    ds_read_b64_tr_b16 v[234:235], v118 offset:12800
    ds_read_b64_tr_b16 v[236:237], v119 offset:12288
    ds_read_b64_tr_b16 v[238:239], v119 offset:12800
    v_mfma_f32_32x32x16_bf16 v[136:151], v[188:191], v[244:247], v[136:151]
    buffer_load_dwordx4 v[188:191], v100, s[4:7], s38 offen offset:512 sc1
    s_waitcnt lgkmcnt(0)
    s_nop 0
    v_mfma_f32_32x32x16_bf16 v[120:135], v[192:195], v[232:235], v[120:135]
    ds_read_b64_tr_b16 v[240:241], v118 offset:14336
    ds_read_b64_tr_b16 v[242:243], v118 offset:14848
    ds_read_b64_tr_b16 v[244:245], v119 offset:14336
    ds_read_b64_tr_b16 v[246:247], v119 offset:14848
    v_mfma_f32_32x32x16_bf16 v[136:151], v[192:195], v[236:239], v[136:151]
    s_waitcnt vmcnt(6)
    s_nop 0
    v_max3_u32 v117, v200, v201, v202
    v_max3_u32 v117, v117, v203, v204
    v_max3_u32 v117, v117, v205, v206
    v_max3_u32 v117, v117, v207, v208
    s_waitcnt lgkmcnt(0)
    s_nop 0
    v_mfma_f32_32x32x16_bf16 v[120:135], v[196:199], v[240:243], v[120:135]
    v_max3_u32 v117, v117, v209, v210
    v_max3_u32 v117, v117, v211, v212
    v_max3_u32 v117, v117, v213, v214
    v_max_u32 v117, v117, v215
    v_cmp_eq_u32 vcc, -1, v117
    s_waitcnt vmcnt(15)
    s_nop 0
    ds_read_b64_tr_b16 v[232:233], v118 offset:0
    ds_read_b64_tr_b16 v[234:235], v118 offset:512
    ds_read_b64_tr_b16 v[236:237], v119 offset:0
    ds_read_b64_tr_b16 v[238:239], v119 offset:512
    v_mfma_f32_32x32x16_bf16 v[136:151], v[196:199], v[244:247], v[136:151]
    buffer_load_dwordx4 v[192:195], v89, s[4:7], s39 offen offset:512 sc1
    s_cbranch_vccnz L_g2slow_163
L_g2back_164:
    s_waitcnt lgkmcnt(0)
    v_mfma_f32_32x32x16_bf16 v[120:135], v[200:203], v[232:235], v[120:135]
    buffer_load_dwordx4 v[196:199], v100, s[4:7], s39 offen offset:512 sc1
    ds_read_b64_tr_b16 v[240:241], v118 offset:2048
    ds_read_b64_tr_b16 v[242:243], v118 offset:2560
    ds_read_b64_tr_b16 v[244:245], v119 offset:2048
    ds_read_b64_tr_b16 v[246:247], v119 offset:2560
    v_mfma_f32_32x32x16_bf16 v[136:151], v[200:203], v[236:239], v[136:151]
    buffer_load_dwordx4 v[200:203], v89, s[4:7], s32 offen offset:512 sc1
    s_waitcnt lgkmcnt(0)
    v_mfma_f32_32x32x16_bf16 v[120:135], v[204:207], v[240:243], v[120:135]
    s_waitcnt vmcnt(10)
    ds_read_b64_tr_b16 v[232:233], v118 offset:4096
    ds_read_b64_tr_b16 v[234:235], v118 offset:4608
    ds_read_b64_tr_b16 v[236:237], v119 offset:4096
    ds_read_b64_tr_b16 v[238:239], v119 offset:4608
    v_mfma_f32_32x32x16_bf16 v[136:151], v[204:207], v[244:247], v[136:151]
    buffer_load_dwordx4 v[204:207], v100, s[4:7], s32 offen offset:512 sc1
    s_waitcnt lgkmcnt(0)
    s_nop 0
    v_mfma_f32_32x32x16_bf16 v[120:135], v[208:211], v[232:235], v[120:135]
    ds_read_b64_tr_b16 v[240:241], v118 offset:6144
    ds_read_b64_tr_b16 v[242:243], v118 offset:6656
    ds_read_b64_tr_b16 v[244:245], v119 offset:6144
    ds_read_b64_tr_b16 v[246:247], v119 offset:6656
    v_mfma_f32_32x32x16_bf16 v[136:151], v[208:211], v[236:239], v[136:151]
    s_waitcnt vmcnt(6)
    s_nop 0
    v_max3_u32 v117, v216, v217, v218
    v_max3_u32 v117, v117, v219, v220
    v_max3_u32 v117, v117, v221, v222
    v_max3_u32 v117, v117, v223, v224
    s_waitcnt lgkmcnt(0)
    s_nop 0
    v_mfma_f32_32x32x16_bf16 v[120:135], v[212:215], v[240:243], v[120:135]
    v_max3_u32 v117, v117, v225, v226
    v_max3_u32 v117, v117, v227, v228
    v_max3_u32 v117, v117, v229, v230
    v_max_u32 v117, v117, v231
    v_cmp_eq_u32 vcc, -1, v117
    ds_read_b64_tr_b16 v[232:233], v118 offset:8192
    ds_read_b64_tr_b16 v[234:235], v118 offset:8704
    ds_read_b64_tr_b16 v[236:237], v119 offset:8192
    ds_read_b64_tr_b16 v[238:239], v119 offset:8704
    v_mfma_f32_32x32x16_bf16 v[136:151], v[212:215], v[244:247], v[136:151]
    buffer_load_dwordx4 v[208:211], v89, s[4:7], s33 offen offset:512 sc1
    s_cbranch_vccnz L_g2slow_165
L_g2back_166:
    s_waitcnt lgkmcnt(0)
    v_mfma_f32_32x32x16_bf16 v[152:167], v[216:219], v[232:235], 0
    buffer_load_dwordx4 v[212:215], v100, s[4:7], s33 offen offset:512 sc1
    ds_read_b64_tr_b16 v[240:241], v118 offset:10240
    ds_read_b64_tr_b16 v[242:243], v118 offset:10752
    ds_read_b64_tr_b16 v[244:245], v119 offset:10240
    ds_read_b64_tr_b16 v[246:247], v119 offset:10752
    v_mfma_f32_32x32x16_bf16 v[168:183], v[216:219], v[236:239], 0
    buffer_load_dwordx4 v[216:219], v89, s[4:7], s34 offen offset:512 sc1
    s_waitcnt lgkmcnt(0)
    s_nop 0
    v_mfma_f32_32x32x16_bf16 v[152:167], v[220:223], v[240:243], v[152:167]
    ds_read_b64_tr_b16 v[232:233], v118 offset:12288
    ds_read_b64_tr_b16 v[234:235], v118 offset:12800
    ds_read_b64_tr_b16 v[236:237], v119 offset:12288
    ds_read_b64_tr_b16 v[238:239], v119 offset:12800
    v_mfma_f32_32x32x16_bf16 v[168:183], v[220:223], v[244:247], v[168:183]
    buffer_load_dwordx4 v[220:223], v100, s[4:7], s34 offen offset:512 sc1
    s_waitcnt lgkmcnt(0)
    s_nop 0
    v_mfma_f32_32x32x16_bf16 v[152:167], v[224:227], v[232:235], v[152:167]
    ds_read_b64_tr_b16 v[240:241], v118 offset:14336
    ds_read_b64_tr_b16 v[242:243], v118 offset:14848
    ds_read_b64_tr_b16 v[244:245], v119 offset:14336
    ds_read_b64_tr_b16 v[246:247], v119 offset:14848
    v_mfma_f32_32x32x16_bf16 v[168:183], v[224:227], v[236:239], v[168:183]
    s_waitcnt vmcnt(6)
    s_nop 0
    v_max3_u32 v117, v184, v185, v186
    v_max3_u32 v117, v117, v187, v188
    v_max3_u32 v117, v117, v189, v190
    v_max3_u32 v117, v117, v191, v192
    s_waitcnt lgkmcnt(0)
    s_nop 0
    v_mfma_f32_32x32x16_bf16 v[152:167], v[228:231], v[240:243], v[152:167]
    v_max3_u32 v117, v117, v193, v194
    v_max3_u32 v117, v117, v195, v196
    v_max3_u32 v117, v117, v197, v198
    v_max_u32 v117, v117, v199
    v_cmp_eq_u32 vcc, -1, v117
    ds_read_b64_tr_b16 v[232:233], v118 offset:0
    ds_read_b64_tr_b16 v[234:235], v118 offset:512
    ds_read_b64_tr_b16 v[236:237], v119 offset:0
    ds_read_b64_tr_b16 v[238:239], v119 offset:512
    v_mfma_f32_32x32x16_bf16 v[168:183], v[228:231], v[244:247], v[168:183]
    buffer_load_dwordx4 v[224:227], v89, s[4:7], s35 offen offset:512 sc1
    s_cbranch_vccnz L_g2slow_167
L_g2back_168:
    s_waitcnt lgkmcnt(0)
    v_mfma_f32_32x32x16_bf16 v[152:167], v[184:187], v[232:235], v[152:167]
    buffer_load_dwordx4 v[228:231], v100, s[4:7], s35 offen offset:512 sc1
    ds_read_b64_tr_b16 v[240:241], v118 offset:2048
    ds_read_b64_tr_b16 v[242:243], v118 offset:2560
    ds_read_b64_tr_b16 v[244:245], v119 offset:2048
    ds_read_b64_tr_b16 v[246:247], v119 offset:2560
    v_mfma_f32_32x32x16_bf16 v[168:183], v[184:187], v[236:239], v[168:183]
    buffer_load_dwordx4 v[184:187], v89, s[4:7], s36 offen offset:512 sc1
    s_add_u32 m0, s88, 8192
    s_nop 0
    s_nop 0
    buffer_load_dwordx4 v103, s[20:23], s28 offen lds
    s_add_u32 m0, s88, 9216
    s_add_u32 s28, s28, 32768
    buffer_load_dwordx4 v103, s[20:23], s28 offen lds
    s_waitcnt lgkmcnt(0)
    s_nop 0
    v_mfma_f32_32x32x16_bf16 v[152:167], v[188:191], v[240:243], v[152:167]
    ds_read_b64_tr_b16 v[232:233], v118 offset:4096
    ds_read_b64_tr_b16 v[234:235], v118 offset:4608
    ds_read_b64_tr_b16 v[236:237], v119 offset:4096
    ds_read_b64_tr_b16 v[238:239], v119 offset:4608
    v_mfma_f32_32x32x16_bf16 v[168:183], v[188:191], v[244:247], v[168:183]
    buffer_load_dwordx4 v[188:191], v100, s[4:7], s36 offen offset:512 sc1
    s_add_u32 m0, s88, 10240
    s_add_u32 s28, s28, 32768
    buffer_load_dwordx4 v103, s[20:23], s28 offen lds
    s_add_u32 m0, s88, 11264
    s_add_u32 s28, s28, 32768
    buffer_load_dwordx4 v103, s[20:23], s28 offen lds
    s_waitcnt lgkmcnt(0)
    s_nop 0
    v_mfma_f32_32x32x16_bf16 v[152:167], v[192:195], v[232:235], v[152:167]
    ds_read_b64_tr_b16 v[240:241], v118 offset:6144
    ds_read_b64_tr_b16 v[242:243], v118 offset:6656
    ds_read_b64_tr_b16 v[244:245], v119 offset:6144
    ds_read_b64_tr_b16 v[246:247], v119 offset:6656
    v_mfma_f32_32x32x16_bf16 v[168:183], v[192:195], v[236:239], v[168:183]
    s_waitcnt vmcnt(10)
    s_nop 0
    v_max3_u32 v117, v200, v201, v202
    v_max3_u32 v117, v117, v203, v204
    v_max3_u32 v117, v117, v205, v206
    v_max3_u32 v117, v117, v207, v208
    s_add_u32 m0, s88, 12288
    s_nop 0
    s_nop 0
    buffer_load_dwordx4 v103, s[20:23], s29 offen lds
    s_add_u32 m0, s88, 13312
    s_add_u32 s29, s29, 32768
    buffer_load_dwordx4 v103, s[20:23], s29 offen lds
    s_waitcnt lgkmcnt(0)
    s_nop 0
    v_mfma_f32_32x32x16_bf16 v[152:167], v[196:199], v[240:243], v[152:167]
    v_max3_u32 v117, v117, v209, v210
    v_max3_u32 v117, v117, v211, v212
    v_max3_u32 v117, v117, v213, v214
    v_max_u32 v117, v117, v215
    v_cmp_eq_u32 vcc, -1, v117
    ds_read_b64_tr_b16 v[232:233], v106 offset:0
    ds_read_b64_tr_b16 v[234:235], v106 offset:512
    ds_read_b64_tr_b16 v[236:237], v107 offset:0
    ds_read_b64_tr_b16 v[238:239], v107 offset:512
    v_mfma_f32_32x32x16_bf16 v[168:183], v[196:199], v[244:247], v[168:183]
    buffer_load_dwordx4 v[192:195], v89, s[4:7], s37 offen offset:512 sc1
    s_add_u32 m0, s88, 14336
    s_add_u32 s29, s29, 32768
    buffer_load_dwordx4 v103, s[20:23], s29 offen lds
    s_add_u32 m0, s88, 15360
    s_add_u32 s29, s29, 32768
    buffer_load_dwordx4 v103, s[20:23], s29 offen lds
    s_cbranch_vccnz L_g2slow_169
L_g2back_170:
    s_waitcnt lgkmcnt(0)
    v_mfma_f32_32x32x16_bf16 v[152:167], v[200:203], v[232:235], v[152:167]
    buffer_load_dwordx4 v[196:199], v100, s[4:7], s37 offen offset:512 sc1
    ds_read_b64_tr_b16 v[240:241], v106 offset:2048
    ds_read_b64_tr_b16 v[242:243], v106 offset:2560
    ds_read_b64_tr_b16 v[244:245], v107 offset:2048
    ds_read_b64_tr_b16 v[246:247], v107 offset:2560
    v_mfma_f32_32x32x16_bf16 v[168:183], v[200:203], v[236:239], v[168:183]
    buffer_load_dwordx4 v[200:203], v89, s[4:7], s42 offen offset:0 sc1
    s_add_u32 m0, s88, 0
    s_nop 0
    buffer_load_dwordx4 v103, s[20:23], s30 offen lds
    s_add_u32 m0, s88, 1024
    s_add_u32 s30, s30, 32768
    buffer_load_dwordx4 v103, s[20:23], s30 offen lds
    s_waitcnt lgkmcnt(0)
    s_nop 0
    v_mfma_f32_32x32x16_bf16 v[152:167], v[204:207], v[240:243], v[152:167]
    ds_read_b64_tr_b16 v[232:233], v106 offset:4096
    ds_read_b64_tr_b16 v[234:235], v106 offset:4608
    ds_read_b64_tr_b16 v[236:237], v107 offset:4096
    ds_read_b64_tr_b16 v[238:239], v107 offset:4608
    v_mfma_f32_32x32x16_bf16 v[168:183], v[204:207], v[244:247], v[168:183]
    buffer_load_dwordx4 v[204:207], v89, s[4:7], s42 offen offset:512 sc1
    s_add_u32 m0, s88, 2048
    s_add_u32 s30, s30, 32768
    buffer_load_dwordx4 v103, s[20:23], s30 offen lds
    s_add_u32 m0, s88, 3072
    s_add_u32 s30, s30, 32768
    buffer_load_dwordx4 v103, s[20:23], s30 offen lds
    s_waitcnt lgkmcnt(0)
    s_nop 0
    v_mfma_f32_32x32x16_bf16 v[152:167], v[208:211], v[232:235], v[152:167]
    ds_read_b64_tr_b16 v[240:241], v106 offset:6144
    ds_read_b64_tr_b16 v[242:243], v106 offset:6656
    ds_read_b64_tr_b16 v[244:245], v107 offset:6144
    ds_read_b64_tr_b16 v[246:247], v107 offset:6656
    v_mfma_f32_32x32x16_bf16 v[168:183], v[208:211], v[236:239], v[168:183]
    s_waitcnt vmcnt(18)
    s_nop 0
    v_max3_u32 v117, v216, v217, v218
    v_max3_u32 v117, v117, v219, v220
    v_max3_u32 v117, v117, v221, v222
    v_max3_u32 v117, v117, v223, v224
    s_add_u32 m0, s88, 4096
    s_nop 0
    s_nop 0
    buffer_load_dwordx4 v103, s[20:23], s31 offen lds
    s_add_u32 m0, s88, 5120
    s_add_u32 s31, s31, 32768
    buffer_load_dwordx4 v103, s[20:23], s31 offen lds
    s_waitcnt lgkmcnt(0)
    s_nop 0
    v_mfma_f32_32x32x16_bf16 v[152:167], v[212:215], v[240:243], v[152:167]
    v_max3_u32 v117, v117, v225, v226
    v_max3_u32 v117, v117, v227, v228
    v_max3_u32 v117, v117, v229, v230
    v_max_u32 v117, v117, v231
    v_cmp_eq_u32 vcc, -1, v117
    ds_read_b64_tr_b16 v[232:233], v106 offset:8192
    ds_read_b64_tr_b16 v[234:235], v106 offset:8704
    ds_read_b64_tr_b16 v[236:237], v107 offset:8192
    ds_read_b64_tr_b16 v[238:239], v107 offset:8704
    v_mfma_f32_32x32x16_bf16 v[168:183], v[212:215], v[244:247], v[168:183]
    buffer_load_dwordx4 v[208:211], v100, s[4:7], s42 offen offset:0 sc1
    s_add_u32 m0, s88, 6144
    s_add_u32 s31, s31, 32768
    buffer_load_dwordx4 v103, s[20:23], s31 offen lds
    s_add_u32 m0, s88, 7168
    s_add_u32 s31, s31, 32768
    buffer_load_dwordx4 v103, s[20:23], s31 offen lds
    s_cbranch_vccnz L_g2slow_171
L_g2back_172:
    s_waitcnt lgkmcnt(0)
    v_mfma_f32_32x32x16_bf16 v[152:167], v[216:219], v[232:235], v[152:167]
    buffer_load_dwordx4 v[212:215], v100, s[4:7], s42 offen offset:512 sc1
    ds_read_b64_tr_b16 v[240:241], v106 offset:10240
    ds_read_b64_tr_b16 v[242:243], v106 offset:10752
    ds_read_b64_tr_b16 v[244:245], v107 offset:10240
    ds_read_b64_tr_b16 v[246:247], v107 offset:10752
    v_mfma_f32_32x32x16_bf16 v[168:183], v[216:219], v[236:239], v[168:183]
    buffer_load_dwordx4 v[216:219], v89, s[4:7], s43 offen offset:0 sc1
    s_waitcnt lgkmcnt(0)
    s_nop 0
    v_mfma_f32_32x32x16_bf16 v[152:167], v[220:223], v[240:243], v[152:167]
    ds_read_b64_tr_b16 v[232:233], v106 offset:12288
    ds_read_b64_tr_b16 v[234:235], v106 offset:12800
    ds_read_b64_tr_b16 v[236:237], v107 offset:12288
    ds_read_b64_tr_b16 v[238:239], v107 offset:12800
    v_mfma_f32_32x32x16_bf16 v[168:183], v[220:223], v[244:247], v[168:183]
    buffer_load_dwordx4 v[220:223], v89, s[4:7], s43 offen offset:512 sc1
    s_waitcnt lgkmcnt(0)
    s_nop 0
    v_mfma_f32_32x32x16_bf16 v[152:167], v[224:227], v[232:235], v[152:167]
    ds_read_b64_tr_b16 v[240:241], v106 offset:14336
    ds_read_b64_tr_b16 v[242:243], v106 offset:14848
    ds_read_b64_tr_b16 v[244:245], v107 offset:14336
    ds_read_b64_tr_b16 v[246:247], v107 offset:14848
    v_mfma_f32_32x32x16_bf16 v[168:183], v[224:227], v[236:239], v[168:183]
    s_waitcnt vmcnt(14)
    s_nop 0
    v_max3_u32 v117, v184, v185, v186
    v_max3_u32 v117, v117, v187, v188
    v_max3_u32 v117, v117, v189, v190
    v_max3_u32 v117, v117, v191, v192
    s_waitcnt lgkmcnt(0)
    s_nop 0
    v_mfma_f32_32x32x16_bf16 v[152:167], v[228:231], v[240:243], v[152:167]
    v_max3_u32 v117, v117, v193, v194
    v_max3_u32 v117, v117, v195, v196
    v_max3_u32 v117, v117, v197, v198
    v_max_u32 v117, v117, v199
    v_cmp_eq_u32 vcc, -1, v117
    ds_read_b64_tr_b16 v[232:233], v106 offset:16384
    ds_read_b64_tr_b16 v[234:235], v106 offset:16896
    ds_read_b64_tr_b16 v[236:237], v107 offset:16384
    ds_read_b64_tr_b16 v[238:239], v107 offset:16896
    v_mfma_f32_32x32x16_bf16 v[168:183], v[228:231], v[244:247], v[168:183]
    buffer_load_dwordx4 v[224:227], v100, s[4:7], s43 offen offset:0 sc1
    s_cbranch_vccnz L_g2slow_173
L_g2back_174:
    s_waitcnt lgkmcnt(0)
    v_mfma_f32_32x32x16_bf16 v[152:167], v[184:187], v[232:235], v[152:167]
    buffer_load_dwordx4 v[228:231], v100, s[4:7], s43 offen offset:512 sc1
    ds_read_b64_tr_b16 v[240:241], v106 offset:18432
    ds_read_b64_tr_b16 v[242:243], v106 offset:18944
    ds_read_b64_tr_b16 v[244:245], v107 offset:18432
    ds_read_b64_tr_b16 v[246:247], v107 offset:18944
    v_mfma_f32_32x32x16_bf16 v[168:183], v[184:187], v[236:239], v[168:183]
    buffer_load_dwordx4 v[184:187], v89, s[4:7], s44 offen offset:0 sc1
    s_waitcnt lgkmcnt(0)
    s_nop 0
    v_mfma_f32_32x32x16_bf16 v[152:167], v[188:191], v[240:243], v[152:167]
    ds_read_b64_tr_b16 v[232:233], v106 offset:20480
    ds_read_b64_tr_b16 v[234:235], v106 offset:20992
    ds_read_b64_tr_b16 v[236:237], v107 offset:20480
    ds_read_b64_tr_b16 v[238:239], v107 offset:20992
    v_mfma_f32_32x32x16_bf16 v[168:183], v[188:191], v[244:247], v[168:183]
    buffer_load_dwordx4 v[188:191], v89, s[4:7], s44 offen offset:512 sc1
    s_waitcnt lgkmcnt(0)
    s_nop 0
    v_mfma_f32_32x32x16_bf16 v[152:167], v[192:195], v[232:235], v[152:167]
    ds_read_b64_tr_b16 v[240:241], v106 offset:22528
    ds_read_b64_tr_b16 v[242:243], v106 offset:23040
    ds_read_b64_tr_b16 v[244:245], v107 offset:22528
    ds_read_b64_tr_b16 v[246:247], v107 offset:23040
    v_mfma_f32_32x32x16_bf16 v[168:183], v[192:195], v[236:239], v[168:183]
    s_waitcnt vmcnt(6)
    s_nop 0
    v_max3_u32 v117, v200, v201, v202
    v_max3_u32 v117, v117, v203, v204
    v_max3_u32 v117, v117, v205, v206
    v_max3_u32 v117, v117, v207, v208
    s_waitcnt lgkmcnt(0)
    s_nop 0
    v_mfma_f32_32x32x16_bf16 v[152:167], v[196:199], v[240:243], v[152:167]
    v_max3_u32 v117, v117, v209, v210
    v_max3_u32 v117, v117, v211, v212
    v_max3_u32 v117, v117, v213, v214
    v_max_u32 v117, v117, v215
    v_cmp_eq_u32 vcc, -1, v117
    s_waitcnt vmcnt(24)
    s_nop 0
    ds_read_b64_tr_b16 v[232:233], v118 offset:8192
    ds_read_b64_tr_b16 v[234:235], v118 offset:8704
    ds_read_b64_tr_b16 v[236:237], v119 offset:8192
    ds_read_b64_tr_b16 v[238:239], v119 offset:8704
    v_mfma_f32_32x32x16_bf16 v[168:183], v[196:199], v[244:247], v[168:183]
    buffer_load_dwordx4 v[192:195], v100, s[4:7], s44 offen offset:0 sc1
    s_cbranch_vccnz L_g2slow_175
L_g2back_176:
    s_waitcnt lgkmcnt(0)
    v_mfma_f32_32x32x16_bf16 v[120:135], v[200:203], v[232:235], v[120:135]
    buffer_load_dwordx4 v[196:199], v100, s[4:7], s44 offen offset:512 sc1
    ds_read_b64_tr_b16 v[240:241], v118 offset:10240
    ds_read_b64_tr_b16 v[242:243], v118 offset:10752
    ds_read_b64_tr_b16 v[244:245], v119 offset:10240
    ds_read_b64_tr_b16 v[246:247], v119 offset:10752
    v_mfma_f32_32x32x16_bf16 v[136:151], v[200:203], v[236:239], v[136:151]
    buffer_load_dwordx4 v[200:203], v89, s[4:7], s45 offen offset:0 sc1
    v_and_b32_e64 v248, 7, v1
    v_lshl_add_u32 v101, v248, 4, v101
    v_bfe_u32 v102, v1, 1, 1
    v_mfma_f32_32x32x16_bf16 v[152:167], v[204:207], v[232:235], v[152:167]
    v_lshl_or_b32 v102, v102, 3, v248
    v_lshrrev_b32 v249, 5, v1
    v_lshlrev_b32 v249, 3, v249
    v_xor_b32_e64 v102, v102, v249
    v_mfma_f32_32x32x16_bf16 v[168:183], v[204:207], v[236:239], v[168:183]
    buffer_load_dwordx4 v[204:207], v89, s[4:7], s45 offen offset:512 sc1
    v_lshlrev_b32 v102, 4, v102
    v_and_b32 v249, 31, v1
    v_lshl_add_u32 v102, v249, 8, v102
    s_waitcnt lgkmcnt(0)
    v_mfma_f32_32x32x16_bf16 v[120:135], v[208:211], v[240:243], v[120:135]
    s_waitcnt vmcnt(23)
    ds_read_b64_tr_b16 v[232:233], v118 offset:12288
    ds_read_b64_tr_b16 v[234:235], v118 offset:12800
    ds_read_b64_tr_b16 v[236:237], v119 offset:12288
    ds_read_b64_tr_b16 v[238:239], v119 offset:12800
    v_mfma_f32_32x32x16_bf16 v[136:151], v[208:211], v[244:247], v[136:151]
    s_waitcnt vmcnt(6)
    s_nop 0
    v_max3_u32 v117, v216, v217, v218
    v_max3_u32 v117, v117, v219, v220
    v_max3_u32 v117, v117, v221, v222
    v_max3_u32 v117, v117, v223, v224
    v_mfma_f32_32x32x16_bf16 v[152:167], v[212:215], v[240:243], v[152:167]
    v_max3_u32 v117, v117, v225, v226
    v_max3_u32 v117, v117, v227, v228
    v_max3_u32 v117, v117, v229, v230
    v_max_u32 v117, v117, v231
    v_cmp_eq_u32 vcc, -1, v117
    v_mfma_f32_32x32x16_bf16 v[168:183], v[212:215], v[244:247], v[168:183]
    buffer_load_dwordx4 v[208:211], v100, s[4:7], s45 offen offset:0 sc1
    v_add_u32_e64 v102, s88, v102
    v_bfe_u32 v249, v1, 4, 1
    v_lshlrev_b32 v249, 3, v249
    s_cbranch_vccnz L_g2slow_177
L_g2back_178:
    s_waitcnt lgkmcnt(0)
    s_nop 0
    v_mfma_f32_32x32x16_bf16 v[120:135], v[216:219], v[232:235], v[120:135]
    buffer_load_dwordx4 v[212:215], v100, s[4:7], s45 offen offset:512 sc1
    ds_read_b64_tr_b16 v[240:241], v118 offset:14336
    ds_read_b64_tr_b16 v[242:243], v118 offset:14848
    ds_read_b64_tr_b16 v[244:245], v119 offset:14336
    ds_read_b64_tr_b16 v[246:247], v119 offset:14848
    v_mfma_f32_32x32x16_bf16 v[136:151], v[216:219], v[236:239], v[136:151]
    v_xor_b32 v248, v248, v249
    v_lshrrev_b32 v249, 3, v1
    v_xor_b32_e64 v248, v248, v249
    v_mfma_f32_32x32x16_bf16 v[152:167], v[220:223], v[232:235], v[152:167]
    v_lshlrev_b32_e64 v248, 4, v248
    v_lshl_add_u32 v248, v249, 8, v248
    s_lshl_b32 s50, s3, 12
    v_add_u32 v248, s50, v248
    v_mfma_f32_32x32x16_bf16 v[168:183], v[220:223], v[236:239], v[168:183]
    v_xor_b32 v249, 128, v248
    s_waitcnt lgkmcnt(0)
    v_mfma_f32_32x32x16_bf16 v[120:135], v[224:227], v[240:243], v[120:135]
    s_waitcnt vmcnt(18)
    ds_read_b64_tr_b16 v[232:233], v118 offset:0
    ds_read_b64_tr_b16 v[234:235], v118 offset:512
    ds_read_b64_tr_b16 v[236:237], v119 offset:0
    ds_read_b64_tr_b16 v[238:239], v119 offset:512
    v_mfma_f32_32x32x16_bf16 v[136:151], v[224:227], v[244:247], v[136:151]
    s_waitcnt vmcnt(4)
    s_nop 0
    v_max3_u32 v117, v184, v185, v186
    v_max3_u32 v117, v117, v187, v188
    v_max3_u32 v117, v117, v189, v190
    v_max3_u32 v117, v117, v191, v192
    v_mfma_f32_32x32x16_bf16 v[152:167], v[228:231], v[240:243], v[152:167]
    v_max3_u32 v117, v117, v193, v194
    v_max3_u32 v117, v117, v195, v196
    v_max3_u32 v117, v117, v197, v198
    v_max_u32 v117, v117, v199
    v_cmp_eq_u32 vcc, -1, v117
    v_mfma_f32_32x32x16_bf16 v[168:183], v[228:231], v[244:247], v[168:183]
    s_cbranch_vccnz L_g2slow_179
L_g2back_180:
    s_waitcnt lgkmcnt(0)
    v_mfma_f32_32x32x16_bf16 v[120:135], v[184:187], v[232:235], v[120:135]
    ds_read_b64_tr_b16 v[240:241], v118 offset:2048
    ds_read_b64_tr_b16 v[242:243], v118 offset:2560
    ds_read_b64_tr_b16 v[244:245], v119 offset:2048
    ds_read_b64_tr_b16 v[246:247], v119 offset:2560
    v_mfma_f32_32x32x16_bf16 v[136:151], v[184:187], v[236:239], v[136:151]
    v_mfma_f32_32x32x16_bf16 v[152:167], v[188:191], v[232:235], v[152:167]
    s_mov_b32 s66, 0
    v_cmp_ne_u32 vcc, s68, v104
    s_cbranch_vccz L_fwd_182
L_fw_181:
    v_lshlrev_b32 v105, 6, v1
    s_and_b32 s48, s77, 255
    s_lshl_b32 s48, s48, 6
    s_lshl_b32 s49, s64, 14
    s_add_u32 s48, s48, s49
    s_add_u32 s48, s48, 25280512
    buffer_load_dword v104, v105, s[4:7], s48 offen sc1
L_fwc_183:
    s_waitcnt vmcnt(0)
    v_cmp_ne_u32 vcc, s68, v104
    s_cbranch_vccz L_fwd_182
    s_add_u32 s66, s66, 1
    s_cmp_lt_u32 s66, s67
    s_sleep 2
    s_cbranch_scc1 L_fw_181
    s_mov_b32 s67, 1
L_fwd_182:
    s_add_u32 s52, s46, s65
    s_add_u32 s52, s52, 8388608
    s_add_u32 s53, s52, 7168
    buffer_load_dwordx4 v[216:219], v101, s[4:7], s52 offen sc1
    buffer_load_dwordx4 v[220:223], v101, s[4:7], s53 offen sc1
    v_mfma_f32_32x32x16_bf16 v[168:183], v[188:191], v[236:239], v[168:183]
    v_and_b32 v225, 31, v1
    v_lshlrev_b32 v225, 6, v225
    s_mov_b32 s48, 25231360
    buffer_load_dword v224, v225, s[4:7], s48 offen sc1
    s_waitcnt lgkmcnt(0)
    v_mfma_f32_32x32x16_bf16 v[120:135], v[192:195], v[240:243], v[120:135]
    s_waitcnt vmcnt(16)
    ds_read_b64_tr_b16 v[232:233], v118 offset:4096
    ds_read_b64_tr_b16 v[234:235], v118 offset:4608
    ds_read_b64_tr_b16 v[236:237], v119 offset:4096
    ds_read_b64_tr_b16 v[238:239], v119 offset:4608
    v_mfma_f32_32x32x16_bf16 v[136:151], v[192:195], v[244:247], v[136:151]
    s_waitcnt vmcnt(3)
    s_nop 0
    v_max3_u32 v117, v200, v201, v202
    v_max3_u32 v117, v117, v203, v204
    v_max3_u32 v117, v117, v205, v206
    v_max3_u32 v117, v117, v207, v208
    v_mfma_f32_32x32x16_bf16 v[152:167], v[196:199], v[240:243], v[152:167]
    v_max3_u32 v117, v117, v209, v210
    v_max3_u32 v117, v117, v211, v212
    v_max3_u32 v117, v117, v213, v214
    v_max_u32 v117, v117, v215
    v_cmp_eq_u32 vcc, -1, v117
    v_mfma_f32_32x32x16_bf16 v[168:183], v[196:199], v[244:247], v[168:183]
    s_cbranch_vccnz L_g2slow_184
L_g2back_185:
    s_waitcnt lgkmcnt(0)
    v_mfma_f32_32x32x16_bf16 v[120:135], v[200:203], v[232:235], v[120:135]
    ds_read_b64_tr_b16 v[240:241], v118 offset:6144
    ds_read_b64_tr_b16 v[242:243], v118 offset:6656
    ds_read_b64_tr_b16 v[244:245], v119 offset:6144
    ds_read_b64_tr_b16 v[246:247], v119 offset:6656
    v_mfma_f32_32x32x16_bf16 v[136:151], v[200:203], v[236:239], v[136:151]
    v_mfma_f32_32x32x16_bf16 v[152:167], v[204:207], v[232:235], v[152:167]
    v_mfma_f32_32x32x16_bf16 v[168:183], v[204:207], v[236:239], v[168:183]
    s_waitcnt lgkmcnt(0)
    s_nop 0
    v_mfma_f32_32x32x16_bf16 v[120:135], v[208:211], v[240:243], v[120:135]
    v_mfma_f32_32x32x16_bf16 v[136:151], v[208:211], v[244:247], v[136:151]
    v_mfma_f32_32x32x16_bf16 v[152:167], v[212:215], v[240:243], v[152:167]
    v_mfma_f32_32x32x16_bf16 v[168:183], v[212:215], v[244:247], v[168:183]
    s_cmp_lg_u32 s3, 0
    s_cbranch_scc1 L_tok_186
    s_lshl_b32 s48, s74, 6
    s_add_u32 s48, s48, 25378816
    v_mov_b32 v232, s68
    v_mov_b32 v233, 0
    s_mov_b64 exec, 1
    buffer_store_dword v232, v233, s[4:7], s48 offen sc1
    s_mov_b64 exec, -1
L_tok_186:
    v_xor_b32 v104, 0, v102
    s_nop 5
    ds_write_b128 v104, v[120:123] offset:0
    ds_write_b128 v104, v[136:139] offset:8192
    v_xor_b32 v105, 16, v102
    ds_write_b128 v105, v[124:127] offset:0
    ds_write_b128 v105, v[140:143] offset:8192
    v_xor_b32_e64 v104, 32, v102
    ds_write_b128 v104, v[128:131] offset:0
    ds_write_b128 v104, v[144:147] offset:8192
    v_xor_b32_e64 v105, 48, v102
    ds_write_b128 v105, v[132:135] offset:0
    ds_write_b128 v105, v[148:151] offset:8192
    s_mov_b32 s66, 0
    s_branch L_fwc_189
L_fw_187:
    v_and_b32 v225, 31, v1
    v_lshlrev_b32 v225, 6, v225
    s_mov_b32 s48, 25231360
    buffer_load_dword v224, v225, s[4:7], s48 offen sc1
L_fwc_189:
    s_waitcnt vmcnt(0)
    v_cmp_ne_u32 vcc, s68, v224
    s_cbranch_vccz L_fwd_188
    s_add_u32 s66, s66, 1
    s_cmp_lt_u32 s66, s67
    s_sleep 2
    s_cbranch_scc1 L_fw_187
    s_mov_b32 s67, 1
L_fwd_188:
    v_xor_b32_e64 v104, 64, v102
    ds_write_b128 v104, v[152:155] offset:0
    ds_write_b128 v104, v[168:171] offset:8192
    v_lshlrev_b32_e64 v232, 16, v216
    v_and_b32 v233, 0xffff0000, v216
    v_lshlrev_b32_e64 v234, 16, v217
    v_and_b32 v235, 0xffff0000, v217
    v_lshlrev_b32_e64 v236, 16, v218
    v_and_b32 v237, 0xffff0000, v218
    v_xor_b32 v105, 80, v102
    ds_write_b128 v105, v[156:159] offset:0
    ds_write_b128 v105, v[172:175] offset:8192
    v_lshlrev_b32_e64 v238, 16, v219
    v_and_b32 v239, 0xffff0000, v219
    v_pk_add_f32 v[232:233], v[232:233], v[98:99] op_sel_hi:[1,0]
    v_pk_add_f32 v[234:235], v[234:235], v[98:99] op_sel_hi:[1,0]
    v_pk_add_f32 v[236:237], v[236:237], v[98:99] op_sel_hi:[1,0]
    v_pk_add_f32 v[238:239], v[238:239], v[98:99] op_sel_hi:[1,0]
    v_xor_b32 v104, 96, v102
    ds_write_b128 v104, v[160:163] offset:0
    ds_write_b128 v104, v[176:179] offset:8192
    v_lshlrev_b32_e64 v240, 16, v220
    v_and_b32 v241, 0xffff0000, v220
    v_lshlrev_b32_e64 v242, 16, v221
    v_and_b32 v243, 0xffff0000, v221
    v_lshlrev_b32_e64 v244, 16, v222
    v_and_b32 v245, 0xffff0000, v222
    v_xor_b32 v105, 112, v102
    ds_write_b128 v105, v[164:167] offset:0
    ds_write_b128 v105, v[180:183] offset:8192
    v_lshlrev_b32_e64 v246, 16, v223
    v_and_b32 v247, 0xffff0000, v223
    v_pk_add_f32 v[240:241], v[240:241], v[98:99] op_sel:[0,1] op_sel_hi:[1,1]
    v_pk_add_f32 v[242:243], v[242:243], v[98:99] op_sel:[0,1] op_sel_hi:[1,1]
    v_pk_add_f32 v[244:245], v[244:245], v[98:99] op_sel:[0,1] op_sel_hi:[1,1]
    v_pk_add_f32 v[246:247], v[246:247], v[98:99] op_sel:[0,1] op_sel_hi:[1,1]
    s_add_u32 s53, s46, 7168
    s_waitcnt lgkmcnt(0)
    s_barrier
    ds_read_b128 v[120:123], v248 offset:0
    ds_read_b128 v[124:127], v249 offset:0
    ds_read_b128 v[136:139], v248 offset:16384
    ds_read_b128 v[140:143], v249 offset:16384
    ds_read_b128 v[152:155], v248 offset:32768
    ds_read_b128 v[156:159], v249 offset:32768
    ds_read_b128 v[168:171], v248 offset:49152
    ds_read_b128 v[172:175], v249 offset:49152
    ds_read_b128 v[128:131], v248 offset:2048
    ds_read_b128 v[132:135], v249 offset:2048
    ds_read_b128 v[144:147], v248 offset:18432
    ds_read_b128 v[148:151], v249 offset:18432
    ds_read_b128 v[160:163], v248 offset:34816
    ds_read_b128 v[164:167], v249 offset:34816
    ds_read_b128 v[176:179], v248 offset:51200
    ds_read_b128 v[180:183], v249 offset:51200
    s_waitcnt lgkmcnt(15)
    v_pk_add_f32 v[120:121], v[120:121], v[232:233]
    v_pk_add_f32 v[122:123], v[122:123], v[234:235]
    s_waitcnt lgkmcnt(14)
    v_pk_add_f32 v[124:125], v[124:125], v[236:237]
    s_waitcnt lgkmcnt(13)
    v_pk_add_f32 v[122:123], v[122:123], v[138:139]
    v_pk_add_f32 v[126:127], v[126:127], v[238:239]
    v_pk_add_f32 v[120:121], v[120:121], v[136:137]
    s_waitcnt lgkmcnt(12)
    v_pk_add_f32 v[126:127], v[126:127], v[142:143]
    s_waitcnt lgkmcnt(9)
    v_pk_add_f32 v[152:153], v[152:153], v[168:169]
    v_pk_add_f32 v[154:155], v[154:155], v[170:171]
    s_waitcnt lgkmcnt(7)
    v_pk_add_f32 v[130:131], v[130:131], v[242:243]
    v_pk_add_f32 v[158:159], v[158:159], v[174:175]
    s_waitcnt lgkmcnt(5)
    s_nop 0
    v_pk_add_f32 v[130:131], v[130:131], v[146:147]
    v_pk_add_f32 v[126:127], v[126:127], v[158:159]
    v_pk_add_f32 v[134:135], v[134:135], v[246:247]
    v_pk_add_f32 v[120:121], v[120:121], v[152:153]
    s_waitcnt lgkmcnt(4)
    v_pk_add_f32 v[134:135], v[134:135], v[150:151]
    v_pk_add_f32 v[156:157], v[156:157], v[172:173]
    v_pk_add_f32 v[128:129], v[128:129], v[240:241]
    s_waitcnt lgkmcnt(1)
    v_pk_add_f32 v[162:163], v[162:163], v[178:179]
    v_pk_add_f32 v[128:129], v[128:129], v[144:145]
    v_pk_add_f32 v[130:131], v[130:131], v[162:163]
    v_pk_add_f32 v[132:133], v[132:133], v[244:245]
    s_waitcnt lgkmcnt(0)
    s_nop 0
    v_pk_add_f32 v[164:165], v[164:165], v[180:181]
    v_pk_add_f32 v[132:133], v[132:133], v[148:149]
    v_pk_add_f32 v[166:167], v[166:167], v[182:183]
    v_pk_add_f32 v[160:161], v[160:161], v[176:177]
    v_pk_add_f32 v[134:135], v[134:135], v[166:167]
    v_pk_add_f32 v[128:129], v[128:129], v[160:161]
    v_pk_add_f32 v[122:123], v[122:123], v[154:155]
    v_pk_add_f32 v[124:125], v[124:125], v[140:141]
    v_pk_add_f32 v[132:133], v[132:133], v[164:165]
    v_pk_add_f32 v[124:125], v[124:125], v[156:157]
    v_cvt_pk_bf16_f32 v178, v132, v133
    v_cvt_pk_bf16_f32 v179, v134, v135
    v_cvt_pk_bf16_f32 v176, v128, v129
    v_cvt_pk_bf16_f32 v177, v130, v131
    v_min_u32_e64 v178, -2, v178
    v_cvt_pk_bf16_f32 v170, v124, v125
    v_cvt_pk_bf16_f32 v171, v126, v127
    v_min_u32 v170, -2, v170
    v_min_u32 v176, -2, v176
    v_min_u32 v177, -2, v177
    v_min_u32 v179, -2, v179
    v_cvt_pk_bf16_f32 v168, v120, v121
    v_min_u32_e64 v171, -2, v171
    v_cvt_pk_bf16_f32 v169, v122, v123
    v_min_u32 v168, -2, v168
    v_min_u32 v169, -2, v169
    s_cmp_lg_u32 s64, 0
    s_cbranch_scc1 L_o1_190
    buffer_store_dwordx4 v[168:171], v101, s[12:15], s46 offen sc1
    buffer_store_dwordx4 v[176:179], v101, s[12:15], s53 offen sc1
    s_branch L_o2_191
L_o1_190:
    buffer_store_dwordx4 v[168:171], v101, s[12:15], s46 offen sc1 nt
    buffer_store_dwordx4 v[176:179], v101, s[12:15], s53 offen sc1 nt
L_o2_191:
    s_branch L_g2end_153
L_g2no_154:
    s_cmp_lg_u32 s64, 0
    s_cbranch_scc1 L_l0_192
    s_cmp_eq_u32 s73, 2
    s_cbranch_scc1 L_p2pre_193
    v_lshrrev_b32 v124, 2, v1
    v_and_b32 v125, 3, v1
    v_lshlrev_b32_e64 v117, 15, v124
    v_lshl_add_u32 v117, v125, 4, v117
    s_lshl_b32 s24, s78, 8
    s_lshl_b32 s50, s3, 2
    s_add_u32 s24, s24, s50
    s_lshl_b32 s24, s24, 11
    s_lshl_b32 s50, s79, 1
    s_add_u32 s50, s50, s73
    s_lshl_b32 s51, s50, 6
    s_add_u32 s24, s24, s51
    v_and_b32 v126, 3, v124
    v_lshrrev_b32 v127, 2, v124
    v_lshlrev_b32_e64 v128, 8, v127
    v_lshl_add_u32 v126, v126, 2, v128
    v_lshl_add_u32 v126, v125, 12, v126
    s_lshr_b32 s50, s3, 1
    s_lshl_b32 s50, s50, 7
    v_add_u32 v126, s50, v126
    v_and_b32 v127, 1, v127
    v_lshl_or_b32 v127, v125, 1, v127
    s_and_b32 s50, s3, 1
    s_lshl_b32 s50, s50, 2
    s_add_u32 s51, s50, 0
    v_xor_b32 v128, s51, v127
    v_lshl_add_u32 v120, v128, 4, v126
    s_add_u32 s51, s50, 1
    v_xor_b32 v128, s51, v127
    v_lshl_add_u32 v121, v128, 4, v126
    s_add_u32 s51, s50, 2
    v_xor_b32 v128, s51, v127
    v_lshl_add_u32 v122, v128, 4, v126
    s_add_u32 s51, s50, 3
    v_xor_b32 v128, s51, v127
    v_lshl_add_u32 v123, v128, 4, v126
    s_add_u32 s48, s24, 10485760
    buffer_load_dwordx4 v[132:135], v117, s[4:7], s48 offen sc1
    s_add_u32 s48, s24, 10487808
    buffer_load_dwordx4 v[136:139], v117, s[4:7], s48 offen sc1
    s_add_u32 s48, s24, 10489856
    buffer_load_dwordx4 v[140:143], v117, s[4:7], s48 offen sc1
    s_add_u32 s48, s24, 10491904
    buffer_load_dwordx4 v[144:147], v117, s[4:7], s48 offen sc1
    s_waitcnt vmcnt(0)
    s_nop 0
    ds_write2st64_b32 v120, v132, v133 offset0:192 offset1:196
    ds_write2st64_b32 v120, v134, v135 offset0:200 offset1:204
    ds_write2st64_b32 v121, v136, v137 offset0:192 offset1:196
    ds_write2st64_b32 v121, v138, v139 offset0:200 offset1:204
    ds_write2st64_b32 v122, v140, v141 offset0:192 offset1:196
    ds_write2st64_b32 v122, v142, v143 offset0:200 offset1:204
    ds_write2st64_b32 v123, v144, v145 offset0:192 offset1:196
    ds_write2st64_b32 v123, v146, v147 offset0:200 offset1:204
L_p2pre_193:
    s_mov_b32 s66, 0
L_fw_194:
    v_and_b32 v105, 31, v1
    v_lshlrev_b32_e64 v105, 6, v105
    s_mov_b32 s48, 25231360
    buffer_load_dword v104, v105, s[4:7], s48 offen sc1
L_fwc_196:
    s_waitcnt vmcnt(0)
    v_cmp_ne_u32 vcc, s68, v104
    s_cbranch_vccz L_fwd_195
    s_add_u32 s66, s66, 1
    s_cmp_lt_u32 s66, s67
    s_sleep 8
    s_cbranch_scc1 L_fw_194
    s_mov_b32 s67, 1
L_fwd_195:
    s_mov_b32 s66, 0
L_fw_197:
    s_mov_b32 s48, 25378816
    v_lshlrev_b32 v105, 6, v0
    v_min_u32 v105, 14272, v105
    buffer_load_dword v104, v105, s[4:7], s48 offen sc1
L_fwc_199:
    s_waitcnt vmcnt(0)
    v_cmp_ne_u32 vcc, s68, v104
    s_cbranch_vccz L_fwd_198
    s_add_u32 s66, s66, 1
    s_cmp_lt_u32 s66, s67
    s_sleep 4
    s_cbranch_scc1 L_fw_197
    s_mov_b32 s67, 1
L_fwd_198:
    s_sleep 5
L_l0_192:
L_g2end_153:
    s_cmp_lg_u32 s64, 0
    s_cbranch_scc1 L_fin
    s_mov_b32 s64, 1
    s_mov_b32 s65, 12582912
    s_mov_b32 s8, s12
    s_mov_b32 s9, s13
    s_mov_b32 s12, s96
    s_and_b32 s13, s97, 0xffff
    s_barrier
    s_cmp_eq_u32 s71, 0
    s_cbranch_scc1 L_layer
    v_mov_b32 v100, -1
    v_mov_b32 v101, -1
    v_mov_b32 v102, -1
    v_mov_b32 v103, -1
    s_lshl_b32 s48, s74, 14
    s_lshl_b32 s49, s3, 12
    s_add_u32 s48, s48, s49
    s_nop 0
    s_add_u32 s48, s48, 16777216
    buffer_store_dwordx4 v[100:103], v45, s[4:7], s48 offen offset:0 sc1
    buffer_store_dwordx4 v[100:103], v45, s[4:7], s48 offen offset:1024 sc1
    buffer_store_dwordx4 v[100:103], v45, s[4:7], s48 offen offset:2048 sc1
    buffer_store_dwordx4 v[100:103], v45, s[4:7], s48 offen offset:3072 sc1
    s_cmp_eq_u32 s73, 2
    s_cbranch_scc1 L_p2pre_200
    v_lshrrev_b32 v118, 2, v1
    v_and_b32 v119, 3, v1
    v_lshlrev_b32_e64 v100, 15, v118
    v_lshl_add_u32 v100, v119, 4, v100
    s_lshl_b32 s24, s78, 8
    s_lshl_b32 s50, s3, 2
    s_add_u32 s24, s24, s50
    s_lshl_b32 s24, s24, 11
    s_lshl_b32 s50, s79, 1
    s_add_u32 s50, s50, s73
    s_lshl_b32 s51, s50, 6
    s_add_u32 s24, s24, s51
    v_and_b32 v120, 3, v118
    v_lshrrev_b32 v121, 2, v118
    v_lshlrev_b32_e64 v101, 8, v121
    v_lshl_add_u32 v120, v120, 2, v101
    v_lshl_add_u32 v120, v119, 12, v120
    s_lshr_b32 s50, s3, 1
    s_lshl_b32 s50, s50, 7
    v_add_u32 v120, s50, v120
    v_and_b32 v121, 1, v121
    v_lshl_or_b32 v121, v119, 1, v121
    s_and_b32 s50, s3, 1
    s_lshl_b32 s50, s50, 2
    s_add_u32 s51, s50, 0
    v_xor_b32 v101, s51, v121
    v_lshl_add_u32 v102, v101, 4, v120
    s_add_u32 s51, s50, 1
    v_xor_b32 v101, s51, v121
    v_lshl_add_u32 v103, v101, 4, v120
    s_add_u32 s51, s50, 2
    v_xor_b32 v101, s51, v121
    v_lshl_add_u32 v104, v101, 4, v120
    s_add_u32 s51, s50, 3
    v_xor_b32 v101, s51, v121
    v_lshl_add_u32 v105, v101, 4, v120
    s_add_u32 s48, s24, 10485760
    buffer_load_dwordx4 v[124:127], v100, s[4:7], s48 offen sc1
    s_add_u32 s48, s24, 10487808
    buffer_load_dwordx4 v[128:131], v100, s[4:7], s48 offen sc1
    s_add_u32 s48, s24, 10489856
    buffer_load_dwordx4 v[132:135], v100, s[4:7], s48 offen sc1
    s_add_u32 s48, s24, 10491904
    buffer_load_dwordx4 v[136:139], v100, s[4:7], s48 offen sc1
    s_waitcnt vmcnt(0)
    s_nop 0
    ds_write2st64_b32 v102, v124, v125 offset0:192 offset1:196
    ds_write2st64_b32 v102, v126, v127 offset0:200 offset1:204
    ds_write2st64_b32 v103, v128, v129 offset0:192 offset1:196
    ds_write2st64_b32 v103, v130, v131 offset0:200 offset1:204
    ds_write2st64_b32 v104, v132, v133 offset0:192 offset1:196
    ds_write2st64_b32 v104, v134, v135 offset0:200 offset1:204
    ds_write2st64_b32 v105, v136, v137 offset0:192 offset1:196
    ds_write2st64_b32 v105, v138, v139 offset0:200 offset1:204
L_p2pre_200:
    s_waitcnt vmcnt(0)
    s_branch L_layer
L_fin:
L_exit:
    s_endpgm
L_g1slow_57:
    s_sleep 2
    buffer_load_dwordx4 v[184:187], v89, s[4:7], s24 offen offset:0 sc1
    buffer_load_dwordx4 v[188:191], v100, s[4:7], s24 offen offset:0 sc1
    buffer_load_dwordx4 v[192:195], v101, s[4:7], s24 offen offset:0 sc1
    buffer_load_dwordx4 v[196:199], v102, s[4:7], s24 offen offset:0 sc1
    buffer_load_dwordx4 v[200:203], v89, s[4:7], s25 offen offset:0 sc1
    buffer_load_dwordx4 v[204:207], v100, s[4:7], s25 offen offset:0 sc1
    buffer_load_dwordx4 v[208:211], v101, s[4:7], s25 offen offset:0 sc1
    buffer_load_dwordx4 v[212:215], v102, s[4:7], s25 offen offset:0 sc1
    buffer_load_dwordx4 v[216:219], v89, s[4:7], s26 offen offset:0 sc1
    buffer_load_dwordx4 v[220:223], v100, s[4:7], s26 offen offset:0 sc1
    buffer_load_dwordx4 v[224:227], v101, s[4:7], s26 offen offset:0 sc1
    buffer_load_dwordx4 v[228:231], v102, s[4:7], s26 offen offset:0 sc1
    buffer_load_dwordx4 v[232:235], v89, s[4:7], s27 offen offset:0 sc1
    buffer_load_dwordx4 v[236:239], v100, s[4:7], s27 offen offset:0 sc1
    buffer_load_dwordx4 v[240:243], v101, s[4:7], s27 offen offset:0 sc1
    buffer_load_dwordx4 v[244:247], v102, s[4:7], s27 offen offset:0 sc1
    s_waitcnt vmcnt(0)
    s_nop 0
    v_max3_u32 v248, v184, v185, v186
    v_max3_u32 v248, v248, v187, v188
    v_max3_u32 v248, v248, v189, v190
    v_max3_u32 v248, v248, v191, v192
    v_max3_u32 v248, v248, v193, v194
    v_max3_u32 v248, v248, v195, v196
    v_max3_u32 v248, v248, v197, v198
    v_max_u32 v248, v248, v199
    v_cmp_eq_u32 vcc, -1, v248
    s_add_u32 s66, s66, 1
    s_cbranch_vccz L_g1back_58
    s_cmp_lt_u32 s66, s67
    s_cbranch_scc1 L_g1slow_57
    s_mov_b32 s67, 1
    s_branch L_g1back_58
L_g1slow_59:
    s_sleep 2
    s_nop 0
    buffer_load_dwordx4 v[200:203], v89, s[4:7], s25 offen offset:0 sc1
    buffer_load_dwordx4 v[204:207], v100, s[4:7], s25 offen offset:0 sc1
    buffer_load_dwordx4 v[208:211], v101, s[4:7], s25 offen offset:0 sc1
    buffer_load_dwordx4 v[212:215], v102, s[4:7], s25 offen offset:0 sc1
    buffer_load_dwordx4 v[216:219], v89, s[4:7], s26 offen offset:0 sc1
    buffer_load_dwordx4 v[220:223], v100, s[4:7], s26 offen offset:0 sc1
    buffer_load_dwordx4 v[224:227], v101, s[4:7], s26 offen offset:0 sc1
    buffer_load_dwordx4 v[228:231], v102, s[4:7], s26 offen offset:0 sc1
    buffer_load_dwordx4 v[232:235], v89, s[4:7], s27 offen offset:0 sc1
    buffer_load_dwordx4 v[236:239], v100, s[4:7], s27 offen offset:0 sc1
    buffer_load_dwordx4 v[240:243], v101, s[4:7], s27 offen offset:0 sc1
    buffer_load_dwordx4 v[244:247], v102, s[4:7], s27 offen offset:0 sc1
    buffer_load_dwordx4 v[184:187], v89, s[4:7], s56 offen offset:0 sc1
    buffer_load_dwordx4 v[188:191], v100, s[4:7], s56 offen offset:0 sc1
    buffer_load_dwordx4 v[192:195], v101, s[4:7], s56 offen offset:0 sc1
    s_waitcnt vmcnt(0)
    s_nop 0
    v_max3_u32 v248, v200, v201, v202
    v_max3_u32 v248, v248, v203, v204
    v_max3_u32 v248, v248, v205, v206
    v_max3_u32 v248, v248, v207, v208
    v_max3_u32 v248, v248, v209, v210
    v_max3_u32 v248, v248, v211, v212
    v_max3_u32 v248, v248, v213, v214
    v_max_u32 v248, v248, v215
    v_cmp_eq_u32 vcc, -1, v248
    s_add_u32 s66, s66, 1
    s_cbranch_vccz L_g1back_60
    s_cmp_lt_u32 s66, s67
    s_cbranch_scc1 L_g1slow_59
    s_mov_b32 s67, 1
    s_branch L_g1back_60
L_g1slow_61:
    s_sleep 2
    s_nop 0
    buffer_load_dwordx4 v[216:219], v89, s[4:7], s26 offen offset:0 sc1
    buffer_load_dwordx4 v[220:223], v100, s[4:7], s26 offen offset:0 sc1
    buffer_load_dwordx4 v[224:227], v101, s[4:7], s26 offen offset:0 sc1
    buffer_load_dwordx4 v[228:231], v102, s[4:7], s26 offen offset:0 sc1
    buffer_load_dwordx4 v[232:235], v89, s[4:7], s27 offen offset:0 sc1
    buffer_load_dwordx4 v[236:239], v100, s[4:7], s27 offen offset:0 sc1
    buffer_load_dwordx4 v[240:243], v101, s[4:7], s27 offen offset:0 sc1
    buffer_load_dwordx4 v[244:247], v102, s[4:7], s27 offen offset:0 sc1
    buffer_load_dwordx4 v[184:187], v89, s[4:7], s56 offen offset:0 sc1
    buffer_load_dwordx4 v[188:191], v100, s[4:7], s56 offen offset:0 sc1
    buffer_load_dwordx4 v[192:195], v101, s[4:7], s56 offen offset:0 sc1
    buffer_load_dwordx4 v[196:199], v102, s[4:7], s56 offen offset:0 sc1
    buffer_load_dwordx4 v[200:203], v89, s[4:7], s57 offen offset:0 sc1
    buffer_load_dwordx4 v[204:207], v100, s[4:7], s57 offen offset:0 sc1
    buffer_load_dwordx4 v[208:211], v101, s[4:7], s57 offen offset:0 sc1
    s_waitcnt vmcnt(0)
    s_nop 0
    v_max3_u32 v248, v216, v217, v218
    v_max3_u32 v248, v248, v219, v220
    v_max3_u32 v248, v248, v221, v222
    v_max3_u32 v248, v248, v223, v224
    v_max3_u32 v248, v248, v225, v226
    v_max3_u32 v248, v248, v227, v228
    v_max3_u32 v248, v248, v229, v230
    v_max_u32 v248, v248, v231
    v_cmp_eq_u32 vcc, -1, v248
    s_add_u32 s66, s66, 1
    s_cbranch_vccz L_g1back_62
    s_cmp_lt_u32 s66, s67
    s_cbranch_scc1 L_g1slow_61
    s_mov_b32 s67, 1
    s_branch L_g1back_62
L_g1slow_63:
    s_sleep 2
    s_nop 0
    buffer_load_dwordx4 v[232:235], v89, s[4:7], s27 offen offset:0 sc1
    buffer_load_dwordx4 v[236:239], v100, s[4:7], s27 offen offset:0 sc1
    buffer_load_dwordx4 v[240:243], v101, s[4:7], s27 offen offset:0 sc1
    buffer_load_dwordx4 v[244:247], v102, s[4:7], s27 offen offset:0 sc1
    buffer_load_dwordx4 v[184:187], v89, s[4:7], s56 offen offset:0 sc1
    buffer_load_dwordx4 v[188:191], v100, s[4:7], s56 offen offset:0 sc1
    buffer_load_dwordx4 v[192:195], v101, s[4:7], s56 offen offset:0 sc1
    buffer_load_dwordx4 v[196:199], v102, s[4:7], s56 offen offset:0 sc1
    buffer_load_dwordx4 v[200:203], v89, s[4:7], s57 offen offset:0 sc1
    buffer_load_dwordx4 v[204:207], v100, s[4:7], s57 offen offset:0 sc1
    buffer_load_dwordx4 v[208:211], v101, s[4:7], s57 offen offset:0 sc1
    buffer_load_dwordx4 v[212:215], v102, s[4:7], s57 offen offset:0 sc1
    buffer_load_dwordx4 v[216:219], v89, s[4:7], s58 offen offset:0 sc1
    buffer_load_dwordx4 v[220:223], v100, s[4:7], s58 offen offset:0 sc1
    buffer_load_dwordx4 v[224:227], v101, s[4:7], s58 offen offset:0 sc1
    s_waitcnt vmcnt(0)
    s_nop 0
    v_max3_u32 v248, v232, v233, v234
    v_max3_u32 v248, v248, v235, v236
    v_max3_u32 v248, v248, v237, v238
    v_max3_u32 v248, v248, v239, v240
    v_max3_u32 v248, v248, v241, v242
    v_max3_u32 v248, v248, v243, v244
    v_max3_u32 v248, v248, v245, v246
    v_max_u32 v248, v248, v247
    v_cmp_eq_u32 vcc, -1, v248
    s_add_u32 s66, s66, 1
    s_cbranch_vccz L_g1back_64
    s_cmp_lt_u32 s66, s67
    s_cbranch_scc1 L_g1slow_63
    s_mov_b32 s67, 1
    s_branch L_g1back_64
L_g1slow_65:
    s_sleep 2
    s_nop 0
    buffer_load_dwordx4 v[184:187], v89, s[4:7], s56 offen offset:0 sc1
    buffer_load_dwordx4 v[188:191], v100, s[4:7], s56 offen offset:0 sc1
    buffer_load_dwordx4 v[192:195], v101, s[4:7], s56 offen offset:0 sc1
    buffer_load_dwordx4 v[196:199], v102, s[4:7], s56 offen offset:0 sc1
    buffer_load_dwordx4 v[200:203], v89, s[4:7], s57 offen offset:0 sc1
    buffer_load_dwordx4 v[204:207], v100, s[4:7], s57 offen offset:0 sc1
    buffer_load_dwordx4 v[208:211], v101, s[4:7], s57 offen offset:0 sc1
    buffer_load_dwordx4 v[212:215], v102, s[4:7], s57 offen offset:0 sc1
    buffer_load_dwordx4 v[216:219], v89, s[4:7], s58 offen offset:0 sc1
    buffer_load_dwordx4 v[220:223], v100, s[4:7], s58 offen offset:0 sc1
    buffer_load_dwordx4 v[224:227], v101, s[4:7], s58 offen offset:0 sc1
    buffer_load_dwordx4 v[228:231], v102, s[4:7], s58 offen offset:0 sc1
    buffer_load_dwordx4 v[232:235], v89, s[4:7], s59 offen offset:0 sc1
    buffer_load_dwordx4 v[236:239], v100, s[4:7], s59 offen offset:0 sc1
    buffer_load_dwordx4 v[240:243], v101, s[4:7], s59 offen offset:0 sc1
    s_waitcnt vmcnt(0)
    s_nop 0
    v_max3_u32 v248, v184, v185, v186
    v_max3_u32 v248, v248, v187, v188
    v_max3_u32 v248, v248, v189, v190
    v_max3_u32 v248, v248, v191, v192
    v_max3_u32 v248, v248, v193, v194
    v_max3_u32 v248, v248, v195, v196
    v_max3_u32 v248, v248, v197, v198
    v_max_u32 v248, v248, v199
    v_cmp_eq_u32 vcc, -1, v248
    s_add_u32 s66, s66, 1
    s_cbranch_vccz L_g1back_66
    s_cmp_lt_u32 s66, s67
    s_cbranch_scc1 L_g1slow_65
    s_mov_b32 s67, 1
    s_branch L_g1back_66
L_g1slow_67:
    s_sleep 2
    s_nop 0
    buffer_load_dwordx4 v[200:203], v89, s[4:7], s57 offen offset:0 sc1
    buffer_load_dwordx4 v[204:207], v100, s[4:7], s57 offen offset:0 sc1
    buffer_load_dwordx4 v[208:211], v101, s[4:7], s57 offen offset:0 sc1
    buffer_load_dwordx4 v[212:215], v102, s[4:7], s57 offen offset:0 sc1
    buffer_load_dwordx4 v[216:219], v89, s[4:7], s58 offen offset:0 sc1
    buffer_load_dwordx4 v[220:223], v100, s[4:7], s58 offen offset:0 sc1
    buffer_load_dwordx4 v[224:227], v101, s[4:7], s58 offen offset:0 sc1
    buffer_load_dwordx4 v[228:231], v102, s[4:7], s58 offen offset:0 sc1
    buffer_load_dwordx4 v[232:235], v89, s[4:7], s59 offen offset:0 sc1
    buffer_load_dwordx4 v[236:239], v100, s[4:7], s59 offen offset:0 sc1
    buffer_load_dwordx4 v[240:243], v101, s[4:7], s59 offen offset:0 sc1
    buffer_load_dwordx4 v[244:247], v102, s[4:7], s59 offen offset:0 sc1
    buffer_load_dwordx4 v[184:187], v89, s[4:7], s24 offen offset:512 sc1
    buffer_load_dwordx4 v[188:191], v100, s[4:7], s24 offen offset:512 sc1
    buffer_load_dwordx4 v[192:195], v101, s[4:7], s24 offen offset:512 sc1
    s_waitcnt vmcnt(0)
    s_nop 0
    v_max3_u32 v248, v200, v201, v202
    v_max3_u32 v248, v248, v203, v204
    v_max3_u32 v248, v248, v205, v206
    v_max3_u32 v248, v248, v207, v208
    v_max3_u32 v248, v248, v209, v210
    v_max3_u32 v248, v248, v211, v212
    v_max3_u32 v248, v248, v213, v214
    v_max_u32 v248, v248, v215
    v_cmp_eq_u32 vcc, -1, v248
    s_add_u32 s66, s66, 1
    s_cbranch_vccz L_g1back_68
    s_cmp_lt_u32 s66, s67
    s_cbranch_scc1 L_g1slow_67
    s_mov_b32 s67, 1
    s_branch L_g1back_68
L_g1slow_69:
    s_sleep 2
    s_nop 0
    buffer_load_dwordx4 v[216:219], v89, s[4:7], s58 offen offset:0 sc1
    buffer_load_dwordx4 v[220:223], v100, s[4:7], s58 offen offset:0 sc1
    buffer_load_dwordx4 v[224:227], v101, s[4:7], s58 offen offset:0 sc1
    buffer_load_dwordx4 v[228:231], v102, s[4:7], s58 offen offset:0 sc1
    buffer_load_dwordx4 v[232:235], v89, s[4:7], s59 offen offset:0 sc1
    buffer_load_dwordx4 v[236:239], v100, s[4:7], s59 offen offset:0 sc1
    buffer_load_dwordx4 v[240:243], v101, s[4:7], s59 offen offset:0 sc1
    buffer_load_dwordx4 v[244:247], v102, s[4:7], s59 offen offset:0 sc1
    buffer_load_dwordx4 v[184:187], v89, s[4:7], s24 offen offset:512 sc1
    buffer_load_dwordx4 v[188:191], v100, s[4:7], s24 offen offset:512 sc1
    buffer_load_dwordx4 v[192:195], v101, s[4:7], s24 offen offset:512 sc1
    buffer_load_dwordx4 v[196:199], v102, s[4:7], s24 offen offset:512 sc1
    buffer_load_dwordx4 v[200:203], v89, s[4:7], s25 offen offset:512 sc1
    buffer_load_dwordx4 v[204:207], v100, s[4:7], s25 offen offset:512 sc1
    buffer_load_dwordx4 v[208:211], v101, s[4:7], s25 offen offset:512 sc1
    s_waitcnt vmcnt(0)
    s_nop 0
    v_max3_u32 v248, v216, v217, v218
    v_max3_u32 v248, v248, v219, v220
    v_max3_u32 v248, v248, v221, v222
    v_max3_u32 v248, v248, v223, v224
    v_max3_u32 v248, v248, v225, v226
    v_max3_u32 v248, v248, v227, v228
    v_max3_u32 v248, v248, v229, v230
    v_max_u32 v248, v248, v231
    v_cmp_eq_u32 vcc, -1, v248
    s_add_u32 s66, s66, 1
    s_cbranch_vccz L_g1back_70
    s_cmp_lt_u32 s66, s67
    s_cbranch_scc1 L_g1slow_69
    s_mov_b32 s67, 1
    s_branch L_g1back_70
L_g1slow_71:
    s_sleep 2
    s_nop 0
    buffer_load_dwordx4 v[232:235], v89, s[4:7], s59 offen offset:0 sc1
    buffer_load_dwordx4 v[236:239], v100, s[4:7], s59 offen offset:0 sc1
    buffer_load_dwordx4 v[240:243], v101, s[4:7], s59 offen offset:0 sc1
    buffer_load_dwordx4 v[244:247], v102, s[4:7], s59 offen offset:0 sc1
    buffer_load_dwordx4 v[184:187], v89, s[4:7], s24 offen offset:512 sc1
    buffer_load_dwordx4 v[188:191], v100, s[4:7], s24 offen offset:512 sc1
    buffer_load_dwordx4 v[192:195], v101, s[4:7], s24 offen offset:512 sc1
    buffer_load_dwordx4 v[196:199], v102, s[4:7], s24 offen offset:512 sc1
    buffer_load_dwordx4 v[200:203], v89, s[4:7], s25 offen offset:512 sc1
    buffer_load_dwordx4 v[204:207], v100, s[4:7], s25 offen offset:512 sc1
    buffer_load_dwordx4 v[208:211], v101, s[4:7], s25 offen offset:512 sc1
    buffer_load_dwordx4 v[212:215], v102, s[4:7], s25 offen offset:512 sc1
    buffer_load_dwordx4 v[216:219], v89, s[4:7], s26 offen offset:512 sc1
    buffer_load_dwordx4 v[220:223], v100, s[4:7], s26 offen offset:512 sc1
    buffer_load_dwordx4 v[224:227], v101, s[4:7], s26 offen offset:512 sc1
    s_waitcnt vmcnt(0)
    s_nop 0
    v_max3_u32 v248, v232, v233, v234
    v_max3_u32 v248, v248, v235, v236
    v_max3_u32 v248, v248, v237, v238
    v_max3_u32 v248, v248, v239, v240
    v_max3_u32 v248, v248, v241, v242
    v_max3_u32 v248, v248, v243, v244
    v_max3_u32 v248, v248, v245, v246
    v_max_u32 v248, v248, v247
    v_cmp_eq_u32 vcc, -1, v248
    s_add_u32 s66, s66, 1
    s_cbranch_vccz L_g1back_72
    s_cmp_lt_u32 s66, s67
    s_cbranch_scc1 L_g1slow_71
    s_mov_b32 s67, 1
    s_branch L_g1back_72
L_g1slow_73:
    s_sleep 2
    s_nop 0
    buffer_load_dwordx4 v[184:187], v89, s[4:7], s24 offen offset:512 sc1
    buffer_load_dwordx4 v[188:191], v100, s[4:7], s24 offen offset:512 sc1
    buffer_load_dwordx4 v[192:195], v101, s[4:7], s24 offen offset:512 sc1
    buffer_load_dwordx4 v[196:199], v102, s[4:7], s24 offen offset:512 sc1
    buffer_load_dwordx4 v[200:203], v89, s[4:7], s25 offen offset:512 sc1
    buffer_load_dwordx4 v[204:207], v100, s[4:7], s25 offen offset:512 sc1
    buffer_load_dwordx4 v[208:211], v101, s[4:7], s25 offen offset:512 sc1
    buffer_load_dwordx4 v[212:215], v102, s[4:7], s25 offen offset:512 sc1
    buffer_load_dwordx4 v[216:219], v89, s[4:7], s26 offen offset:512 sc1
    buffer_load_dwordx4 v[220:223], v100, s[4:7], s26 offen offset:512 sc1
    buffer_load_dwordx4 v[224:227], v101, s[4:7], s26 offen offset:512 sc1
    buffer_load_dwordx4 v[228:231], v102, s[4:7], s26 offen offset:512 sc1
    buffer_load_dwordx4 v[232:235], v89, s[4:7], s27 offen offset:512 sc1
    buffer_load_dwordx4 v[236:239], v100, s[4:7], s27 offen offset:512 sc1
    buffer_load_dwordx4 v[240:243], v101, s[4:7], s27 offen offset:512 sc1
    s_waitcnt vmcnt(0)
    s_nop 0
    v_max3_u32 v248, v184, v185, v186
    v_max3_u32 v248, v248, v187, v188
    v_max3_u32 v248, v248, v189, v190
    v_max3_u32 v248, v248, v191, v192
    v_max3_u32 v248, v248, v193, v194
    v_max3_u32 v248, v248, v195, v196
    v_max3_u32 v248, v248, v197, v198
    v_max_u32 v248, v248, v199
    v_cmp_eq_u32 vcc, -1, v248
    s_add_u32 s66, s66, 1
    s_cbranch_vccz L_g1back_74
    s_cmp_lt_u32 s66, s67
    s_cbranch_scc1 L_g1slow_73
    s_mov_b32 s67, 1
    s_branch L_g1back_74
L_g1slow_76:
    s_sleep 2
    s_nop 0
    buffer_load_dwordx4 v[200:203], v89, s[4:7], s25 offen offset:512 sc1
    buffer_load_dwordx4 v[204:207], v100, s[4:7], s25 offen offset:512 sc1
    buffer_load_dwordx4 v[208:211], v101, s[4:7], s25 offen offset:512 sc1
    buffer_load_dwordx4 v[212:215], v102, s[4:7], s25 offen offset:512 sc1
    buffer_load_dwordx4 v[216:219], v89, s[4:7], s26 offen offset:512 sc1
    buffer_load_dwordx4 v[220:223], v100, s[4:7], s26 offen offset:512 sc1
    buffer_load_dwordx4 v[224:227], v101, s[4:7], s26 offen offset:512 sc1
    buffer_load_dwordx4 v[228:231], v102, s[4:7], s26 offen offset:512 sc1
    buffer_load_dwordx4 v[232:235], v89, s[4:7], s27 offen offset:512 sc1
    buffer_load_dwordx4 v[236:239], v100, s[4:7], s27 offen offset:512 sc1
    buffer_load_dwordx4 v[240:243], v101, s[4:7], s27 offen offset:512 sc1
    buffer_load_dwordx4 v[244:247], v102, s[4:7], s27 offen offset:512 sc1
    buffer_load_dwordx4 v[184:187], v89, s[4:7], s56 offen offset:512 sc1
    buffer_load_dwordx4 v[188:191], v100, s[4:7], s56 offen offset:512 sc1
    buffer_load_dwordx4 v[192:195], v101, s[4:7], s56 offen offset:512 sc1
    s_waitcnt vmcnt(0)
    s_nop 0
    v_max3_u32 v248, v200, v201, v202
    v_max3_u32 v248, v248, v203, v204
    v_max3_u32 v248, v248, v205, v206
    v_max3_u32 v248, v248, v207, v208
    v_max3_u32 v248, v248, v209, v210
    v_max3_u32 v248, v248, v211, v212
    v_max3_u32 v248, v248, v213, v214
    v_max_u32 v248, v248, v215
    v_cmp_eq_u32 vcc, -1, v248
    s_add_u32 s66, s66, 1
    s_cbranch_vccz L_g1back_77
    s_cmp_lt_u32 s66, s67
    s_cbranch_scc1 L_g1slow_76
    s_mov_b32 s67, 1
    s_branch L_g1back_77
L_g1slow_78:
    s_sleep 2
    s_nop 0
    buffer_load_dwordx4 v[216:219], v89, s[4:7], s26 offen offset:512 sc1
    buffer_load_dwordx4 v[220:223], v100, s[4:7], s26 offen offset:512 sc1
    buffer_load_dwordx4 v[224:227], v101, s[4:7], s26 offen offset:512 sc1
    buffer_load_dwordx4 v[228:231], v102, s[4:7], s26 offen offset:512 sc1
    buffer_load_dwordx4 v[232:235], v89, s[4:7], s27 offen offset:512 sc1
    buffer_load_dwordx4 v[236:239], v100, s[4:7], s27 offen offset:512 sc1
    buffer_load_dwordx4 v[240:243], v101, s[4:7], s27 offen offset:512 sc1
    buffer_load_dwordx4 v[244:247], v102, s[4:7], s27 offen offset:512 sc1
    buffer_load_dwordx4 v[184:187], v89, s[4:7], s56 offen offset:512 sc1
    buffer_load_dwordx4 v[188:191], v100, s[4:7], s56 offen offset:512 sc1
    buffer_load_dwordx4 v[192:195], v101, s[4:7], s56 offen offset:512 sc1
    buffer_load_dwordx4 v[196:199], v102, s[4:7], s56 offen offset:512 sc1
    buffer_load_dwordx4 v[200:203], v89, s[4:7], s57 offen offset:512 sc1
    buffer_load_dwordx4 v[204:207], v100, s[4:7], s57 offen offset:512 sc1
    buffer_load_dwordx4 v[208:211], v101, s[4:7], s57 offen offset:512 sc1
    s_waitcnt vmcnt(0)
    s_nop 0
    v_max3_u32 v248, v216, v217, v218
    v_max3_u32 v248, v248, v219, v220
    v_max3_u32 v248, v248, v221, v222
    v_max3_u32 v248, v248, v223, v224
    v_max3_u32 v248, v248, v225, v226
    v_max3_u32 v248, v248, v227, v228
    v_max3_u32 v248, v248, v229, v230
    v_max_u32 v248, v248, v231
    v_cmp_eq_u32 vcc, -1, v248
    s_add_u32 s66, s66, 1
    s_cbranch_vccz L_g1back_79
    s_cmp_lt_u32 s66, s67
    s_cbranch_scc1 L_g1slow_78
    s_mov_b32 s67, 1
    s_branch L_g1back_79
L_g1slow_80:
    s_sleep 2
    s_nop 0
    buffer_load_dwordx4 v[232:235], v89, s[4:7], s27 offen offset:512 sc1
    buffer_load_dwordx4 v[236:239], v100, s[4:7], s27 offen offset:512 sc1
    buffer_load_dwordx4 v[240:243], v101, s[4:7], s27 offen offset:512 sc1
    buffer_load_dwordx4 v[244:247], v102, s[4:7], s27 offen offset:512 sc1
    buffer_load_dwordx4 v[184:187], v89, s[4:7], s56 offen offset:512 sc1
    buffer_load_dwordx4 v[188:191], v100, s[4:7], s56 offen offset:512 sc1
    buffer_load_dwordx4 v[192:195], v101, s[4:7], s56 offen offset:512 sc1
    buffer_load_dwordx4 v[196:199], v102, s[4:7], s56 offen offset:512 sc1
    buffer_load_dwordx4 v[200:203], v89, s[4:7], s57 offen offset:512 sc1
    buffer_load_dwordx4 v[204:207], v100, s[4:7], s57 offen offset:512 sc1
    buffer_load_dwordx4 v[208:211], v101, s[4:7], s57 offen offset:512 sc1
    buffer_load_dwordx4 v[212:215], v102, s[4:7], s57 offen offset:512 sc1
    buffer_load_dwordx4 v[216:219], v89, s[4:7], s58 offen offset:512 sc1
    buffer_load_dwordx4 v[220:223], v100, s[4:7], s58 offen offset:512 sc1
    buffer_load_dwordx4 v[224:227], v101, s[4:7], s58 offen offset:512 sc1
    s_waitcnt vmcnt(0)
    s_nop 0
    v_max3_u32 v248, v232, v233, v234
    v_max3_u32 v248, v248, v235, v236
    v_max3_u32 v248, v248, v237, v238
    v_max3_u32 v248, v248, v239, v240
    v_max3_u32 v248, v248, v241, v242
    v_max3_u32 v248, v248, v243, v244
    v_max3_u32 v248, v248, v245, v246
    v_max_u32 v248, v248, v247
    v_cmp_eq_u32 vcc, -1, v248
    s_add_u32 s66, s66, 1
    s_cbranch_vccz L_g1back_81
    s_cmp_lt_u32 s66, s67
    s_cbranch_scc1 L_g1slow_80
    s_mov_b32 s67, 1
    s_branch L_g1back_81
L_g1slow_82:
    s_sleep 2
    s_nop 0
    buffer_load_dwordx4 v[184:187], v89, s[4:7], s56 offen offset:512 sc1
    buffer_load_dwordx4 v[188:191], v100, s[4:7], s56 offen offset:512 sc1
    buffer_load_dwordx4 v[192:195], v101, s[4:7], s56 offen offset:512 sc1
    buffer_load_dwordx4 v[196:199], v102, s[4:7], s56 offen offset:512 sc1
    buffer_load_dwordx4 v[200:203], v89, s[4:7], s57 offen offset:512 sc1
    buffer_load_dwordx4 v[204:207], v100, s[4:7], s57 offen offset:512 sc1
    buffer_load_dwordx4 v[208:211], v101, s[4:7], s57 offen offset:512 sc1
    buffer_load_dwordx4 v[212:215], v102, s[4:7], s57 offen offset:512 sc1
    buffer_load_dwordx4 v[216:219], v89, s[4:7], s58 offen offset:512 sc1
    buffer_load_dwordx4 v[220:223], v100, s[4:7], s58 offen offset:512 sc1
    buffer_load_dwordx4 v[224:227], v101, s[4:7], s58 offen offset:512 sc1
    buffer_load_dwordx4 v[228:231], v102, s[4:7], s58 offen offset:512 sc1
    buffer_load_dwordx4 v[232:235], v89, s[4:7], s59 offen offset:512 sc1
    buffer_load_dwordx4 v[236:239], v100, s[4:7], s59 offen offset:512 sc1
    buffer_load_dwordx4 v[240:243], v101, s[4:7], s59 offen offset:512 sc1
    s_waitcnt vmcnt(0)
    s_nop 0
    v_max3_u32 v248, v184, v185, v186
    v_max3_u32 v248, v248, v187, v188
    v_max3_u32 v248, v248, v189, v190
    v_max3_u32 v248, v248, v191, v192
    v_max3_u32 v248, v248, v193, v194
    v_max3_u32 v248, v248, v195, v196
    v_max3_u32 v248, v248, v197, v198
    v_max_u32 v248, v248, v199
    v_cmp_eq_u32 vcc, -1, v248
    s_add_u32 s66, s66, 1
    s_cbranch_vccz L_g1back_83
    s_cmp_lt_u32 s66, s67
    s_cbranch_scc1 L_g1slow_82
    s_mov_b32 s67, 1
    s_branch L_g1back_83
L_g1slow_87:
    s_sleep 2
    s_nop 0
    buffer_load_dwordx4 v[200:203], v89, s[4:7], s57 offen offset:512 sc1
    buffer_load_dwordx4 v[204:207], v100, s[4:7], s57 offen offset:512 sc1
    buffer_load_dwordx4 v[208:211], v101, s[4:7], s57 offen offset:512 sc1
    buffer_load_dwordx4 v[212:215], v102, s[4:7], s57 offen offset:512 sc1
    buffer_load_dwordx4 v[216:219], v89, s[4:7], s58 offen offset:512 sc1
    buffer_load_dwordx4 v[220:223], v100, s[4:7], s58 offen offset:512 sc1
    buffer_load_dwordx4 v[224:227], v101, s[4:7], s58 offen offset:512 sc1
    buffer_load_dwordx4 v[228:231], v102, s[4:7], s58 offen offset:512 sc1
    buffer_load_dwordx4 v[232:235], v89, s[4:7], s59 offen offset:512 sc1
    buffer_load_dwordx4 v[236:239], v100, s[4:7], s59 offen offset:512 sc1
    buffer_load_dwordx4 v[240:243], v101, s[4:7], s59 offen offset:512 sc1
    buffer_load_dwordx4 v[244:247], v102, s[4:7], s59 offen offset:512 sc1
    s_waitcnt vmcnt(0)
    s_nop 0
    v_max3_u32 v248, v200, v201, v202
    v_max3_u32 v248, v248, v203, v204
    v_max3_u32 v248, v248, v205, v206
    v_max3_u32 v248, v248, v207, v208
    v_max3_u32 v248, v248, v209, v210
    v_max3_u32 v248, v248, v211, v212
    v_max3_u32 v248, v248, v213, v214
    v_max_u32 v248, v248, v215
    v_cmp_eq_u32 vcc, -1, v248
    s_add_u32 s66, s66, 1
    s_cbranch_vccz L_g1back_88
    s_cmp_lt_u32 s66, s67
    s_cbranch_scc1 L_g1slow_87
    s_mov_b32 s67, 1
    s_branch L_g1back_88
L_g1slow_89:
    s_sleep 2
    s_nop 0
    buffer_load_dwordx4 v[216:219], v89, s[4:7], s58 offen offset:512 sc1
    buffer_load_dwordx4 v[220:223], v100, s[4:7], s58 offen offset:512 sc1
    buffer_load_dwordx4 v[224:227], v101, s[4:7], s58 offen offset:512 sc1
    buffer_load_dwordx4 v[228:231], v102, s[4:7], s58 offen offset:512 sc1
    buffer_load_dwordx4 v[232:235], v89, s[4:7], s59 offen offset:512 sc1
    buffer_load_dwordx4 v[236:239], v100, s[4:7], s59 offen offset:512 sc1
    buffer_load_dwordx4 v[240:243], v101, s[4:7], s59 offen offset:512 sc1
    buffer_load_dwordx4 v[244:247], v102, s[4:7], s59 offen offset:512 sc1
    s_waitcnt vmcnt(0)
    s_nop 0
    v_max3_u32 v248, v216, v217, v218
    v_max3_u32 v248, v248, v219, v220
    v_max3_u32 v248, v248, v221, v222
    v_max3_u32 v248, v248, v223, v224
    v_max3_u32 v248, v248, v225, v226
    v_max3_u32 v248, v248, v227, v228
    v_max3_u32 v248, v248, v229, v230
    v_max_u32 v248, v248, v231
    v_cmp_eq_u32 vcc, -1, v248
    s_add_u32 s66, s66, 1
    s_cbranch_vccz L_g1back_90
    s_cmp_lt_u32 s66, s67
    s_cbranch_scc1 L_g1slow_89
    s_mov_b32 s67, 1
    s_branch L_g1back_90
L_g1slow_91:
    s_sleep 2
    s_nop 0
    buffer_load_dwordx4 v[232:235], v89, s[4:7], s59 offen offset:512 sc1
    buffer_load_dwordx4 v[236:239], v100, s[4:7], s59 offen offset:512 sc1
    buffer_load_dwordx4 v[240:243], v101, s[4:7], s59 offen offset:512 sc1
    buffer_load_dwordx4 v[244:247], v102, s[4:7], s59 offen offset:512 sc1
    s_waitcnt vmcnt(0)
    s_nop 0
    v_max3_u32 v248, v232, v233, v234
    v_max3_u32 v248, v248, v235, v236
    v_max3_u32 v248, v248, v237, v238
    v_max3_u32 v248, v248, v239, v240
    v_max3_u32 v248, v248, v241, v242
    v_max3_u32 v248, v248, v243, v244
    v_max3_u32 v248, v248, v245, v246
    v_max_u32 v248, v248, v247
    v_cmp_eq_u32 vcc, -1, v248
    s_add_u32 s66, s66, 1
    s_cbranch_vccz L_g1back_92
    s_cmp_lt_u32 s66, s67
    s_cbranch_scc1 L_g1slow_91
    s_mov_b32 s67, 1
    s_branch L_g1back_92
L_g1slow_93:
    s_sleep 2
    s_nop 0
    buffer_load_dwordx4 v[184:187], v89, s[4:7], s24 offen offset:0 sc1
    buffer_load_dwordx4 v[188:191], v100, s[4:7], s24 offen offset:0 sc1
    buffer_load_dwordx4 v[192:195], v101, s[4:7], s24 offen offset:0 sc1
    buffer_load_dwordx4 v[196:199], v102, s[4:7], s24 offen offset:0 sc1
    buffer_load_dwordx4 v[200:203], v89, s[4:7], s25 offen offset:0 sc1
    buffer_load_dwordx4 v[204:207], v100, s[4:7], s25 offen offset:0 sc1
    buffer_load_dwordx4 v[208:211], v101, s[4:7], s25 offen offset:0 sc1
    buffer_load_dwordx4 v[212:215], v102, s[4:7], s25 offen offset:0 sc1
    buffer_load_dwordx4 v[216:219], v89, s[4:7], s26 offen offset:0 sc1
    buffer_load_dwordx4 v[220:223], v100, s[4:7], s26 offen offset:0 sc1
    buffer_load_dwordx4 v[224:227], v101, s[4:7], s26 offen offset:0 sc1
    buffer_load_dwordx4 v[228:231], v102, s[4:7], s26 offen offset:0 sc1
    buffer_load_dwordx4 v[232:235], v89, s[4:7], s27 offen offset:0 sc1
    buffer_load_dwordx4 v[236:239], v100, s[4:7], s27 offen offset:0 sc1
    buffer_load_dwordx4 v[240:243], v101, s[4:7], s27 offen offset:0 sc1
    buffer_load_dwordx4 v[244:247], v102, s[4:7], s27 offen offset:0 sc1
    s_waitcnt vmcnt(0)
    s_nop 0
    v_max3_u32 v118, v184, v185, v186
    v_max3_u32 v118, v118, v187, v188
    v_max3_u32 v118, v118, v189, v190
    v_max3_u32 v118, v118, v191, v192
    v_max3_u32 v118, v118, v193, v194
    v_max3_u32 v118, v118, v195, v196
    v_max3_u32 v118, v118, v197, v198
    v_max_u32 v118, v118, v199
    v_cmp_eq_u32 vcc, -1, v118
    s_add_u32 s66, s66, 1
    s_cbranch_vccz L_g1back_94
    s_cmp_lt_u32 s66, s67
    s_cbranch_scc1 L_g1slow_93
    s_mov_b32 s67, 1
    s_branch L_g1back_94
L_g1slow_95:
    s_sleep 2
    s_nop 0
    buffer_load_dwordx4 v[200:203], v89, s[4:7], s25 offen offset:0 sc1
    buffer_load_dwordx4 v[204:207], v100, s[4:7], s25 offen offset:0 sc1
    buffer_load_dwordx4 v[208:211], v101, s[4:7], s25 offen offset:0 sc1
    buffer_load_dwordx4 v[212:215], v102, s[4:7], s25 offen offset:0 sc1
    buffer_load_dwordx4 v[216:219], v89, s[4:7], s26 offen offset:0 sc1
    buffer_load_dwordx4 v[220:223], v100, s[4:7], s26 offen offset:0 sc1
    buffer_load_dwordx4 v[224:227], v101, s[4:7], s26 offen offset:0 sc1
    buffer_load_dwordx4 v[228:231], v102, s[4:7], s26 offen offset:0 sc1
    buffer_load_dwordx4 v[232:235], v89, s[4:7], s27 offen offset:0 sc1
    buffer_load_dwordx4 v[236:239], v100, s[4:7], s27 offen offset:0 sc1
    buffer_load_dwordx4 v[240:243], v101, s[4:7], s27 offen offset:0 sc1
    buffer_load_dwordx4 v[244:247], v102, s[4:7], s27 offen offset:0 sc1
    buffer_load_dwordx4 v[184:187], v89, s[4:7], s56 offen offset:0 sc1
    buffer_load_dwordx4 v[188:191], v100, s[4:7], s56 offen offset:0 sc1
    buffer_load_dwordx4 v[192:195], v101, s[4:7], s56 offen offset:0 sc1
    s_waitcnt vmcnt(0)
    s_nop 0
    v_max3_u32 v118, v200, v201, v202
    v_max3_u32 v118, v118, v203, v204
    v_max3_u32 v118, v118, v205, v206
    v_max3_u32 v118, v118, v207, v208
    v_max3_u32 v118, v118, v209, v210
    v_max3_u32 v118, v118, v211, v212
    v_max3_u32 v118, v118, v213, v214
    v_max_u32 v118, v118, v215
    v_cmp_eq_u32 vcc, -1, v118
    s_add_u32 s66, s66, 1
    s_cbranch_vccz L_g1back_96
    s_cmp_lt_u32 s66, s67
    s_cbranch_scc1 L_g1slow_95
    s_mov_b32 s67, 1
    s_branch L_g1back_96
L_g1slow_97:
    s_sleep 2
    s_nop 0
    buffer_load_dwordx4 v[216:219], v89, s[4:7], s26 offen offset:0 sc1
    buffer_load_dwordx4 v[220:223], v100, s[4:7], s26 offen offset:0 sc1
    buffer_load_dwordx4 v[224:227], v101, s[4:7], s26 offen offset:0 sc1
    buffer_load_dwordx4 v[228:231], v102, s[4:7], s26 offen offset:0 sc1
    buffer_load_dwordx4 v[232:235], v89, s[4:7], s27 offen offset:0 sc1
    buffer_load_dwordx4 v[236:239], v100, s[4:7], s27 offen offset:0 sc1
    buffer_load_dwordx4 v[240:243], v101, s[4:7], s27 offen offset:0 sc1
    buffer_load_dwordx4 v[244:247], v102, s[4:7], s27 offen offset:0 sc1
    buffer_load_dwordx4 v[184:187], v89, s[4:7], s56 offen offset:0 sc1
    buffer_load_dwordx4 v[188:191], v100, s[4:7], s56 offen offset:0 sc1
    buffer_load_dwordx4 v[192:195], v101, s[4:7], s56 offen offset:0 sc1
    buffer_load_dwordx4 v[196:199], v102, s[4:7], s56 offen offset:0 sc1
    buffer_load_dwordx4 v[200:203], v89, s[4:7], s57 offen offset:0 sc1
    buffer_load_dwordx4 v[204:207], v100, s[4:7], s57 offen offset:0 sc1
    buffer_load_dwordx4 v[208:211], v101, s[4:7], s57 offen offset:0 sc1
    s_waitcnt vmcnt(0)
    s_nop 0
    v_max3_u32 v118, v216, v217, v218
    v_max3_u32 v118, v118, v219, v220
    v_max3_u32 v118, v118, v221, v222
    v_max3_u32 v118, v118, v223, v224
    v_max3_u32 v118, v118, v225, v226
    v_max3_u32 v118, v118, v227, v228
    v_max3_u32 v118, v118, v229, v230
    v_max_u32 v118, v118, v231
    v_cmp_eq_u32 vcc, -1, v118
    s_add_u32 s66, s66, 1
    s_cbranch_vccz L_g1back_98
    s_cmp_lt_u32 s66, s67
    s_cbranch_scc1 L_g1slow_97
    s_mov_b32 s67, 1
    s_branch L_g1back_98
L_g1slow_99:
    s_sleep 2
    s_nop 0
    buffer_load_dwordx4 v[232:235], v89, s[4:7], s27 offen offset:0 sc1
    buffer_load_dwordx4 v[236:239], v100, s[4:7], s27 offen offset:0 sc1
    buffer_load_dwordx4 v[240:243], v101, s[4:7], s27 offen offset:0 sc1
    buffer_load_dwordx4 v[244:247], v102, s[4:7], s27 offen offset:0 sc1
    buffer_load_dwordx4 v[184:187], v89, s[4:7], s56 offen offset:0 sc1
    buffer_load_dwordx4 v[188:191], v100, s[4:7], s56 offen offset:0 sc1
    buffer_load_dwordx4 v[192:195], v101, s[4:7], s56 offen offset:0 sc1
    buffer_load_dwordx4 v[196:199], v102, s[4:7], s56 offen offset:0 sc1
    buffer_load_dwordx4 v[200:203], v89, s[4:7], s57 offen offset:0 sc1
    buffer_load_dwordx4 v[204:207], v100, s[4:7], s57 offen offset:0 sc1
    buffer_load_dwordx4 v[208:211], v101, s[4:7], s57 offen offset:0 sc1
    buffer_load_dwordx4 v[212:215], v102, s[4:7], s57 offen offset:0 sc1
    buffer_load_dwordx4 v[216:219], v89, s[4:7], s58 offen offset:0 sc1
    buffer_load_dwordx4 v[220:223], v100, s[4:7], s58 offen offset:0 sc1
    buffer_load_dwordx4 v[224:227], v101, s[4:7], s58 offen offset:0 sc1
    s_waitcnt vmcnt(0)
    s_nop 0
    v_max3_u32 v118, v232, v233, v234
    v_max3_u32 v118, v118, v235, v236
    v_max3_u32 v118, v118, v237, v238
    v_max3_u32 v118, v118, v239, v240
    v_max3_u32 v118, v118, v241, v242
    v_max3_u32 v118, v118, v243, v244
    v_max3_u32 v118, v118, v245, v246
    v_max_u32 v118, v118, v247
    v_cmp_eq_u32 vcc, -1, v118
    s_add_u32 s66, s66, 1
    s_cbranch_vccz L_g1back_100
    s_cmp_lt_u32 s66, s67
    s_cbranch_scc1 L_g1slow_99
    s_mov_b32 s67, 1
    s_branch L_g1back_100
L_g1slow_101:
    s_sleep 2
    s_nop 0
    buffer_load_dwordx4 v[184:187], v89, s[4:7], s56 offen offset:0 sc1
    buffer_load_dwordx4 v[188:191], v100, s[4:7], s56 offen offset:0 sc1
    buffer_load_dwordx4 v[192:195], v101, s[4:7], s56 offen offset:0 sc1
    buffer_load_dwordx4 v[196:199], v102, s[4:7], s56 offen offset:0 sc1
    buffer_load_dwordx4 v[200:203], v89, s[4:7], s57 offen offset:0 sc1
    buffer_load_dwordx4 v[204:207], v100, s[4:7], s57 offen offset:0 sc1
    buffer_load_dwordx4 v[208:211], v101, s[4:7], s57 offen offset:0 sc1
    buffer_load_dwordx4 v[212:215], v102, s[4:7], s57 offen offset:0 sc1
    buffer_load_dwordx4 v[216:219], v89, s[4:7], s58 offen offset:0 sc1
    buffer_load_dwordx4 v[220:223], v100, s[4:7], s58 offen offset:0 sc1
    buffer_load_dwordx4 v[224:227], v101, s[4:7], s58 offen offset:0 sc1
    buffer_load_dwordx4 v[228:231], v102, s[4:7], s58 offen offset:0 sc1
    buffer_load_dwordx4 v[232:235], v89, s[4:7], s59 offen offset:0 sc1
    buffer_load_dwordx4 v[236:239], v100, s[4:7], s59 offen offset:0 sc1
    buffer_load_dwordx4 v[240:243], v101, s[4:7], s59 offen offset:0 sc1
    s_waitcnt vmcnt(0)
    s_nop 0
    v_max3_u32 v118, v184, v185, v186
    v_max3_u32 v118, v118, v187, v188
    v_max3_u32 v118, v118, v189, v190
    v_max3_u32 v118, v118, v191, v192
    v_max3_u32 v118, v118, v193, v194
    v_max3_u32 v118, v118, v195, v196
    v_max3_u32 v118, v118, v197, v198
    v_max_u32 v118, v118, v199
    v_cmp_eq_u32 vcc, -1, v118
    s_add_u32 s66, s66, 1
    s_cbranch_vccz L_g1back_102
    s_cmp_lt_u32 s66, s67
    s_cbranch_scc1 L_g1slow_101
    s_mov_b32 s67, 1
    s_branch L_g1back_102
L_g1slow_103:
    s_sleep 2
    s_nop 0
    buffer_load_dwordx4 v[200:203], v89, s[4:7], s57 offen offset:0 sc1
    buffer_load_dwordx4 v[204:207], v100, s[4:7], s57 offen offset:0 sc1
    buffer_load_dwordx4 v[208:211], v101, s[4:7], s57 offen offset:0 sc1
    buffer_load_dwordx4 v[212:215], v102, s[4:7], s57 offen offset:0 sc1
    buffer_load_dwordx4 v[216:219], v89, s[4:7], s58 offen offset:0 sc1
    buffer_load_dwordx4 v[220:223], v100, s[4:7], s58 offen offset:0 sc1
    buffer_load_dwordx4 v[224:227], v101, s[4:7], s58 offen offset:0 sc1
    buffer_load_dwordx4 v[228:231], v102, s[4:7], s58 offen offset:0 sc1
    buffer_load_dwordx4 v[232:235], v89, s[4:7], s59 offen offset:0 sc1
    buffer_load_dwordx4 v[236:239], v100, s[4:7], s59 offen offset:0 sc1
    buffer_load_dwordx4 v[240:243], v101, s[4:7], s59 offen offset:0 sc1
    buffer_load_dwordx4 v[244:247], v102, s[4:7], s59 offen offset:0 sc1
    buffer_load_dwordx4 v[184:187], v89, s[4:7], s24 offen offset:512 sc1
    buffer_load_dwordx4 v[188:191], v100, s[4:7], s24 offen offset:512 sc1
    buffer_load_dwordx4 v[192:195], v101, s[4:7], s24 offen offset:512 sc1
    s_waitcnt vmcnt(0)
    s_nop 0
    v_max3_u32 v118, v200, v201, v202
    v_max3_u32 v118, v118, v203, v204
    v_max3_u32 v118, v118, v205, v206
    v_max3_u32 v118, v118, v207, v208
    v_max3_u32 v118, v118, v209, v210
    v_max3_u32 v118, v118, v211, v212
    v_max3_u32 v118, v118, v213, v214
    v_max_u32 v118, v118, v215
    v_cmp_eq_u32 vcc, -1, v118
    s_add_u32 s66, s66, 1
    s_cbranch_vccz L_g1back_104
    s_cmp_lt_u32 s66, s67
    s_cbranch_scc1 L_g1slow_103
    s_mov_b32 s67, 1
    s_branch L_g1back_104
L_g1slow_105:
    s_sleep 2
    s_nop 0
    buffer_load_dwordx4 v[216:219], v89, s[4:7], s58 offen offset:0 sc1
    buffer_load_dwordx4 v[220:223], v100, s[4:7], s58 offen offset:0 sc1
    buffer_load_dwordx4 v[224:227], v101, s[4:7], s58 offen offset:0 sc1
    buffer_load_dwordx4 v[228:231], v102, s[4:7], s58 offen offset:0 sc1
    buffer_load_dwordx4 v[232:235], v89, s[4:7], s59 offen offset:0 sc1
    buffer_load_dwordx4 v[236:239], v100, s[4:7], s59 offen offset:0 sc1
    buffer_load_dwordx4 v[240:243], v101, s[4:7], s59 offen offset:0 sc1
    buffer_load_dwordx4 v[244:247], v102, s[4:7], s59 offen offset:0 sc1
    buffer_load_dwordx4 v[184:187], v89, s[4:7], s24 offen offset:512 sc1
    buffer_load_dwordx4 v[188:191], v100, s[4:7], s24 offen offset:512 sc1
    buffer_load_dwordx4 v[192:195], v101, s[4:7], s24 offen offset:512 sc1
    buffer_load_dwordx4 v[196:199], v102, s[4:7], s24 offen offset:512 sc1
    buffer_load_dwordx4 v[200:203], v89, s[4:7], s25 offen offset:512 sc1
    buffer_load_dwordx4 v[204:207], v100, s[4:7], s25 offen offset:512 sc1
    buffer_load_dwordx4 v[208:211], v101, s[4:7], s25 offen offset:512 sc1
    s_waitcnt vmcnt(0)
    s_nop 0
    v_max3_u32 v118, v216, v217, v218
    v_max3_u32 v118, v118, v219, v220
    v_max3_u32 v118, v118, v221, v222
    v_max3_u32 v118, v118, v223, v224
    v_max3_u32 v118, v118, v225, v226
    v_max3_u32 v118, v118, v227, v228
    v_max3_u32 v118, v118, v229, v230
    v_max_u32 v118, v118, v231
    v_cmp_eq_u32 vcc, -1, v118
    s_add_u32 s66, s66, 1
    s_cbranch_vccz L_g1back_106
    s_cmp_lt_u32 s66, s67
    s_cbranch_scc1 L_g1slow_105
    s_mov_b32 s67, 1
    s_branch L_g1back_106
L_g1slow_107:
    s_sleep 2
    s_nop 0
    buffer_load_dwordx4 v[232:235], v89, s[4:7], s59 offen offset:0 sc1
    buffer_load_dwordx4 v[236:239], v100, s[4:7], s59 offen offset:0 sc1
    buffer_load_dwordx4 v[240:243], v101, s[4:7], s59 offen offset:0 sc1
    buffer_load_dwordx4 v[244:247], v102, s[4:7], s59 offen offset:0 sc1
    buffer_load_dwordx4 v[184:187], v89, s[4:7], s24 offen offset:512 sc1
    buffer_load_dwordx4 v[188:191], v100, s[4:7], s24 offen offset:512 sc1
    buffer_load_dwordx4 v[192:195], v101, s[4:7], s24 offen offset:512 sc1
    buffer_load_dwordx4 v[196:199], v102, s[4:7], s24 offen offset:512 sc1
    buffer_load_dwordx4 v[200:203], v89, s[4:7], s25 offen offset:512 sc1
    buffer_load_dwordx4 v[204:207], v100, s[4:7], s25 offen offset:512 sc1
    buffer_load_dwordx4 v[208:211], v101, s[4:7], s25 offen offset:512 sc1
    buffer_load_dwordx4 v[212:215], v102, s[4:7], s25 offen offset:512 sc1
    buffer_load_dwordx4 v[216:219], v89, s[4:7], s26 offen offset:512 sc1
    buffer_load_dwordx4 v[220:223], v100, s[4:7], s26 offen offset:512 sc1
    buffer_load_dwordx4 v[224:227], v101, s[4:7], s26 offen offset:512 sc1
    s_waitcnt vmcnt(0)
    s_nop 0
    v_max3_u32 v118, v232, v233, v234
    v_max3_u32 v118, v118, v235, v236
    v_max3_u32 v118, v118, v237, v238
    v_max3_u32 v118, v118, v239, v240
    v_max3_u32 v118, v118, v241, v242
    v_max3_u32 v118, v118, v243, v244
    v_max3_u32 v118, v118, v245, v246
    v_max_u32 v118, v118, v247
    v_cmp_eq_u32 vcc, -1, v118
    s_add_u32 s66, s66, 1
    s_cbranch_vccz L_g1back_108
    s_cmp_lt_u32 s66, s67
    s_cbranch_scc1 L_g1slow_107
    s_mov_b32 s67, 1
    s_branch L_g1back_108
L_g1slow_109:
    s_sleep 2
    s_nop 0
    buffer_load_dwordx4 v[184:187], v89, s[4:7], s24 offen offset:512 sc1
    buffer_load_dwordx4 v[188:191], v100, s[4:7], s24 offen offset:512 sc1
    buffer_load_dwordx4 v[192:195], v101, s[4:7], s24 offen offset:512 sc1
    buffer_load_dwordx4 v[196:199], v102, s[4:7], s24 offen offset:512 sc1
    buffer_load_dwordx4 v[200:203], v89, s[4:7], s25 offen offset:512 sc1
    buffer_load_dwordx4 v[204:207], v100, s[4:7], s25 offen offset:512 sc1
    buffer_load_dwordx4 v[208:211], v101, s[4:7], s25 offen offset:512 sc1
    buffer_load_dwordx4 v[212:215], v102, s[4:7], s25 offen offset:512 sc1
    buffer_load_dwordx4 v[216:219], v89, s[4:7], s26 offen offset:512 sc1
    buffer_load_dwordx4 v[220:223], v100, s[4:7], s26 offen offset:512 sc1
    buffer_load_dwordx4 v[224:227], v101, s[4:7], s26 offen offset:512 sc1
    buffer_load_dwordx4 v[228:231], v102, s[4:7], s26 offen offset:512 sc1
    buffer_load_dwordx4 v[232:235], v89, s[4:7], s27 offen offset:512 sc1
    buffer_load_dwordx4 v[236:239], v100, s[4:7], s27 offen offset:512 sc1
    buffer_load_dwordx4 v[240:243], v101, s[4:7], s27 offen offset:512 sc1
    s_waitcnt vmcnt(0)
    s_nop 0
    v_max3_u32 v118, v184, v185, v186
    v_max3_u32 v118, v118, v187, v188
    v_max3_u32 v118, v118, v189, v190
    v_max3_u32 v118, v118, v191, v192
    v_max3_u32 v118, v118, v193, v194
    v_max3_u32 v118, v118, v195, v196
    v_max3_u32 v118, v118, v197, v198
    v_max_u32 v118, v118, v199
    v_cmp_eq_u32 vcc, -1, v118
    s_add_u32 s66, s66, 1
    s_cbranch_vccz L_g1back_110
    s_cmp_lt_u32 s66, s67
    s_cbranch_scc1 L_g1slow_109
    s_mov_b32 s67, 1
    s_branch L_g1back_110
L_g1slow_112:
    s_sleep 2
    s_nop 0
    buffer_load_dwordx4 v[200:203], v89, s[4:7], s25 offen offset:512 sc1
    buffer_load_dwordx4 v[204:207], v100, s[4:7], s25 offen offset:512 sc1
    buffer_load_dwordx4 v[208:211], v101, s[4:7], s25 offen offset:512 sc1
    buffer_load_dwordx4 v[212:215], v102, s[4:7], s25 offen offset:512 sc1
    buffer_load_dwordx4 v[216:219], v89, s[4:7], s26 offen offset:512 sc1
    buffer_load_dwordx4 v[220:223], v100, s[4:7], s26 offen offset:512 sc1
    buffer_load_dwordx4 v[224:227], v101, s[4:7], s26 offen offset:512 sc1
    buffer_load_dwordx4 v[228:231], v102, s[4:7], s26 offen offset:512 sc1
    buffer_load_dwordx4 v[232:235], v89, s[4:7], s27 offen offset:512 sc1
    buffer_load_dwordx4 v[236:239], v100, s[4:7], s27 offen offset:512 sc1
    buffer_load_dwordx4 v[240:243], v101, s[4:7], s27 offen offset:512 sc1
    buffer_load_dwordx4 v[244:247], v102, s[4:7], s27 offen offset:512 sc1
    buffer_load_dwordx4 v[184:187], v89, s[4:7], s56 offen offset:512 sc1
    buffer_load_dwordx4 v[188:191], v100, s[4:7], s56 offen offset:512 sc1
    buffer_load_dwordx4 v[192:195], v101, s[4:7], s56 offen offset:512 sc1
    s_waitcnt vmcnt(0)
    s_nop 0
    v_max3_u32 v118, v200, v201, v202
    v_max3_u32 v118, v118, v203, v204
    v_max3_u32 v118, v118, v205, v206
    v_max3_u32 v118, v118, v207, v208
    v_max3_u32 v118, v118, v209, v210
    v_max3_u32 v118, v118, v211, v212
    v_max3_u32 v118, v118, v213, v214
    v_max_u32 v118, v118, v215
    v_cmp_eq_u32 vcc, -1, v118
    s_add_u32 s66, s66, 1
    s_cbranch_vccz L_g1back_113
    s_cmp_lt_u32 s66, s67
    s_cbranch_scc1 L_g1slow_112
    s_mov_b32 s67, 1
    s_branch L_g1back_113
L_g1slow_114:
    s_sleep 2
    s_nop 0
    buffer_load_dwordx4 v[216:219], v89, s[4:7], s26 offen offset:512 sc1
    buffer_load_dwordx4 v[220:223], v100, s[4:7], s26 offen offset:512 sc1
    buffer_load_dwordx4 v[224:227], v101, s[4:7], s26 offen offset:512 sc1
    buffer_load_dwordx4 v[228:231], v102, s[4:7], s26 offen offset:512 sc1
    buffer_load_dwordx4 v[232:235], v89, s[4:7], s27 offen offset:512 sc1
    buffer_load_dwordx4 v[236:239], v100, s[4:7], s27 offen offset:512 sc1
    buffer_load_dwordx4 v[240:243], v101, s[4:7], s27 offen offset:512 sc1
    buffer_load_dwordx4 v[244:247], v102, s[4:7], s27 offen offset:512 sc1
    buffer_load_dwordx4 v[184:187], v89, s[4:7], s56 offen offset:512 sc1
    buffer_load_dwordx4 v[188:191], v100, s[4:7], s56 offen offset:512 sc1
    buffer_load_dwordx4 v[192:195], v101, s[4:7], s56 offen offset:512 sc1
    buffer_load_dwordx4 v[196:199], v102, s[4:7], s56 offen offset:512 sc1
    buffer_load_dwordx4 v[200:203], v89, s[4:7], s57 offen offset:512 sc1
    buffer_load_dwordx4 v[204:207], v100, s[4:7], s57 offen offset:512 sc1
    buffer_load_dwordx4 v[208:211], v101, s[4:7], s57 offen offset:512 sc1
    s_waitcnt vmcnt(0)
    s_nop 0
    v_max3_u32 v118, v216, v217, v218
    v_max3_u32 v118, v118, v219, v220
    v_max3_u32 v118, v118, v221, v222
    v_max3_u32 v118, v118, v223, v224
    v_max3_u32 v118, v118, v225, v226
    v_max3_u32 v118, v118, v227, v228
    v_max3_u32 v118, v118, v229, v230
    v_max_u32 v118, v118, v231
    v_cmp_eq_u32 vcc, -1, v118
    s_add_u32 s66, s66, 1
    s_cbranch_vccz L_g1back_115
    s_cmp_lt_u32 s66, s67
    s_cbranch_scc1 L_g1slow_114
    s_mov_b32 s67, 1
    s_branch L_g1back_115
L_g1slow_116:
    s_sleep 2
    s_nop 0
    buffer_load_dwordx4 v[232:235], v89, s[4:7], s27 offen offset:512 sc1
    buffer_load_dwordx4 v[236:239], v100, s[4:7], s27 offen offset:512 sc1
    buffer_load_dwordx4 v[240:243], v101, s[4:7], s27 offen offset:512 sc1
    buffer_load_dwordx4 v[244:247], v102, s[4:7], s27 offen offset:512 sc1
    buffer_load_dwordx4 v[184:187], v89, s[4:7], s56 offen offset:512 sc1
    buffer_load_dwordx4 v[188:191], v100, s[4:7], s56 offen offset:512 sc1
    buffer_load_dwordx4 v[192:195], v101, s[4:7], s56 offen offset:512 sc1
    buffer_load_dwordx4 v[196:199], v102, s[4:7], s56 offen offset:512 sc1
    buffer_load_dwordx4 v[200:203], v89, s[4:7], s57 offen offset:512 sc1
    buffer_load_dwordx4 v[204:207], v100, s[4:7], s57 offen offset:512 sc1
    buffer_load_dwordx4 v[208:211], v101, s[4:7], s57 offen offset:512 sc1
    buffer_load_dwordx4 v[212:215], v102, s[4:7], s57 offen offset:512 sc1
    buffer_load_dwordx4 v[216:219], v89, s[4:7], s58 offen offset:512 sc1
    buffer_load_dwordx4 v[220:223], v100, s[4:7], s58 offen offset:512 sc1
    buffer_load_dwordx4 v[224:227], v101, s[4:7], s58 offen offset:512 sc1
    s_waitcnt vmcnt(0)
    s_nop 0
    v_max3_u32 v118, v232, v233, v234
    v_max3_u32 v118, v118, v235, v236
    v_max3_u32 v118, v118, v237, v238
    v_max3_u32 v118, v118, v239, v240
    v_max3_u32 v118, v118, v241, v242
    v_max3_u32 v118, v118, v243, v244
    v_max3_u32 v118, v118, v245, v246
    v_max_u32 v118, v118, v247
    v_cmp_eq_u32 vcc, -1, v118
    s_add_u32 s66, s66, 1
    s_cbranch_vccz L_g1back_117
    s_cmp_lt_u32 s66, s67
    s_cbranch_scc1 L_g1slow_116
    s_mov_b32 s67, 1
    s_branch L_g1back_117
L_g1slow_118:
    s_sleep 2
    s_nop 0
    buffer_load_dwordx4 v[184:187], v89, s[4:7], s56 offen offset:512 sc1
    buffer_load_dwordx4 v[188:191], v100, s[4:7], s56 offen offset:512 sc1
    buffer_load_dwordx4 v[192:195], v101, s[4:7], s56 offen offset:512 sc1
    buffer_load_dwordx4 v[196:199], v102, s[4:7], s56 offen offset:512 sc1
    buffer_load_dwordx4 v[200:203], v89, s[4:7], s57 offen offset:512 sc1
    buffer_load_dwordx4 v[204:207], v100, s[4:7], s57 offen offset:512 sc1
    buffer_load_dwordx4 v[208:211], v101, s[4:7], s57 offen offset:512 sc1
    buffer_load_dwordx4 v[212:215], v102, s[4:7], s57 offen offset:512 sc1
    buffer_load_dwordx4 v[216:219], v89, s[4:7], s58 offen offset:512 sc1
    buffer_load_dwordx4 v[220:223], v100, s[4:7], s58 offen offset:512 sc1
    buffer_load_dwordx4 v[224:227], v101, s[4:7], s58 offen offset:512 sc1
    buffer_load_dwordx4 v[228:231], v102, s[4:7], s58 offen offset:512 sc1
    buffer_load_dwordx4 v[232:235], v89, s[4:7], s59 offen offset:512 sc1
    buffer_load_dwordx4 v[236:239], v100, s[4:7], s59 offen offset:512 sc1
    buffer_load_dwordx4 v[240:243], v101, s[4:7], s59 offen offset:512 sc1
    s_waitcnt vmcnt(0)
    s_nop 0
    v_max3_u32 v118, v184, v185, v186
    v_max3_u32 v118, v118, v187, v188
    v_max3_u32 v118, v118, v189, v190
    v_max3_u32 v118, v118, v191, v192
    v_max3_u32 v118, v118, v193, v194
    v_max3_u32 v118, v118, v195, v196
    v_max3_u32 v118, v118, v197, v198
    v_max_u32 v118, v118, v199
    v_cmp_eq_u32 vcc, -1, v118
    s_add_u32 s66, s66, 1
    s_cbranch_vccz L_g1back_119
    s_cmp_lt_u32 s66, s67
    s_cbranch_scc1 L_g1slow_118
    s_mov_b32 s67, 1
    s_branch L_g1back_119
L_g1slow_120:
    s_sleep 2
    s_nop 0
    buffer_load_dwordx4 v[200:203], v89, s[4:7], s57 offen offset:512 sc1
    buffer_load_dwordx4 v[204:207], v100, s[4:7], s57 offen offset:512 sc1
    buffer_load_dwordx4 v[208:211], v101, s[4:7], s57 offen offset:512 sc1
    buffer_load_dwordx4 v[212:215], v102, s[4:7], s57 offen offset:512 sc1
    buffer_load_dwordx4 v[216:219], v89, s[4:7], s58 offen offset:512 sc1
    buffer_load_dwordx4 v[220:223], v100, s[4:7], s58 offen offset:512 sc1
    buffer_load_dwordx4 v[224:227], v101, s[4:7], s58 offen offset:512 sc1
    buffer_load_dwordx4 v[228:231], v102, s[4:7], s58 offen offset:512 sc1
    buffer_load_dwordx4 v[232:235], v89, s[4:7], s59 offen offset:512 sc1
    buffer_load_dwordx4 v[236:239], v100, s[4:7], s59 offen offset:512 sc1
    buffer_load_dwordx4 v[240:243], v101, s[4:7], s59 offen offset:512 sc1
    buffer_load_dwordx4 v[244:247], v102, s[4:7], s59 offen offset:512 sc1
    s_waitcnt vmcnt(0)
    s_nop 0
    v_max3_u32 v118, v200, v201, v202
    v_max3_u32 v118, v118, v203, v204
    v_max3_u32 v118, v118, v205, v206
    v_max3_u32 v118, v118, v207, v208
    v_max3_u32 v118, v118, v209, v210
    v_max3_u32 v118, v118, v211, v212
    v_max3_u32 v118, v118, v213, v214
    v_max_u32 v118, v118, v215
    v_cmp_eq_u32 vcc, -1, v118
    s_add_u32 s66, s66, 1
    s_cbranch_vccz L_g1back_121
    s_cmp_lt_u32 s66, s67
    s_cbranch_scc1 L_g1slow_120
    s_mov_b32 s67, 1
    s_branch L_g1back_121
L_g1slow_122:
    s_sleep 2
    s_nop 0
    buffer_load_dwordx4 v[216:219], v89, s[4:7], s58 offen offset:512 sc1
    buffer_load_dwordx4 v[220:223], v100, s[4:7], s58 offen offset:512 sc1
    buffer_load_dwordx4 v[224:227], v101, s[4:7], s58 offen offset:512 sc1
    buffer_load_dwordx4 v[228:231], v102, s[4:7], s58 offen offset:512 sc1
    buffer_load_dwordx4 v[232:235], v89, s[4:7], s59 offen offset:512 sc1
    buffer_load_dwordx4 v[236:239], v100, s[4:7], s59 offen offset:512 sc1
    buffer_load_dwordx4 v[240:243], v101, s[4:7], s59 offen offset:512 sc1
    buffer_load_dwordx4 v[244:247], v102, s[4:7], s59 offen offset:512 sc1
    s_waitcnt vmcnt(0)
    s_nop 0
    v_max3_u32 v118, v216, v217, v218
    v_max3_u32 v118, v118, v219, v220
    v_max3_u32 v118, v118, v221, v222
    v_max3_u32 v118, v118, v223, v224
    v_max3_u32 v118, v118, v225, v226
    v_max3_u32 v118, v118, v227, v228
    v_max3_u32 v118, v118, v229, v230
    v_max_u32 v118, v118, v231
    v_cmp_eq_u32 vcc, -1, v118
    s_add_u32 s66, s66, 1
    s_cbranch_vccz L_g1back_123
    s_cmp_lt_u32 s66, s67
    s_cbranch_scc1 L_g1slow_122
    s_mov_b32 s67, 1
    s_branch L_g1back_123
L_g1slow_124:
    s_sleep 2
    s_nop 0
    buffer_load_dwordx4 v[232:235], v89, s[4:7], s59 offen offset:512 sc1
    buffer_load_dwordx4 v[236:239], v100, s[4:7], s59 offen offset:512 sc1
    buffer_load_dwordx4 v[240:243], v101, s[4:7], s59 offen offset:512 sc1
    buffer_load_dwordx4 v[244:247], v102, s[4:7], s59 offen offset:512 sc1
    s_waitcnt vmcnt(0)
    s_nop 0
    v_max3_u32 v118, v232, v233, v234
    v_max3_u32 v118, v118, v235, v236
    v_max3_u32 v118, v118, v237, v238
    v_max3_u32 v118, v118, v239, v240
    v_max3_u32 v118, v118, v241, v242
    v_max3_u32 v118, v118, v243, v244
    v_max3_u32 v118, v118, v245, v246
    v_max_u32 v118, v118, v247
    v_cmp_eq_u32 vcc, -1, v118
    s_add_u32 s66, s66, 1
    s_cbranch_vccz L_g1back_125
    s_cmp_lt_u32 s66, s67
    s_cbranch_scc1 L_g1slow_124
    s_mov_b32 s67, 1
    s_branch L_g1back_125
L_g2slow_155:
    s_sleep 2
    s_nop 0
    buffer_load_dwordx4 v[184:187], v89, s[4:7], s32 offen offset:0 sc1
    buffer_load_dwordx4 v[188:191], v100, s[4:7], s32 offen offset:0 sc1
    buffer_load_dwordx4 v[192:195], v89, s[4:7], s33 offen offset:0 sc1
    buffer_load_dwordx4 v[196:199], v100, s[4:7], s33 offen offset:0 sc1
    buffer_load_dwordx4 v[200:203], v89, s[4:7], s34 offen offset:0 sc1
    buffer_load_dwordx4 v[204:207], v100, s[4:7], s34 offen offset:0 sc1
    buffer_load_dwordx4 v[208:211], v89, s[4:7], s35 offen offset:0 sc1
    buffer_load_dwordx4 v[212:215], v100, s[4:7], s35 offen offset:0 sc1
    buffer_load_dwordx4 v[216:219], v89, s[4:7], s36 offen offset:0 sc1
    buffer_load_dwordx4 v[220:223], v100, s[4:7], s36 offen offset:0 sc1
    buffer_load_dwordx4 v[224:227], v89, s[4:7], s37 offen offset:0 sc1
    buffer_load_dwordx4 v[228:231], v100, s[4:7], s37 offen offset:0 sc1
    s_waitcnt vmcnt(0)
    s_nop 0
    v_max3_u32 v117, v184, v185, v186
    v_max3_u32 v117, v117, v187, v188
    v_max3_u32 v117, v117, v189, v190
    v_max3_u32 v117, v117, v191, v192
    v_max3_u32 v117, v117, v193, v194
    v_max3_u32 v117, v117, v195, v196
    v_max3_u32 v117, v117, v197, v198
    v_max_u32 v117, v117, v199
    v_cmp_eq_u32 vcc, -1, v117
    s_add_u32 s66, s66, 1
    s_cbranch_vccz L_g2back_156
    s_cmp_lt_u32 s66, s67
    s_cbranch_scc1 L_g2slow_155
    s_mov_b32 s67, 1
    s_branch L_g2back_156
L_g2slow_157:
    s_sleep 2
    s_nop 0
    buffer_load_dwordx4 v[200:203], v89, s[4:7], s34 offen offset:0 sc1
    buffer_load_dwordx4 v[204:207], v100, s[4:7], s34 offen offset:0 sc1
    buffer_load_dwordx4 v[208:211], v89, s[4:7], s35 offen offset:0 sc1
    buffer_load_dwordx4 v[212:215], v100, s[4:7], s35 offen offset:0 sc1
    buffer_load_dwordx4 v[216:219], v89, s[4:7], s36 offen offset:0 sc1
    buffer_load_dwordx4 v[220:223], v100, s[4:7], s36 offen offset:0 sc1
    buffer_load_dwordx4 v[224:227], v89, s[4:7], s37 offen offset:0 sc1
    buffer_load_dwordx4 v[228:231], v100, s[4:7], s37 offen offset:0 sc1
    buffer_load_dwordx4 v[184:187], v89, s[4:7], s40 offen offset:0 sc1
    buffer_load_dwordx4 v[188:191], v100, s[4:7], s40 offen offset:0 sc1
    buffer_load_dwordx4 v[192:195], v89, s[4:7], s41 offen offset:0 sc1
    s_waitcnt vmcnt(0)
    s_nop 0
    v_max3_u32 v117, v200, v201, v202
    v_max3_u32 v117, v117, v203, v204
    v_max3_u32 v117, v117, v205, v206
    v_max3_u32 v117, v117, v207, v208
    v_max3_u32 v117, v117, v209, v210
    v_max3_u32 v117, v117, v211, v212
    v_max3_u32 v117, v117, v213, v214
    v_max_u32 v117, v117, v215
    v_cmp_eq_u32 vcc, -1, v117
    s_add_u32 s66, s66, 1
    s_cbranch_vccz L_g2back_158
    s_cmp_lt_u32 s66, s67
    s_cbranch_scc1 L_g2slow_157
    s_mov_b32 s67, 1
    s_branch L_g2back_158
L_g2slow_159:
    s_sleep 2
    s_nop 0
    buffer_load_dwordx4 v[216:219], v89, s[4:7], s36 offen offset:0 sc1
    buffer_load_dwordx4 v[220:223], v100, s[4:7], s36 offen offset:0 sc1
    buffer_load_dwordx4 v[224:227], v89, s[4:7], s37 offen offset:0 sc1
    buffer_load_dwordx4 v[228:231], v100, s[4:7], s37 offen offset:0 sc1
    buffer_load_dwordx4 v[184:187], v89, s[4:7], s40 offen offset:0 sc1
    buffer_load_dwordx4 v[188:191], v100, s[4:7], s40 offen offset:0 sc1
    buffer_load_dwordx4 v[192:195], v89, s[4:7], s41 offen offset:0 sc1
    buffer_load_dwordx4 v[196:199], v100, s[4:7], s41 offen offset:0 sc1
    buffer_load_dwordx4 v[200:203], v89, s[4:7], s38 offen offset:0 sc1
    buffer_load_dwordx4 v[204:207], v100, s[4:7], s38 offen offset:0 sc1
    buffer_load_dwordx4 v[208:211], v89, s[4:7], s39 offen offset:0 sc1
    s_waitcnt vmcnt(0)
    s_nop 0
    v_max3_u32 v117, v216, v217, v218
    v_max3_u32 v117, v117, v219, v220
    v_max3_u32 v117, v117, v221, v222
    v_max3_u32 v117, v117, v223, v224
    v_max3_u32 v117, v117, v225, v226
    v_max3_u32 v117, v117, v227, v228
    v_max3_u32 v117, v117, v229, v230
    v_max_u32 v117, v117, v231
    v_cmp_eq_u32 vcc, -1, v117
    s_add_u32 s66, s66, 1
    s_cbranch_vccz L_g2back_160
    s_cmp_lt_u32 s66, s67
    s_cbranch_scc1 L_g2slow_159
    s_mov_b32 s67, 1
    s_branch L_g2back_160
L_g2slow_161:
    s_sleep 2
    s_nop 0
    buffer_load_dwordx4 v[184:187], v89, s[4:7], s40 offen offset:0 sc1
    buffer_load_dwordx4 v[188:191], v100, s[4:7], s40 offen offset:0 sc1
    buffer_load_dwordx4 v[192:195], v89, s[4:7], s41 offen offset:0 sc1
    buffer_load_dwordx4 v[196:199], v100, s[4:7], s41 offen offset:0 sc1
    buffer_load_dwordx4 v[200:203], v89, s[4:7], s38 offen offset:0 sc1
    buffer_load_dwordx4 v[204:207], v100, s[4:7], s38 offen offset:0 sc1
    buffer_load_dwordx4 v[208:211], v89, s[4:7], s39 offen offset:0 sc1
    buffer_load_dwordx4 v[212:215], v100, s[4:7], s39 offen offset:0 sc1
    buffer_load_dwordx4 v[216:219], v89, s[4:7], s40 offen offset:512 sc1
    buffer_load_dwordx4 v[220:223], v100, s[4:7], s40 offen offset:512 sc1
    buffer_load_dwordx4 v[224:227], v89, s[4:7], s41 offen offset:512 sc1
    s_waitcnt vmcnt(0)
    s_nop 0
    v_max3_u32 v117, v184, v185, v186
    v_max3_u32 v117, v117, v187, v188
    v_max3_u32 v117, v117, v189, v190
    v_max3_u32 v117, v117, v191, v192
    v_max3_u32 v117, v117, v193, v194
    v_max3_u32 v117, v117, v195, v196
    v_max3_u32 v117, v117, v197, v198
    v_max_u32 v117, v117, v199
    v_cmp_eq_u32 vcc, -1, v117
    s_add_u32 s66, s66, 1
    s_cbranch_vccz L_g2back_162
    s_cmp_lt_u32 s66, s67
    s_cbranch_scc1 L_g2slow_161
    s_mov_b32 s67, 1
    s_branch L_g2back_162
L_g2slow_163:
    s_sleep 2
    s_nop 0
    buffer_load_dwordx4 v[200:203], v89, s[4:7], s38 offen offset:0 sc1
    buffer_load_dwordx4 v[204:207], v100, s[4:7], s38 offen offset:0 sc1
    buffer_load_dwordx4 v[208:211], v89, s[4:7], s39 offen offset:0 sc1
    buffer_load_dwordx4 v[212:215], v100, s[4:7], s39 offen offset:0 sc1
    buffer_load_dwordx4 v[216:219], v89, s[4:7], s40 offen offset:512 sc1
    buffer_load_dwordx4 v[220:223], v100, s[4:7], s40 offen offset:512 sc1
    buffer_load_dwordx4 v[224:227], v89, s[4:7], s41 offen offset:512 sc1
    buffer_load_dwordx4 v[228:231], v100, s[4:7], s41 offen offset:512 sc1
    buffer_load_dwordx4 v[184:187], v89, s[4:7], s38 offen offset:512 sc1
    buffer_load_dwordx4 v[188:191], v100, s[4:7], s38 offen offset:512 sc1
    buffer_load_dwordx4 v[192:195], v89, s[4:7], s39 offen offset:512 sc1
    s_waitcnt vmcnt(0)
    s_nop 0
    v_max3_u32 v117, v200, v201, v202
    v_max3_u32 v117, v117, v203, v204
    v_max3_u32 v117, v117, v205, v206
    v_max3_u32 v117, v117, v207, v208
    v_max3_u32 v117, v117, v209, v210
    v_max3_u32 v117, v117, v211, v212
    v_max3_u32 v117, v117, v213, v214
    v_max_u32 v117, v117, v215
    v_cmp_eq_u32 vcc, -1, v117
    s_add_u32 s66, s66, 1
    s_cbranch_vccz L_g2back_164
    s_cmp_lt_u32 s66, s67
    s_cbranch_scc1 L_g2slow_163
    s_mov_b32 s67, 1
    s_branch L_g2back_164
L_g2slow_165:
    s_sleep 2
    s_nop 0
    buffer_load_dwordx4 v[216:219], v89, s[4:7], s40 offen offset:512 sc1
    buffer_load_dwordx4 v[220:223], v100, s[4:7], s40 offen offset:512 sc1
    buffer_load_dwordx4 v[224:227], v89, s[4:7], s41 offen offset:512 sc1
    buffer_load_dwordx4 v[228:231], v100, s[4:7], s41 offen offset:512 sc1
    buffer_load_dwordx4 v[184:187], v89, s[4:7], s38 offen offset:512 sc1
    buffer_load_dwordx4 v[188:191], v100, s[4:7], s38 offen offset:512 sc1
    buffer_load_dwordx4 v[192:195], v89, s[4:7], s39 offen offset:512 sc1
    buffer_load_dwordx4 v[196:199], v100, s[4:7], s39 offen offset:512 sc1
    buffer_load_dwordx4 v[200:203], v89, s[4:7], s32 offen offset:512 sc1
    buffer_load_dwordx4 v[204:207], v100, s[4:7], s32 offen offset:512 sc1
    buffer_load_dwordx4 v[208:211], v89, s[4:7], s33 offen offset:512 sc1
    s_waitcnt vmcnt(0)
    s_nop 0
    v_max3_u32 v117, v216, v217, v218
    v_max3_u32 v117, v117, v219, v220
    v_max3_u32 v117, v117, v221, v222
    v_max3_u32 v117, v117, v223, v224
    v_max3_u32 v117, v117, v225, v226
    v_max3_u32 v117, v117, v227, v228
    v_max3_u32 v117, v117, v229, v230
    v_max_u32 v117, v117, v231
    v_cmp_eq_u32 vcc, -1, v117
    s_add_u32 s66, s66, 1
    s_cbranch_vccz L_g2back_166
    s_cmp_lt_u32 s66, s67
    s_cbranch_scc1 L_g2slow_165
    s_mov_b32 s67, 1
    s_branch L_g2back_166
L_g2slow_167:
    s_sleep 2
    s_nop 0
    buffer_load_dwordx4 v[184:187], v89, s[4:7], s38 offen offset:512 sc1
    buffer_load_dwordx4 v[188:191], v100, s[4:7], s38 offen offset:512 sc1
    buffer_load_dwordx4 v[192:195], v89, s[4:7], s39 offen offset:512 sc1
    buffer_load_dwordx4 v[196:199], v100, s[4:7], s39 offen offset:512 sc1
    buffer_load_dwordx4 v[200:203], v89, s[4:7], s32 offen offset:512 sc1
    buffer_load_dwordx4 v[204:207], v100, s[4:7], s32 offen offset:512 sc1
    buffer_load_dwordx4 v[208:211], v89, s[4:7], s33 offen offset:512 sc1
    buffer_load_dwordx4 v[212:215], v100, s[4:7], s33 offen offset:512 sc1
    buffer_load_dwordx4 v[216:219], v89, s[4:7], s34 offen offset:512 sc1
    buffer_load_dwordx4 v[220:223], v100, s[4:7], s34 offen offset:512 sc1
    buffer_load_dwordx4 v[224:227], v89, s[4:7], s35 offen offset:512 sc1
    s_waitcnt vmcnt(0)
    s_nop 0
    v_max3_u32 v117, v184, v185, v186
    v_max3_u32 v117, v117, v187, v188
    v_max3_u32 v117, v117, v189, v190
    v_max3_u32 v117, v117, v191, v192
    v_max3_u32 v117, v117, v193, v194
    v_max3_u32 v117, v117, v195, v196
    v_max3_u32 v117, v117, v197, v198
    v_max_u32 v117, v117, v199
    v_cmp_eq_u32 vcc, -1, v117
    s_add_u32 s66, s66, 1
    s_cbranch_vccz L_g2back_168
    s_cmp_lt_u32 s66, s67
    s_cbranch_scc1 L_g2slow_167
    s_mov_b32 s67, 1
    s_branch L_g2back_168
L_g2slow_169:
    s_sleep 2
    s_nop 0
    buffer_load_dwordx4 v[200:203], v89, s[4:7], s32 offen offset:512 sc1
    buffer_load_dwordx4 v[204:207], v100, s[4:7], s32 offen offset:512 sc1
    buffer_load_dwordx4 v[208:211], v89, s[4:7], s33 offen offset:512 sc1
    buffer_load_dwordx4 v[212:215], v100, s[4:7], s33 offen offset:512 sc1
    buffer_load_dwordx4 v[216:219], v89, s[4:7], s34 offen offset:512 sc1
    buffer_load_dwordx4 v[220:223], v100, s[4:7], s34 offen offset:512 sc1
    buffer_load_dwordx4 v[224:227], v89, s[4:7], s35 offen offset:512 sc1
    buffer_load_dwordx4 v[228:231], v100, s[4:7], s35 offen offset:512 sc1
    buffer_load_dwordx4 v[184:187], v89, s[4:7], s36 offen offset:512 sc1
    buffer_load_dwordx4 v[188:191], v100, s[4:7], s36 offen offset:512 sc1
    buffer_load_dwordx4 v[192:195], v89, s[4:7], s37 offen offset:512 sc1
    s_waitcnt vmcnt(0)
    s_nop 0
    v_max3_u32 v117, v200, v201, v202
    v_max3_u32 v117, v117, v203, v204
    v_max3_u32 v117, v117, v205, v206
    v_max3_u32 v117, v117, v207, v208
    v_max3_u32 v117, v117, v209, v210
    v_max3_u32 v117, v117, v211, v212
    v_max3_u32 v117, v117, v213, v214
    v_max_u32 v117, v117, v215
    v_cmp_eq_u32 vcc, -1, v117
    s_add_u32 s66, s66, 1
    s_cbranch_vccz L_g2back_170
    s_cmp_lt_u32 s66, s67
    s_cbranch_scc1 L_g2slow_169
    s_mov_b32 s67, 1
    s_branch L_g2back_170
L_g2slow_171:
    s_sleep 2
    s_nop 0
    buffer_load_dwordx4 v[216:219], v89, s[4:7], s34 offen offset:512 sc1
    buffer_load_dwordx4 v[220:223], v100, s[4:7], s34 offen offset:512 sc1
    buffer_load_dwordx4 v[224:227], v89, s[4:7], s35 offen offset:512 sc1
    buffer_load_dwordx4 v[228:231], v100, s[4:7], s35 offen offset:512 sc1
    buffer_load_dwordx4 v[184:187], v89, s[4:7], s36 offen offset:512 sc1
    buffer_load_dwordx4 v[188:191], v100, s[4:7], s36 offen offset:512 sc1
    buffer_load_dwordx4 v[192:195], v89, s[4:7], s37 offen offset:512 sc1
    buffer_load_dwordx4 v[196:199], v100, s[4:7], s37 offen offset:512 sc1
    buffer_load_dwordx4 v[200:203], v89, s[4:7], s42 offen offset:0 sc1
    buffer_load_dwordx4 v[204:207], v89, s[4:7], s42 offen offset:512 sc1
    buffer_load_dwordx4 v[208:211], v100, s[4:7], s42 offen offset:0 sc1
    s_waitcnt vmcnt(0)
    s_nop 0
    v_max3_u32 v117, v216, v217, v218
    v_max3_u32 v117, v117, v219, v220
    v_max3_u32 v117, v117, v221, v222
    v_max3_u32 v117, v117, v223, v224
    v_max3_u32 v117, v117, v225, v226
    v_max3_u32 v117, v117, v227, v228
    v_max3_u32 v117, v117, v229, v230
    v_max_u32 v117, v117, v231
    v_cmp_eq_u32 vcc, -1, v117
    s_add_u32 s66, s66, 1
    s_cbranch_vccz L_g2back_172
    s_cmp_lt_u32 s66, s67
    s_cbranch_scc1 L_g2slow_171
    s_mov_b32 s67, 1
    s_branch L_g2back_172
L_g2slow_173:
    s_sleep 2
    s_nop 0
    buffer_load_dwordx4 v[184:187], v89, s[4:7], s36 offen offset:512 sc1
    buffer_load_dwordx4 v[188:191], v100, s[4:7], s36 offen offset:512 sc1
    buffer_load_dwordx4 v[192:195], v89, s[4:7], s37 offen offset:512 sc1
    buffer_load_dwordx4 v[196:199], v100, s[4:7], s37 offen offset:512 sc1
    buffer_load_dwordx4 v[200:203], v89, s[4:7], s42 offen offset:0 sc1
    buffer_load_dwordx4 v[204:207], v89, s[4:7], s42 offen offset:512 sc1
    buffer_load_dwordx4 v[208:211], v100, s[4:7], s42 offen offset:0 sc1
    buffer_load_dwordx4 v[212:215], v100, s[4:7], s42 offen offset:512 sc1
    buffer_load_dwordx4 v[216:219], v89, s[4:7], s43 offen offset:0 sc1
    buffer_load_dwordx4 v[220:223], v89, s[4:7], s43 offen offset:512 sc1
    buffer_load_dwordx4 v[224:227], v100, s[4:7], s43 offen offset:0 sc1
    s_waitcnt vmcnt(0)
    s_nop 0
    v_max3_u32 v117, v184, v185, v186
    v_max3_u32 v117, v117, v187, v188
    v_max3_u32 v117, v117, v189, v190
    v_max3_u32 v117, v117, v191, v192
    v_max3_u32 v117, v117, v193, v194
    v_max3_u32 v117, v117, v195, v196
    v_max3_u32 v117, v117, v197, v198
    v_max_u32 v117, v117, v199
    v_cmp_eq_u32 vcc, -1, v117
    s_add_u32 s66, s66, 1
    s_cbranch_vccz L_g2back_174
    s_cmp_lt_u32 s66, s67
    s_cbranch_scc1 L_g2slow_173
    s_mov_b32 s67, 1
    s_branch L_g2back_174
L_g2slow_175:
    s_sleep 2
    s_nop 0
    buffer_load_dwordx4 v[200:203], v89, s[4:7], s42 offen offset:0 sc1
    buffer_load_dwordx4 v[204:207], v89, s[4:7], s42 offen offset:512 sc1
    buffer_load_dwordx4 v[208:211], v100, s[4:7], s42 offen offset:0 sc1
    buffer_load_dwordx4 v[212:215], v100, s[4:7], s42 offen offset:512 sc1
    buffer_load_dwordx4 v[216:219], v89, s[4:7], s43 offen offset:0 sc1
    buffer_load_dwordx4 v[220:223], v89, s[4:7], s43 offen offset:512 sc1
    buffer_load_dwordx4 v[224:227], v100, s[4:7], s43 offen offset:0 sc1
    buffer_load_dwordx4 v[228:231], v100, s[4:7], s43 offen offset:512 sc1
    buffer_load_dwordx4 v[184:187], v89, s[4:7], s44 offen offset:0 sc1
    buffer_load_dwordx4 v[188:191], v89, s[4:7], s44 offen offset:512 sc1
    buffer_load_dwordx4 v[192:195], v100, s[4:7], s44 offen offset:0 sc1
    s_waitcnt vmcnt(0)
    s_nop 0
    v_max3_u32 v117, v200, v201, v202
    v_max3_u32 v117, v117, v203, v204
    v_max3_u32 v117, v117, v205, v206
    v_max3_u32 v117, v117, v207, v208
    v_max3_u32 v117, v117, v209, v210
    v_max3_u32 v117, v117, v211, v212
    v_max3_u32 v117, v117, v213, v214
    v_max_u32 v117, v117, v215
    v_cmp_eq_u32 vcc, -1, v117
    s_add_u32 s66, s66, 1
    s_cbranch_vccz L_g2back_176
    s_cmp_lt_u32 s66, s67
    s_cbranch_scc1 L_g2slow_175
    s_mov_b32 s67, 1
    s_branch L_g2back_176
L_g2slow_177:
    s_sleep 2
    s_nop 0
    buffer_load_dwordx4 v[216:219], v89, s[4:7], s43 offen offset:0 sc1
    buffer_load_dwordx4 v[220:223], v89, s[4:7], s43 offen offset:512 sc1
    buffer_load_dwordx4 v[224:227], v100, s[4:7], s43 offen offset:0 sc1
    buffer_load_dwordx4 v[228:231], v100, s[4:7], s43 offen offset:512 sc1
    buffer_load_dwordx4 v[184:187], v89, s[4:7], s44 offen offset:0 sc1
    buffer_load_dwordx4 v[188:191], v89, s[4:7], s44 offen offset:512 sc1
    buffer_load_dwordx4 v[192:195], v100, s[4:7], s44 offen offset:0 sc1
    buffer_load_dwordx4 v[196:199], v100, s[4:7], s44 offen offset:512 sc1
    buffer_load_dwordx4 v[200:203], v89, s[4:7], s45 offen offset:0 sc1
    buffer_load_dwordx4 v[204:207], v89, s[4:7], s45 offen offset:512 sc1
    buffer_load_dwordx4 v[208:211], v100, s[4:7], s45 offen offset:0 sc1
    s_waitcnt vmcnt(0)
    s_nop 0
    v_max3_u32 v117, v216, v217, v218
    v_max3_u32 v117, v117, v219, v220
    v_max3_u32 v117, v117, v221, v222
    v_max3_u32 v117, v117, v223, v224
    v_max3_u32 v117, v117, v225, v226
    v_max3_u32 v117, v117, v227, v228
    v_max3_u32 v117, v117, v229, v230
    v_max_u32 v117, v117, v231
    v_cmp_eq_u32 vcc, -1, v117
    s_add_u32 s66, s66, 1
    s_cbranch_vccz L_g2back_178
    s_cmp_lt_u32 s66, s67
    s_cbranch_scc1 L_g2slow_177
    s_mov_b32 s67, 1
    s_branch L_g2back_178
L_g2slow_179:
    s_sleep 2
    s_nop 0
    buffer_load_dwordx4 v[184:187], v89, s[4:7], s44 offen offset:0 sc1
    buffer_load_dwordx4 v[188:191], v89, s[4:7], s44 offen offset:512 sc1
    buffer_load_dwordx4 v[192:195], v100, s[4:7], s44 offen offset:0 sc1
    buffer_load_dwordx4 v[196:199], v100, s[4:7], s44 offen offset:512 sc1
    buffer_load_dwordx4 v[200:203], v89, s[4:7], s45 offen offset:0 sc1
    buffer_load_dwordx4 v[204:207], v89, s[4:7], s45 offen offset:512 sc1
    buffer_load_dwordx4 v[208:211], v100, s[4:7], s45 offen offset:0 sc1
    buffer_load_dwordx4 v[212:215], v100, s[4:7], s45 offen offset:512 sc1
    s_waitcnt vmcnt(0)
    s_nop 0
    v_max3_u32 v117, v184, v185, v186
    v_max3_u32 v117, v117, v187, v188
    v_max3_u32 v117, v117, v189, v190
    v_max3_u32 v117, v117, v191, v192
    v_max3_u32 v117, v117, v193, v194
    v_max3_u32 v117, v117, v195, v196
    v_max3_u32 v117, v117, v197, v198
    v_max_u32 v117, v117, v199
    v_cmp_eq_u32 vcc, -1, v117
    s_add_u32 s66, s66, 1
    s_cbranch_vccz L_g2back_180
    s_cmp_lt_u32 s66, s67
    s_cbranch_scc1 L_g2slow_179
    s_mov_b32 s67, 1
    s_branch L_g2back_180
L_g2slow_184:
    s_sleep 2
    s_nop 0
    buffer_load_dwordx4 v[200:203], v89, s[4:7], s45 offen offset:0 sc1
    buffer_load_dwordx4 v[204:207], v89, s[4:7], s45 offen offset:512 sc1
    buffer_load_dwordx4 v[208:211], v100, s[4:7], s45 offen offset:0 sc1
    buffer_load_dwordx4 v[212:215], v100, s[4:7], s45 offen offset:512 sc1
    s_waitcnt vmcnt(0)
    s_nop 0
    v_max3_u32 v117, v200, v201, v202
    v_max3_u32 v117, v117, v203, v204
    v_max3_u32 v117, v117, v205, v206
    v_max3_u32 v117, v117, v207, v208
    v_max3_u32 v117, v117, v209, v210
    v_max3_u32 v117, v117, v211, v212
    v_max3_u32 v117, v117, v213, v214
    v_max_u32 v117, v117, v215
    v_cmp_eq_u32 vcc, -1, v117
    s_add_u32 s66, s66, 1
    s_cbranch_vccz L_g2back_185
    s_cmp_lt_u32 s66, s67
    s_cbranch_scc1 L_g2slow_184
    s_mov_b32 s67, 1
    s_branch L_g2back_185
    s_endpgm
.p2align 8
.type L_table,@object
L_table:
.long 0x3f803f80,0x3f803f80,0x80008000,0x80008000,0x3f673f80,0x3e643f20,0xbede8000,0xbf7abf48
.long 0x3f203f80,0xbf67be64,0xbf488000,0xbedebf7a,0x3e643f80,0xbf20bf67,0xbf7a8000,0x3f48bede
.long 0xbe643f80,0x3f20bf67,0xbf7a8000,0x3f483ede,0xbf203f80,0x3f67be64,0xbf488000,0xbede3f7a
.long 0xbf673f80,0xbe643f20,0xbede8000,0xbf7a3f48,0xbf803f80,0xbf803f80,0xa50d8000,0xa50d8000
.long 0xbf673f80,0xbe643f20,0x3ede8000,0x3f7abf48,0xbf203f80,0x3f67be64,0x3f488000,0x3edebf7a
.long 0xbe643f80,0x3f20bf67,0x3f7a8000,0xbf48bede,0x3e643f80,0xbf20bf67,0x3f7a8000,0xbf483ede
.long 0x3f203f80,0xbf67be64,0x3f488000,0x3ede3f7a,0x3f673f80,0x3e643f20,0x3ede8000,0x3f7a3f48
.long 0x3f803f80,0x3f803f80,0x80008000,0x80008000,0x3f673f80,0x3e643f20,0xbede8000,0xbf7abf48
.long 0x3f803f80,0x3f803f80,0x80008000,0x80008000,0xbf20be64,0xbf80bf67,0xbf48bf7a,0xa50dbede
.long 0xbe64bf67,0x3f803f20,0x3f7a3ede,0x80003f48,0x3f673f20,0xbf80be64,0xbede3f48,0xa50dbf7a
.long 0xbf673f20,0x3f80be64,0xbedebf48,0x80003f7a,0x3e64bf67,0xbf803f20,0x3f7abede,0xa50dbf48
.long 0x3f20be64,0x3f80bf67,0xbf483f7a,0x80003ede,0xbf803f80,0xbf803f80,0xa50d8000,0xa50d8000
.long 0x3f20be64,0x3f80bf67,0x3f48bf7a,0x8000bede,0x3e64bf67,0xbf803f20,0xbf7a3ede,0xa50d3f48
.long 0xbf673f20,0x3f80be64,0x3ede3f48,0x8000bf7a,0x3f673f20,0xbf80be64,0x3edebf48,0xa50d3f7a
.long 0xbe64bf67,0x3f803f20,0xbf7abede,0x8000bf48,0xbf20be64,0xbf80bf67,0x3f483f7a,0xa50d3ede
.long 0x3f803f80,0x3f803f80,0x80008000,0x80008000,0xbf20be64,0xbf80bf67,0xbf48bf7a,0xa50dbede
.long 0x3f803f80,0x3f803f80,0x80008000,0x80008000,0xbf20bf67,0x3e64be64,0x3f483ede,0x3f7a3f7a
.long 0xbe643f20,0xbf67bf67,0xbf7abf48,0x3edebede,0x3f67be64,0xbf203f20,0x3ede3f7a,0xbf48bf48
.long 0xbf67be64,0x3f203f20,0x3edebf7a,0xbf483f48,0x3e643f20,0x3f67bf67,0xbf7a3f48,0x3ede3ede
.long 0x3f20bf67,0xbe64be64,0x3f48bede,0x3f7abf7a,0xbf803f80,0xbf803f80,0xa50d8000,0xa50d8000
.long 0x3f20bf67,0xbe64be64,0xbf483ede,0xbf7a3f7a,0x3e643f20,0x3f67bf67,0x3f7abf48,0xbedebede
.long 0xbf67be64,0x3f203f20,0xbede3f7a,0x3f48bf48,0x3f67be64,0xbf203f20,0xbedebf7a,0x3f483f48
.long 0xbe643f20,0xbf67bf67,0x3f7a3f48,0xbede3ede,0xbf20bf67,0x3e64be64,0xbf48bede,0xbf7abf7a
.long 0x3f803f80,0x3f803f80,0x80008000,0x80008000,0xbf20bf67,0x3e64be64,0x3f483ede,0x3f7a3f7a
.long 0x3f803f80,0x0,0x80008000,0x0,0x3f673f20,0x0,0x3ede3f48,0x0
.long 0x3f20be64,0x0,0x3f483f7a,0x0,0x3e64bf67,0x0,0x3f7a3ede,0x0
.long 0xbe64bf67,0x0,0x3f7abede,0x0,0xbf20be64,0x0,0x3f48bf7a,0x0
.long 0xbf673f20,0x0,0x3edebf48,0x0,0xbf803f80,0x0,0xa50d8000,0x0
.long 0xbf673f20,0x0,0xbede3f48,0x0,0xbf20be64,0x0,0xbf483f7a,0x0
.long 0xbe64bf67,0x0,0xbf7a3ede,0x0,0x3e64bf67,0x0,0xbf7abede,0x0
.long 0x3f20be64,0x0,0xbf48bf7a,0x0,0x3f673f20,0x0,0xbedebf48,0x0
.long 0x3f803f80,0x0,0x80008000,0x0,0x3f673f20,0x0,0x3ede3f48,0x0
.long 0x3f800000,0x3f800000,0x3f800000,0x3f800000,0x3f800000,0x3f7ff98e,0x3f7fe638,0x3f7fc600
.long 0x3f800000,0x3f7fe638,0x3f7f98e6,0x3f7f181a,0x3f800000,0x3f7fc600,0x3f7f181a,0x3f7df69c
.long 0x3f800000,0x3f7f98e6,0x3f7e63ec,0x3f7c620b,0x3f800000,0x3f7f5eee,0x3f7d7c83,0x3f7a5b1d
.long 0x3f800000,0x3f7f181a,0x3f7c620b,0x3f77e2bd,0x3f800000,0x3f7ec46d,0x3f7b14be,0x3f74fa0b
.long 0x3f800000,0x3f7e63ec,0x3f7994e0,0x3f71a257,0x3f800000,0x3f7df69c,0x3f77e2bd,0x3f6ddd24
.long 0x3f800000,0x3f7d7c83,0x3f75fead,0x3f69ac2a,0x3f800000,0x3f7cf5a5,0x3f73e912,0x3f65114d
.long 0x3f800000,0x3f7c620b,0x3f71a257,0x3f600ea4,0x3f800000,0x3f7bc1bb,0x3f6f2af0,0x3f5aa675
.long 0x3f800000,0xbf800000,0x3f800000,0xbf800000,0x3f800000,0x3f7a5b1d,0x3f69ac2a,0x3f4eaf7a
.long 0x3f800000,0x3f800000,0x3f800000,0x3f800000,0x3f7f98e6,0x3f7f5eee,0x3f7f181a,0x3f7ec46d
.long 0x3f7e63ec,0x3f7d7c83,0x3f7c620b,0x3f7b14be,0x3f7c620b,0x3f7a5b1d,0x3f77e2bd,0x3f74fa0b
.long 0x3f7994e0,0x3f75fead,0x3f71a257,0x3f6c835e,0x3f75fead,0x3f706cb1,0x3f69ac2a,0x3f61c598
.long 0x3f71a257,0x3f69ac2a,0x3f600ea4,0x3f54db31,0x3f6c835e,0x3f61c598,0x3f54db31,0x3f45e403
.long 0x3f66a5e5,0x3f58c2eb,0x3f48261c,0x3f3504f3,0x3f600ea4,0x3f4eaf7a,0x3f3a0669,0x3f226799
.long 0x3f58c2eb,0x3f4397f4,0x3f2a95b0,0x3f0e39da,0x3f50c899,0x3f378a4d,0x3f19efeb,0x3ef15aea
.long 0x3f48261c,0x3f2a95b0,0x3f083341,0x3ec3ef15,0x3f3ee268,0x3f1cca6b,0x3eeaffac,0x3e94a031
.long 0x3f800000,0xbf800000,0x3f800000,0xbf800000,0x3f2a95b0,0x3efdec9f,0x3e9b7b85,0x3dc8bd36
.long 0x3f800000,0x3f800000,0x3f800000,0x3f800000,0x3f7e63ec,0x3f7df69c,0x3f7d7c83,0x3f7cf5a5
.long 0x3f7994e0,0x3f77e2bd,0x3f75fead,0x3f73e912,0x3f71a257,0x3f6ddd24,0x3f69ac2a,0x3f65114d
.long 0x3f66a5e5,0x3f600ea4,0x3f58c2eb,0x3f50c899,0x3f58c2eb,0x3f4eaf7a,0x3f4397f4,0x3f378a4d
.long 0x3f48261c,0x3f3a0669,0x3f2a95b0,0x3f19efeb,0x3f3504f3,0x3f226799,0x3f0e39da,0x3ef15aea
.long 0x3f1f9d07,0x3f083341,0x3ede2602,0x3ea91a56,0x3f083341,0x3ed7a83d,0x3e9b7b85,0x3e39aaee
.long 0x3ede2602,0x3e9b7b85,0x3e2b86c0,0x3ce5c143,0x3ea91a56,0x3e39aaee,0x3ce5c143,0xbe00e941
.long 0x3e63dc87,0x3d65aa20,0xbde54da2,0xbe8dbd62,0x3de54da2,0xbd8f7f7c,0xbe7fc568,0xbed7a83d
.long 0x3f800000,0xbf800000,0x3f800000,0xbf800000,0xbde54da2,0xbea24f04,0xbf02113a,0xbf2d3eb9
.long 0x3f800000,0x3f800000,0x3f800000,0x3f800000,0x3f7c620b,0x3f7bc1bb,0x3f7b14be,0x3f7a5b1d
.long 0x3f71a257,0x3f6f2af0,0x3f6c835e,0x3f69ac2a,0x3f600ea4,0x3f5aa675,0x3f54db31,0x3f4eaf7a
.long 0x3f48261c,0x3f3ee268,0x3f3504f3,0x3f2a95b0,0x3f2a95b0,0x3f1cca6b,0x3f0e39da,0x3efdec9f
.long 0x3f083341,0x3eeaffac,0x3ec3ef15,0x3e9b7b85,0x3ec3ef15,0x3e94a031,0x3e47c5c2,0x3dc8bd36
.long 0x3e63dc87,0x3de54da2,0x248d3132,0xbde54da2,0x3d65aa20,0xbd8f7f7c,0xbe47c5c2,0xbea24f04
.long 0xbde54da2,0xbe7fc568,0xbec3ef15,0xbf02113a,0xbe8dbd62,0xbed7a83d,0xbf0e39da,0xbf2d3eb9
.long 0xbede2602,0xbf1423cd,0xbf3504f3,0xbf50c899,0xbf1423cd,0xbf378a4d,0xbf54db31,0xbf6b1db0
.long 0x3f800000,0xbf800000,0x3f800000,0xbf800000,0xbf50c899,0xbf6b1db0,0xbf7b14be,0xbf7ff98e
.long 0x3f800000,0x3f800000,0x3f800000,0x3f800000,0x3f7994e0,0x3f78c212,0x3f77e2bd,0x3f76f6ed
.long 0x3f66a5e5,0x3f63712c,0x3f600ea4,0x3f5c7efc,0x3f48261c,0x3f41420b,0x3f3a0669,0x3f32767c
.long 0x3f1f9d07,0x3f1423cd,0x3f083341,0x3ef7aa01,0x3ede2602,0x3ebd47db,0x3e9b7b85,0x3e71d70e
.long 0x3e63dc87,0x3e0f2533,0x3d65aa20,0xbce5c143,0x248d3132,0xbdc8bd36,0xbe47c5c2,0xbe94a031
.long 0xbe63dc87,0xbea91a56,0xbede2602,0xbf083341,0xbede2602,0xbf0b3a0f,0xbf2529fe,0xbf3c7927
.long 0xbf1f9d07,0xbf3a0669,0xbf50c899,0xbf63712c,0xbf48261c,0xbf5e4c69,0xbf6f2af0,0xbf7a5b1d
.long 0xbf66a5e5,0xbf75fead,0xbf7e63ec,0xbf7f98e6,0xbf7994e0,0xbf7fc600,0xbf7d7c83,0xbf72cbd1
.long 0x3f800000,0xbf800000,0x3f800000,0xbf800000,0xbf7994e0,0xbf682ee0,0xbf4c8bf3,0xbf27e411
.long 0x3f800000,0x3f800000,0x3f800000,0x3f800000,0x3f75fead,0x3f74fa0b,0x3f73e912,0x3f72cbd1
.long 0x3f58c2eb,0x3f54db31,0x3f50c899,0x3f4c8bf3,0x3f2a95b0,0x3f226799,0x3f19efeb,0x3f11327b
.long 0x3ede2602,0x3ec3ef15,0x3ea91a56,0x3e8dbd62,0x3e2b86c0,0x3dc8bd36,0x3ce5c143,0xbd2c49b7
.long 0xbde54da2,0xbe47c5c2,0xbe8dbd62,0xbeb69719,0xbec3ef15,0xbef15aea,0xbf0e39da,0xbf226799
.long 0xbf1f9d07,0xbf3504f3,0xbf48261c,0xbf58c2eb,0xbf50c899,0xbf61c598,0xbf6f2af0,0xbf78c212
.long 0xbf71a257,0xbf7b14be,0xbf7f98e6,0xbf7f181a,0xbf7f98e6,0xbf7ec46d,0xbf77e2bd,0xbf6b1db0
.long 0xbf7994e0,0xbf6c835e,0xbf58c2eb,0xbf3ee268,0xbf600ea4,0xbf45e403,0xbf2529fe,0xbefdec9f
.long 0x3f800000,0xbf800000,0x3f800000,0xbf800000,0xbef7aa01,0xbe94a031,0xbdac22ae,0x3e00e941
.long 0x3f800000,0x3f800000,0x3f800000,0x3f800000,0x3f71a257,0x3f706cb1,0x3f6f2af0,0x3f6ddd24
.long 0x3f48261c,0x3f4397f4,0x3f3ee268,0x3f3a0669,0x3f083341,0x3efdec9f,0x3eeaffac,0x3ed7a83d
.long 0x3e63dc87,0x3e2b86c0,0x3de54da2,0x3d65aa20,0xbde54da2,0xbe39aaee,0xbe7fc568,0xbea24f04
.long 0xbede2602,0xbf02113a,0xbf1423cd,0xbf2529fe,0xbf3504f3,0xbf45e403,0xbf54db31,0xbf61c598
.long 0xbf66a5e5,0xbf71a257,0xbf7994e0,0xbf7e63ec,0xbf7e63ec,0xbf7ff98e,0xbf7d7c83,0xbf76f6ed
.long 0xbf7994e0,0xbf6f2af0,0xbf600ea4,0xbf4c8bf3,0xbf58c2eb,0xbf41420b,0xbf2529fe,0xbf052598
.long 0xbf1f9d07,0xbef7aa01,0xbea91a56,0xbe2b86c0,0xbea91a56,0xbe1d59f0,0x3ce5c143,0x3e55d687
.long 0x3f800000,0xbf800000,0x3f800000,0xbf800000,0x3ea91a56,0x3f052598,0x3f2fdf08,0x3f52d734
.long 0x3f800000,0x3f800000,0x3f800000,0x3f800000,0x3f6c835e,0x3f6b1db0,0x3f69ac2a,0x3f682ee0
.long 0x3f3504f3,0x3f2fdf08,0x3f2a95b0,0x3f2529fe,0x3ec3ef15,0x3eafdd25,0x3e9b7b85,0x3e86d370
.long 0x248d3132,0xbd65aa20,0xbde54da2,0xbe2b86c0,0xbec3ef15,0xbee49898,0xbf02113a,0xbf11327b
.long 0xbf3504f3,0xbf4397f4,0xbf50c899,0xbf5c7efc,0xbf6c835e,0xbf74fa0b,0xbf7b14be,0xbf7ec46d
.long 0xbf800000,0xbf7e63ec,0xbf7994e0,0xbf71a257,0xbf6c835e,0xbf5e4c69,0xbf4c8bf3,0xbf378a4d
.long 0xbf3504f3,0xbf19efeb,0xbef7aa01,0xbeb69719,0xbec3ef15,0xbe71d70e,0xbdac22ae,0x3d8f7f7c
.long 0xa553c9ca,0x3e2b86c0,0x3ea91a56,0x3ef7aa01,0x3ec3ef15,0x3f0b3a0f,0x3f2fdf08,0x3f4eaf7a
.long 0x3f800000,0xbf800000,0x3f800000,0xbf800000,0x3f6c835e,0x3f7bc1bb,0x3f7fe638,0x3f78c212
.long 0x0,0x0,0x0,0x0,0x0,0x3c65c70c,0x3ce5c143,0x3d2c49b7
.long 0x0,0x3ce5c143,0x3d65aa20,0x3dac22ae,0x0,0x3d2c49b7,0x3dac22ae,0x3e00e941
.long 0x0,0x3d65aa20,0x3de54da2,0x3e2b86c0,0x0,0x3d8f7f7c,0x3e0f2533,0x3e55d687
.long 0x0,0x3dac22ae,0x3e2b86c0,0x3e7fc568,0x0,0x3dc8bd36,0x3e47c5c2,0x3e94a031
.long 0x0,0x3de54da2,0x3e63dc87,0x3ea91a56,0x0,0x3e00e941,0x3e7fc568,0x3ebd47db
.long 0x0,0x3e0f2533,0x3e8dbd62,0x3ed11f9b,0x0,0x3e1d59f0,0x3e9b7b85,0x3ee49898
.long 0x0,0x3e2b86c0,0x3ea91a56,0x3ef7aa01,0x0,0x3e39aaee,0x3eb69719,0x3f052598
.long 0x0,0x250d3132,0x0,0x250d3132,0x0,0x3e55d687,0x3ed11f9b,0x3f170daa
.long 0x0,0x0,0x0,0x0,0x3d65aa20,0x3d8f7f7c,0x3dac22ae,0x3dc8bd36
.long 0x3de54da2,0x3e0f2533,0x3e2b86c0,0x3e47c5c2,0x3e2b86c0,0x3e55d687,0x3e7fc568,0x3e94a031
.long 0x3e63dc87,0x3e8dbd62,0x3ea91a56,0x3ec3ef15,0x3e8dbd62,0x3eafdd25,0x3ed11f9b,0x3ef15aea
.long 0x3ea91a56,0x3ed11f9b,0x3ef7aa01,0x3f0e39da,0x3ec3ef15,0x3ef15aea,0x3f0e39da,0x3f226799
.long 0x3ede2602,0x3f083341,0x3f1f9d07,0x3f3504f3,0x3ef7aa01,0x3f170daa,0x3f2fdf08,0x3f45e403
.long 0x3f083341,0x3f2529fe,0x3f3ee268,0x3f54db31,0x3f1423cd,0x3f32767c,0x3f4c8bf3,0x3f61c598
.long 0x3f1f9d07,0x3f3ee268,0x3f58c2eb,0x3f6c835e,0x3f2a95b0,0x3f4a5e20,0x3f63712c,0x3f74fa0b
.long 0x0,0x250d3132,0x0,0x250d3132,0x3f3ee268,0x3f5e4c69,0x3f73e912,0x3f7ec46d
.long 0x0,0x0,0x0,0x0,0x3de54da2,0x3e00e941,0x3e0f2533,0x3e1d59f0
.long 0x3e63dc87,0x3e7fc568,0x3e8dbd62,0x3e9b7b85,0x3ea91a56,0x3ebd47db,0x3ed11f9b,0x3ee49898
.long 0x3ede2602,0x3ef7aa01,0x3f083341,0x3f1423cd,0x3f083341,0x3f170daa,0x3f2529fe,0x3f32767c
.long 0x3f1f9d07,0x3f2fdf08,0x3f3ee268,0x3f4c8bf3,0x3f3504f3,0x3f45e403,0x3f54db31,0x3f61c598
.long 0x3f48261c,0x3f58c2eb,0x3f66a5e5,0x3f71a257,0x3f58c2eb,0x3f682ee0,0x3f73e912,0x3f7bc1bb
.long 0x3f66a5e5,0x3f73e912,0x3f7c620b,0x3f7fe638,0x3f71a257,0x3f7bc1bb,0x3f7fe638,0x3f7df69c
.long 0x3f7994e0,0x3f7f98e6,0x3f7e63ec,0x3f75fead,0x3f7e63ec,0x3f7f5eee,0x3f77e2bd,0x3f682ee0
.long 0x0,0x250d3132,0x0,0x250d3132,0x3f7e63ec,0x3f72cbd1,0x3f5c7efc,0x3f3c7927
.long 0x0,0x0,0x0,0x0,0x3e2b86c0,0x3e39aaee,0x3e47c5c2,0x3e55d687
.long 0x3ea91a56,0x3eb69719,0x3ec3ef15,0x3ed11f9b,0x3ef7aa01,0x3f052598,0x3f0e39da,0x3f170daa
.long 0x3f1f9d07,0x3f2a95b0,0x3f3504f3,0x3f3ee268,0x3f3ee268,0x3f4a5e20,0x3f54db31,0x3f5e4c69
.long 0x3f58c2eb,0x3f63712c,0x3f6c835e,0x3f73e912,0x3f6c835e,0x3f74fa0b,0x3f7b14be,0x3f7ec46d
.long 0x3f7994e0,0x3f7e63ec,0x3f800000,0x3f7e63ec,0x3f7f98e6,0x3f7f5eee,0x3f7b14be,0x3f72cbd1
.long 0x3f7e63ec,0x3f77e2bd,0x3f6c835e,0x3f5c7efc,0x3f75fead,0x3f682ee0,0x3f54db31,0x3f3c7927
.long 0x3f66a5e5,0x3f50c899,0x3f3504f3,0x3f1423cd,0x3f50c899,0x3f32767c,0x3f0e39da,0x3eca8c72
.long 0x0,0x250d3132,0x0,0x250d3132,0x3f1423cd,0x3eca8c72,0x3e47c5c2,0xbc65c70c
.long 0x0,0x0,0x0,0x0,0x3e63dc87,0x3e71d70e,0x3e7fc568,0x3e86d370
.long 0x3ede2602,0x3eeaffac,0x3ef7aa01,0x3f02113a,0x3f1f9d07,0x3f27e411,0x3f2fdf08,0x3f378a4d
.long 0x3f48261c,0x3f50c899,0x3f58c2eb,0x3f600ea4,0x3f66a5e5,0x3f6ddd24,0x3f73e912,0x3f78c212
.long 0x3f7994e0,0x3f7d7c83,0x3f7f98e6,0x3f7fe638,0x3f800000,0x3f7ec46d,0x3f7b14be,0x3f74fa0b
.long 0x3f7994e0,0x3f71a257,0x3f66a5e5,0x3f58c2eb,0x3f66a5e5,0x3f56d477,0x3f4397f4,0x3f2d3eb9
.long 0x3f48261c,0x3f2fdf08,0x3f1423cd,0x3eeaffac,0x3f1f9d07,0x3efdec9f,0x3eb69719,0x3e55d687
.long 0x3ede2602,0x3e8dbd62,0x3de54da2,0xbd65aa20,0x3e63dc87,0x3d2c49b7,0xbe0f2533,0xbea24f04
.long 0x0,0x250d3132,0x0,0x250d3132,0xbe63dc87,0xbed7a83d,0xbf19efeb,0xbf41420b
.long 0x0,0x0,0x0,0x0,0x3e8dbd62,0x3e94a031,0x3e9b7b85,0x3ea24f04
.long 0x3f083341,0x3f0e39da,0x3f1423cd,0x3f19efeb,0x3f3ee268,0x3f45e403,0x3f4c8bf3,0x3f52d734
.long 0x3f66a5e5,0x3f6c835e,0x3f71a257,0x3f75fead,0x3f7c620b,0x3f7ec46d,0x3f7fe638,0x3f7fc600
.long 0x3f7e63ec,0x3f7b14be,0x3f75fead,0x3f6f2af0,0x3f6c835e,0x3f61c598,0x3f54db31,0x3f45e403
.long 0x3f48261c,0x3f3504f3,0x3f1f9d07,0x3f083341,0x3f1423cd,0x3ef15aea,0x3eb69719,0x3e71d70e
.long 0x3ea91a56,0x3e47c5c2,0x3d65aa20,0xbdac22ae,0x3d65aa20,0xbdc8bd36,0xbe7fc568,0xbeca8c72
.long 0xbe63dc87,0xbec3ef15,0xbf083341,0xbf2a95b0,0xbef7aa01,0xbf226799,0xbf4397f4,0xbf5e4c69
.long 0x0,0x250d3132,0x0,0x250d3132,0xbf600ea4,0xbf74fa0b,0xbf7f181a,0xbf7df69c
.long 0x0,0x0,0x0,0x0,0x3ea91a56,0x3eafdd25,0x3eb69719,0x3ebd47db
.long 0x3f1f9d07,0x3f2529fe,0x3f2a95b0,0x3f2fdf08,0x3f58c2eb,0x3f5e4c69,0x3f63712c,0x3f682ee0
.long 0x3f7994e0,0x3f7c620b,0x3f7e63ec,0x3f7f98e6,0x3f7e63ec,0x3f7bc1bb,0x3f77e2bd,0x3f72cbd1
.long 0x3f66a5e5,0x3f5c7efc,0x3f50c899,0x3f4397f4,0x3f3504f3,0x3f226799,0x3f0e39da,0x3ef15aea
.long 0x3ede2602,0x3ea91a56,0x3e63dc87,0x3de54da2,0x3de54da2,0xbc65c70c,0xbe0f2533,0xbe86d370
.long 0xbe63dc87,0xbeb69719,0xbef7aa01,0xbf19efeb,0xbf083341,0xbf27e411,0xbf4397f4,0xbf5aa675
.long 0xbf48261c,0xbf600ea4,0xbf71a257,0xbf7c620b,0xbf71a257,0xbf7cf5a5,0xbf7fe638,0xbf7a5b1d
.long 0x0,0x250d3132,0x0,0x250d3132,0xbf71a257,0xbf5aa675,0xbf3a0669,0xbf11327b
.long 0x0,0x0,0x0,0x0,0x3ec3ef15,0x3eca8c72,0x3ed11f9b,0x3ed7a83d
.long 0x3f3504f3,0x3f3a0669,0x3f3ee268,0x3f4397f4,0x3f6c835e,0x3f706cb1,0x3f73e912,0x3f76f6ed
.long 0x3f800000,0x3f7f98e6,0x3f7e63ec,0x3f7c620b,0x3f6c835e,0x3f65114d,0x3f5c7efc,0x3f52d734
.long 0x3f3504f3,0x3f2529fe,0x3f1423cd,0x3f02113a,0x3ec3ef15,0x3e94a031,0x3e47c5c2,0x3dc8bd36
.long 0x250d3132,0xbde54da2,0xbe63dc87,0xbea91a56,0xbec3ef15,0xbefdec9f,0xbf19efeb,0xbf32767c
.long 0xbf3504f3,0xbf4c8bf3,0xbf600ea4,0xbf6f2af0,0xbf6c835e,0xbf78c212,0xbf7f181a,0xbf7f5eee
.long 0xbf800000,0xbf7c620b,0xbf71a257,0xbf600ea4,0xbf6c835e,0xbf56d477,0xbf3a0669,0xbf170daa
.long 0x0,0x250d3132,0x0,0x250d3132,0xbec3ef15,0xbe39aaee,0x3ce5c143,0x3e71d70e
.long 0x3f803f80,0x3f803f80,0x3f803f80,0x3f803f80,0x3f7b3f80,0x3f553f6d,0xbf7bbf80,0xbf55bf6d
.long 0x3f6d3f80,0x3ec43f35,0x3f6d3f80,0x3ec43f35,0x3f553f80,0xbe483ec4,0xbf55bf80,0x3e48bec4
.long 0x3f353f80,0xbf35248d,0x3f353f80,0xbf35248d,0x3f0e3f80,0xbf7bbec4,0xbf0ebf80,0x3f7b3ec4
.long 0x3ec43f80,0xbf6dbf35,0x3ec43f80,0xbf6dbf35,0x3e483f80,0xbf0ebf6d,0xbe48bf80,0x3f0e3f6d
.long 0x248d3f80,0xa554bf80,0x248d3f80,0xa554bf80,0xbe483f80,0x3f0ebf6d,0x3e48bf80,0xbf0e3f6d
.long 0xbec43f80,0x3f6dbf35,0xbec43f80,0x3f6dbf35,0xbf0e3f80,0x3f7bbec4,0x3f0ebf80,0xbf7b3ec4
.long 0xbf353f80,0x3f35a554,0xbf353f80,0x3f35a554,0xbf553f80,0x3e483ec4,0x3f55bf80,0xbe48bec4
.long 0xbf6d3f80,0xbec43f35,0xbf6d3f80,0xbec43f35,0xbf7b3f80,0xbf553f6d,0x3f7bbf80,0x3f55bf6d
.long 0x3f803f80,0x3f803f80,0x3f803f80,0x3f803f80,0x3f0e3f35,0x3e483ec4,0xbf0ebf35,0xbe48bec4
.long 0xbec4248d,0xbf6dbf35,0xbec4248d,0xbf6dbf35,0xbf7bbf35,0xbf0ebf6d,0x3f7b3f35,0x3f0e3f6d
.long 0xbf35bf80,0x3f35a554,0xbf35bf80,0x3f35a554,0x3e48bf35,0x3f553f6d,0xbe483f35,0xbf55bf6d
.long 0x3f6da554,0xbec43f35,0x3f6da554,0xbec43f35,0x3f553f35,0xbf7bbec4,0xbf55bf35,0x3f7b3ec4
.long 0x248d3f80,0xa554bf80,0x248d3f80,0xa554bf80,0xbf553f35,0x3f7bbec4,0x3f55bf35,0xbf7b3ec4
.long 0xbf6d248d,0x3ec43f35,0xbf6d248d,0x3ec43f35,0xbe48bf35,0xbf553f6d,0x3e483f35,0x3f55bf6d
.long 0x3f35bf80,0xbf35248d,0x3f35bf80,0xbf35248d,0x3f7bbf35,0x3f0ebf6d,0xbf7b3f35,0xbf0e3f6d
.long 0x3ec4a554,0x3f6dbf35,0x3ec4a554,0x3f6dbf35,0xbf0e3f35,0xbe483ec4,0x3f0ebf35,0x3e48bec4
.long 0x3f803f80,0x3f803f80,0x3f803f80,0x3f803f80,0xbe48248d,0xbf0ebec4,0x3e48a554,0x3f0e3ec4
.long 0xbf6dbf80,0xbec4bf35,0xbf6dbf80,0xbec4bf35,0x3f0ea554,0x3f7b3f6d,0xbf0e248d,0xbf7bbf6d
.long 0x3f353f80,0xbf35248d,0x3f353f80,0xbf35248d,0xbf55248d,0xbe48bf6d,0x3f55a554,0x3e483f6d
.long 0xbec4bf80,0x3f6d3f35,0xbec4bf80,0x3f6d3f35,0x3f7ba554,0xbf553ec4,0xbf7b248d,0x3f55bec4
.long 0x248d3f80,0xa554bf80,0x248d3f80,0xa554bf80,0xbf7b248d,0x3f553ec4,0x3f7ba554,0xbf55bec4
.long 0x3ec4bf80,0xbf6d3f35,0x3ec4bf80,0xbf6d3f35,0x3f55a554,0x3e48bf6d,0xbf55248d,0xbe483f6d
.long 0xbf353f80,0x3f35a554,0xbf353f80,0x3f35a554,0xbf0e248d,0xbf7b3f6d,0x3f0ea554,0x3f7bbf6d
.long 0x3f6dbf80,0x3ec4bf35,0x3f6dbf80,0x3ec4bf35,0x3e48a554,0x3f0ebec4,0xbe48248d,0xbf0e3ec4
.long 0x3f803f80,0x3f803f80,0x3f803f80,0x3f803f80,0xbf55bf35,0xbf7bbf6d,0x3f553f35,0x3f7b3f6d
.long 0x3ec4a554,0x3f6d3f35,0x3ec4a554,0x3f6d3f35,0x3e483f35,0xbf55bec4,0xbe48bf35,0x3f553ec4
.long 0xbf35bf80,0x3f35a554,0xbf35bf80,0x3f35a554,0x3f7b3f35,0xbf0e3ec4,0xbf7bbf35,0x3f0ebec4
.long 0xbf6d248d,0x3ec4bf35,0xbf6d248d,0x3ec4bf35,0x3f0ebf35,0xbe483f6d,0xbf0e3f35,0x3e48bf6d
.long 0x248d3f80,0xa554bf80,0x248d3f80,0xa554bf80,0xbf0ebf35,0x3e483f6d,0x3f0e3f35,0xbe48bf6d
.long 0x3f6da554,0xbec4bf35,0x3f6da554,0xbec4bf35,0xbf7b3f35,0x3f0e3ec4,0x3f7bbf35,0xbf0ebec4
.long 0x3f35bf80,0xbf35248d,0x3f35bf80,0xbf35248d,0xbe483f35,0x3f55bec4,0x3e48bf35,0xbf553ec4
.long 0xbec4248d,0xbf6d3f35,0xbec4248d,0xbf6d3f35,0x3f55bf35,0x3f7bbf6d,0xbf553f35,0xbf7b3f6d
.long 0x0,0x0,0x0,0x0,0x3e480000,0x3f0e3ec4,0xbe48250d,0xbf0ebec4
.long 0x3ec40000,0x3f6d3f35,0x3ec40000,0x3f6d3f35,0x3f0e0000,0x3f7b3f6d,0xbf0e250d,0xbf7bbf6d
.long 0x3f350000,0x3f353f80,0x3f350000,0x3f353f80,0x3f550000,0x3e483f6d,0xbf55250d,0xbe48bf6d
.long 0x3f6d0000,0xbec43f35,0x3f6d0000,0xbec43f35,0x3f7b0000,0xbf553ec4,0xbf7b250d,0x3f55bec4
.long 0x3f800000,0xbf80250d,0x3f800000,0xbf80250d,0x3f7b0000,0xbf55bec4,0xbf7b250d,0x3f553ec4
.long 0x3f6d0000,0xbec4bf35,0x3f6d0000,0xbec4bf35,0x3f550000,0x3e48bf6d,0xbf55250d,0xbe483f6d
.long 0x3f350000,0x3f35bf80,0x3f350000,0x3f35bf80,0x3f0e0000,0x3f7bbf6d,0xbf0e250d,0xbf7b3f6d
.long 0x3ec40000,0x3f6dbf35,0x3ec40000,0x3f6dbf35,0x3e480000,0x3f0ebec4,0xbe48250d,0xbf0e3ec4
.long 0x0,0x0,0x0,0x0,0x3f553f35,0x3f7b3f6d,0xbf55bf35,0xbf7bbf6d
.long 0x3f6d3f80,0x3ec43f35,0x3f6d3f80,0x3ec43f35,0x3e483f35,0xbf55bec4,0xbe48bf35,0x3f553ec4
.long 0xbf35250d,0xbf35bf80,0xbf35250d,0xbf35bf80,0xbf7bbf35,0x3f0ebec4,0x3f7b3f35,0xbf0e3ec4
.long 0xbec4bf80,0x3f6d3f35,0xbec4bf80,0x3f6d3f35,0x3f0ebf35,0xbe483f6d,0xbf0e3f35,0x3e48bf6d
.long 0x3f800000,0xbf80250d,0x3f800000,0xbf80250d,0x3f0e3f35,0xbe48bf6d,0xbf0ebf35,0x3e483f6d
.long 0xbec43f80,0x3f6dbf35,0xbec43f80,0x3f6dbf35,0xbf7b3f35,0x3f0e3ec4,0x3f7bbf35,0xbf0ebec4
.long 0xbf35250d,0xbf353f80,0xbf35250d,0xbf353f80,0x3e48bf35,0xbf553ec4,0xbe483f35,0x3f55bec4
.long 0x3f6dbf80,0x3ec4bf35,0x3f6dbf80,0x3ec4bf35,0x3f55bf35,0x3f7bbf6d,0xbf553f35,0xbf7b3f6d
.long 0x0,0x0,0x0,0x0,0x3f7b3f80,0x3f553f6d,0xbf7bbf80,0xbf55bf6d
.long 0xbec4250d,0xbf6dbf35,0xbec4250d,0xbf6dbf35,0xbf55bf80,0x3e48bec4,0x3f553f80,0xbe483ec4
.long 0x3f350000,0x3f353f80,0x3f350000,0x3f353f80,0x3f0e3f80,0xbf7bbec4,0xbf0ebf80,0x3f7b3ec4
.long 0xbf6d250d,0x3ec4bf35,0xbf6d250d,0x3ec4bf35,0xbe48bf80,0x3f0e3f6d,0x3e483f80,0xbf0ebf6d
.long 0x3f800000,0xbf80250d,0x3f800000,0xbf80250d,0xbe483f80,0x3f0ebf6d,0x3e48bf80,0xbf0e3f6d
.long 0xbf6d250d,0x3ec43f35,0xbf6d250d,0x3ec43f35,0x3f0ebf80,0xbf7b3ec4,0xbf0e3f80,0x3f7bbec4
.long 0x3f350000,0x3f35bf80,0x3f350000,0x3f35bf80,0xbf553f80,0x3e483ec4,0x3f55bf80,0xbe48bec4
.long 0xbec4250d,0xbf6d3f35,0xbec4250d,0xbf6d3f35,0x3f7bbf80,0x3f55bf6d,0xbf7b3f80,0xbf553f6d
.long 0x0,0x0,0x0,0x0,0x3f0e3f35,0x3e483ec4,0xbf0ebf35,0xbe48bec4
.long 0xbf6dbf80,0xbec4bf35,0xbf6dbf80,0xbec4bf35,0x3f7b3f35,0x3f0e3f6d,0xbf7bbf35,0xbf0ebf6d
.long 0xbf35250d,0xbf35bf80,0xbf35250d,0xbf35bf80,0x3e48bf35,0x3f553f6d,0xbe483f35,0xbf55bf6d
.long 0x3ec43f80,0xbf6dbf35,0x3ec43f80,0xbf6dbf35,0xbf55bf35,0x3f7b3ec4,0x3f553f35,0xbf7bbec4
.long 0x3f800000,0xbf80250d,0x3f800000,0xbf80250d,0xbf553f35,0x3f7bbec4,0x3f55bf35,0xbf7b3ec4
.long 0x3ec4bf80,0xbf6d3f35,0x3ec4bf80,0xbf6d3f35,0x3e483f35,0x3f55bf6d,0xbe48bf35,0xbf553f6d
.long 0xbf35250d,0xbf353f80,0xbf35250d,0xbf353f80,0x3f7bbf35,0x3f0ebf6d,0xbf7b3f35,0xbf0e3f6d
.long 0xbf6d3f80,0xbec43f35,0xbf6d3f80,0xbec43f35,0x3f0ebf35,0x3e48bec4,0xbf0e3f35,0xbe483ec4
.long 0x80008000,0x80008000,0x80008000,0x80008000,0xbe488000,0xbf0ebec4,0x3e48a50d,0x3f0e3ec4
.long 0xbec48000,0xbf6dbf35,0xbec48000,0xbf6dbf35,0xbf0e8000,0xbf7bbf6d,0x3f0ea50d,0x3f7b3f6d
.long 0xbf358000,0xbf35bf80,0xbf358000,0xbf35bf80,0xbf558000,0xbe48bf6d,0x3f55a50d,0x3e483f6d
.long 0xbf6d8000,0x3ec4bf35,0xbf6d8000,0x3ec4bf35,0xbf7b8000,0x3f55bec4,0x3f7ba50d,0xbf553ec4
.long 0xbf808000,0x3f80a50d,0xbf808000,0x3f80a50d,0xbf7b8000,0x3f553ec4,0x3f7ba50d,0xbf55bec4
.long 0xbf6d8000,0x3ec43f35,0xbf6d8000,0x3ec43f35,0xbf558000,0xbe483f6d,0x3f55a50d,0x3e48bf6d
.long 0xbf358000,0xbf353f80,0xbf358000,0xbf353f80,0xbf0e8000,0xbf7b3f6d,0x3f0ea50d,0x3f7bbf6d
.long 0xbec48000,0xbf6d3f35,0xbec48000,0xbf6d3f35,0xbe488000,0xbf0e3ec4,0x3e48a50d,0x3f0ebec4
.long 0x80008000,0x80008000,0x80008000,0x80008000,0xbf55bf35,0xbf7bbf6d,0x3f553f35,0x3f7b3f6d
.long 0xbf6dbf80,0xbec4bf35,0xbf6dbf80,0xbec4bf35,0xbe48bf35,0x3f553ec4,0x3e483f35,0xbf55bec4
.long 0x3f35a50d,0x3f353f80,0x3f35a50d,0x3f353f80,0x3f7b3f35,0xbf0e3ec4,0xbf7bbf35,0x3f0ebec4
.long 0x3ec43f80,0xbf6dbf35,0x3ec43f80,0xbf6dbf35,0xbf0e3f35,0x3e48bf6d,0x3f0ebf35,0xbe483f6d
.long 0xbf808000,0x3f80a50d,0xbf808000,0x3f80a50d,0xbf0ebf35,0x3e483f6d,0x3f0e3f35,0xbe48bf6d
.long 0x3ec4bf80,0xbf6d3f35,0x3ec4bf80,0xbf6d3f35,0x3f7bbf35,0xbf0ebec4,0xbf7b3f35,0x3f0e3ec4
.long 0x3f35a50d,0x3f35bf80,0x3f35a50d,0x3f35bf80,0xbe483f35,0x3f55bec4,0x3e48bf35,0xbf553ec4
.long 0xbf6d3f80,0xbec43f35,0xbf6d3f80,0xbec43f35,0xbf553f35,0xbf7b3f6d,0x3f55bf35,0x3f7bbf6d
.long 0x80008000,0x80008000,0x80008000,0x80008000,0xbf7bbf80,0xbf55bf6d,0x3f7b3f80,0x3f553f6d
.long 0x3ec4a50d,0x3f6d3f35,0x3ec4a50d,0x3f6d3f35,0x3f553f80,0xbe483ec4,0xbf55bf80,0x3e48bec4
.long 0xbf358000,0xbf35bf80,0xbf358000,0xbf35bf80,0xbf0ebf80,0x3f7b3ec4,0x3f0e3f80,0xbf7bbec4
.long 0x3f6da50d,0xbec43f35,0x3f6da50d,0xbec43f35,0x3e483f80,0xbf0ebf6d,0xbe48bf80,0x3f0e3f6d
.long 0xbf808000,0x3f80a50d,0xbf808000,0x3f80a50d,0x3e48bf80,0xbf0e3f6d,0xbe483f80,0x3f0ebf6d
.long 0x3f6da50d,0xbec4bf35,0x3f6da50d,0xbec4bf35,0xbf0e3f80,0x3f7bbec4,0x3f0ebf80,0xbf7b3ec4
.long 0xbf358000,0xbf353f80,0xbf358000,0xbf353f80,0x3f55bf80,0xbe48bec4,0xbf553f80,0x3e483ec4
.long 0x3ec4a50d,0x3f6dbf35,0x3ec4a50d,0x3f6dbf35,0xbf7b3f80,0xbf553f6d,0x3f7bbf80,0x3f55bf6d
.long 0x80008000,0x80008000,0x80008000,0x80008000,0xbf0ebf35,0xbe48bec4,0x3f0e3f35,0x3e483ec4
.long 0x3f6d3f80,0x3ec43f35,0x3f6d3f80,0x3ec43f35,0xbf7bbf35,0xbf0ebf6d,0x3f7b3f35,0x3f0e3f6d
.long 0x3f35a50d,0x3f353f80,0x3f35a50d,0x3f353f80,0xbe483f35,0xbf55bf6d,0x3e48bf35,0x3f553f6d
.long 0xbec4bf80,0x3f6d3f35,0xbec4bf80,0x3f6d3f35,0x3f553f35,0xbf7bbec4,0xbf55bf35,0x3f7b3ec4
.long 0xbf808000,0x3f80a50d,0xbf808000,0x3f80a50d,0x3f55bf35,0xbf7b3ec4,0xbf553f35,0x3f7bbec4
.long 0xbec43f80,0x3f6dbf35,0xbec43f80,0x3f6dbf35,0xbe48bf35,0xbf553f6d,0x3e483f35,0x3f55bf6d
.long 0x3f35a50d,0x3f35bf80,0x3f35a50d,0x3f35bf80,0xbf7b3f35,0xbf0e3f6d,0x3f7bbf35,0x3f0ebf6d
.long 0x3f6dbf80,0x3ec4bf35,0x3f6dbf80,0x3ec4bf35,0xbf0e3f35,0xbe483ec4,0x3f0ebf35,0x3e48bec4
.long 0x3b124925,0x3727c5ac,0x0,0x0,0x3b124925,0x3727c5ac,0x10,0x8
.long 0x3b124925,0x3727c5ac,0x20,0x10,0x3b124925,0x3727c5ac,0x30,0x18
.long 0x3b124925,0x3727c5ac,0x40,0x40,0x3b124925,0x3727c5ac,0x50,0x48
.long 0x3b124925,0x3727c5ac,0x60,0x50,0x3b124925,0x3727c5ac,0x70,0x58
.long 0x3b124925,0x3727c5ac,0x80,0x80,0x3b124925,0x3727c5ac,0x90,0x88
.long 0x3b124925,0x3727c5ac,0xa0,0x90,0x3b124925,0x3727c5ac,0xb0,0x98
.long 0x3b124925,0x3727c5ac,0xc0,0xc0,0x3b124925,0x3727c5ac,0xd0,0xc8
.long 0x3b124925,0x3727c5ac,0xe0,0xd0,0x3b124925,0x3727c5ac,0xf0,0xd8
.long 0x3b124925,0x3727c5ac,0x100,0x100,0x3b124925,0x3727c5ac,0x110,0x108
.long 0x3b124925,0x3727c5ac,0x120,0x110,0x3b124925,0x3727c5ac,0x130,0x118
.long 0x3b124925,0x3727c5ac,0x140,0x140,0x3b124925,0x3727c5ac,0x150,0x148
.long 0x3b124925,0x3727c5ac,0x160,0x150,0x3b124925,0x3727c5ac,0x170,0x158
.long 0x3b124925,0x3727c5ac,0x180,0x180,0x3b124925,0x3727c5ac,0x190,0x188
.long 0x3b124925,0x3727c5ac,0x1a0,0x190,0x3b124925,0x3727c5ac,0x1b0,0x198
.long 0x3b124925,0x3727c5ac,0x1c0,0x1c0,0x3b124925,0x3727c5ac,0x1d0,0x1c8
.long 0x3b124925,0x3727c5ac,0x1e0,0x1d0,0x3b124925,0x3727c5ac,0x1f0,0x1d8
.long 0x3b124925,0x3727c5ac,0x200,0x200,0x3b124925,0x3727c5ac,0x210,0x208
.long 0x3b124925,0x3727c5ac,0x220,0x210,0x3b124925,0x3727c5ac,0x230,0x218
.long 0x3b124925,0x3727c5ac,0x240,0x240,0x3b124925,0x3727c5ac,0x250,0x248
.long 0x3b124925,0x3727c5ac,0x260,0x250,0x3b124925,0x3727c5ac,0x270,0x258
.long 0x3b124925,0x3727c5ac,0x280,0x280,0x3b124925,0x3727c5ac,0x290,0x288
.long 0x3b124925,0x3727c5ac,0x2a0,0x290,0x3b124925,0x3727c5ac,0x2b0,0x298
.long 0x3b124925,0x3727c5ac,0x2c0,0x2c0,0x3b124925,0x3727c5ac,0x2d0,0x2c8
.long 0x3b124925,0x3727c5ac,0x2e0,0x2d0,0x3b124925,0x3727c5ac,0x2f0,0x2d8
.long 0x3b124925,0x3727c5ac,0x300,0x300,0x3b124925,0x3727c5ac,0x310,0x308
.long 0x3b124925,0x3727c5ac,0x320,0x310,0x3b124925,0x3727c5ac,0x330,0x318
.long 0x3b124925,0x3727c5ac,0x340,0x340,0x3b124925,0x3727c5ac,0x350,0x348
.long 0x3b124925,0x3727c5ac,0x360,0x350,0x3b124925,0x3727c5ac,0x370,0x358
.long 0x3b124925,0x3727c5ac,0x370,0x380,0x3b124925,0x3727c5ac,0x370,0x388
.long 0x3b124925,0x3727c5ac,0x370,0x390,0x3b124925,0x3727c5ac,0x370,0x398
.long 0x3b124925,0x3727c5ac,0x370,0x3c0,0x3b124925,0x3727c5ac,0x370,0x3c8
.long 0x3b124925,0x3727c5ac,0x370,0x3d0,0x3b124925,0x3727c5ac,0x370,0x3d8
.long 0x0,0x0,0x0,0xffffffff,0x8,0x10,0x10,0xffffffff
.long 0x10,0x20,0x20,0xffffffff,0x18,0x30,0x30,0xffffffff
.long 0x20,0x40,0x40,0xffffffff,0x28,0x50,0x50,0xffffffff
.long 0x30,0x60,0x60,0xffffffff,0x38,0x70,0x70,0xffffffff
.long 0x40,0x80,0x80,0xffffffff,0x48,0x90,0x90,0xffffffff
.long 0x50,0xa0,0xa0,0xffffffff,0x58,0xb0,0xb0,0xffffffff
.long 0x60,0xc0,0xc0,0xffffffff,0x68,0xd0,0xd0,0xffffffff
.long 0x700,0xe0,0xe0,0xffffffff,0x710,0xf0,0xf0,0xffffffff
.long 0x1c0,0x880,0x80000,0xffffffff,0x1c8,0x890,0x80010,0xffffffff
.long 0x1d0,0x8a0,0x80020,0xffffffff,0x1d8,0x8b0,0x80030,0xffffffff
.long 0x1e0,0x8c0,0x80040,0xffffffff,0x1e8,0x8d0,0x80050,0xffffffff
.long 0x1f0,0x8e0,0x80060,0xffffffff,0x1f8,0x8f0,0x80070,0xffffffff
.long 0x200,0x900,0x80080,0xffffffff,0x208,0x910,0x80090,0xffffffff
.long 0x210,0x920,0x800a0,0xffffffff,0x218,0x930,0x800b0,0xffffffff
.long 0x220,0x940,0x800c0,0xffffffff,0x228,0x950,0x800d0,0xffffffff
.long 0x710,0x960,0x800e0,0xffffffff,0x710,0x970,0x800f0,0xffffffff
.long 0x380,0x1100,0x100000,0xffffffff,0x388,0x1110,0x100010,0xffffffff
.long 0x390,0x1120,0x100020,0xffffffff,0x398,0x1130,0x100030,0xffffffff
.long 0x3a0,0x1140,0x100040,0xffffffff,0x3a8,0x1150,0x100050,0xffffffff
.long 0x3b0,0x1160,0x100060,0xffffffff,0x3b8,0x1170,0x100070,0xffffffff
.long 0x3c0,0x1180,0x100080,0xffffffff,0x3c8,0x1190,0x100090,0xffffffff
.long 0x3d0,0x11a0,0x1000a0,0xffffffff,0x3d8,0x11b0,0x1000b0,0xffffffff
.long 0x3e0,0x11c0,0x1000c0,0xffffffff,0x3e8,0x11d0,0x1000d0,0xffffffff
.long 0x710,0x11e0,0x1000e0,0xffffffff,0x710,0x11f0,0x1000f0,0xffffffff
.long 0x540,0x1980,0x180000,0x0,0x548,0x1990,0x180010,0x0
.long 0x550,0x19a0,0x180020,0x0,0x558,0x19b0,0x180030,0x0
.long 0x560,0x19c0,0x180040,0x0,0x568,0x19d0,0x180050,0x0
.long 0x570,0x19e0,0x180060,0x0,0x578,0x19f0,0x180070,0x0
.long 0x580,0x1a00,0x180080,0x0,0x588,0x1a10,0x180090,0x0
.long 0x590,0x1a20,0x1800a0,0x0,0x598,0x1a30,0x1800b0,0x0
.long 0x5a0,0x1a40,0x1800c0,0x0,0x5a8,0x1a50,0x1800d0,0x0
.long 0x710,0x1a60,0x1800e0,0x0,0x710,0x1a70,0x1800f0,0x0
.long 0x0,0x0,0x3f800054,0x2edbe6ff,0xffffffff,0x10,0x3f800054,0x2edbe6ff
.long 0xffffffff,0x20,0x3f800054,0x2edbe6ff,0xffffffff,0x30,0x3f800054,0x2edbe6ff
.long 0xffffffff,0x40,0x3f800054,0x2edbe6ff,0xffffffff,0x50,0x3f800054,0x2edbe6ff
.long 0xffffffff,0x60,0x3f800054,0x2edbe6ff,0xffffffff,0x70,0x3f800054,0x2edbe6ff
.long 0xffffffff,0x80,0x3f800054,0x2edbe6ff,0xffffffff,0x90,0x3f800054,0x2edbe6ff
.long 0xffffffff,0xa0,0x3f800054,0x2edbe6ff,0xffffffff,0xb0,0x3f800054,0x2edbe6ff
.long 0xffffffff,0xc0,0x3f800054,0x2edbe6ff,0xffffffff,0xd0,0x3f800054,0x2edbe6ff
.long 0xffffffff,0xe0,0x3f800054,0x2edbe6ff,0xffffffff,0xf0,0x3f800054,0x2edbe6ff
.long 0xffffffff,0x100,0x3f800054,0x2edbe6ff,0xffffffff,0x110,0x3f800054,0x2edbe6ff
.long 0xffffffff,0x120,0x3f800054,0x2edbe6ff,0xffffffff,0x130,0x3f800054,0x2edbe6ff
.long 0xffffffff,0x140,0x3f800054,0x2edbe6ff,0xffffffff,0x150,0x3f800054,0x2edbe6ff
.long 0xffffffff,0x160,0x3f800054,0x2edbe6ff,0xffffffff,0x170,0x3f800054,0x2edbe6ff
.long 0xffffffff,0x180,0x3f800054,0x2edbe6ff,0xffffffff,0x190,0x3f800054,0x2edbe6ff
.long 0xffffffff,0x1a0,0x3f800054,0x2edbe6ff,0xffffffff,0x1b0,0x3f800054,0x2edbe6ff
.long 0xffffffff,0x1c0,0x3f800054,0x2edbe6ff,0xffffffff,0x1d0,0x3f800054,0x2edbe6ff
.long 0xffffffff,0x1e0,0x3f800054,0x2edbe6ff,0xffffffff,0x1f0,0x3f800054,0x2edbe6ff
.long 0xffffffff,0x200,0x3f800054,0x2edbe6ff,0xffffffff,0x210,0x3f800054,0x2edbe6ff
.long 0xffffffff,0x220,0x3f800054,0x2edbe6ff,0xffffffff,0x230,0x3f800054,0x2edbe6ff
.long 0xffffffff,0x240,0x3f800054,0x2edbe6ff,0xffffffff,0x250,0x3f800054,0x2edbe6ff
.long 0xffffffff,0x260,0x3f800054,0x2edbe6ff,0xffffffff,0x270,0x3f800054,0x2edbe6ff
.long 0xffffffff,0x280,0x3f800054,0x2edbe6ff,0xffffffff,0x290,0x3f800054,0x2edbe6ff
.long 0xffffffff,0x2a0,0x3f800054,0x2edbe6ff,0xffffffff,0x2b0,0x3f800054,0x2edbe6ff
.long 0xffffffff,0x2c0,0x3f800054,0x2edbe6ff,0xffffffff,0x2d0,0x3f800054,0x2edbe6ff
.long 0xffffffff,0x2e0,0x3f800054,0x2edbe6ff,0xffffffff,0x2f0,0x3f800054,0x2edbe6ff
.long 0xffffffff,0x300,0x3f800054,0x2edbe6ff,0xffffffff,0x310,0x3f800054,0x2edbe6ff
.long 0xffffffff,0x320,0x3f800054,0x2edbe6ff,0xffffffff,0x330,0x3f800054,0x2edbe6ff
.long 0xffffffff,0x340,0x3f800054,0x2edbe6ff,0xffffffff,0x350,0x3f800054,0x2edbe6ff
.long 0xffffffff,0x360,0x3f800054,0x2edbe6ff,0xffffffff,0x370,0x3f800054,0x2edbe6ff
.long 0xffffffff,0x380,0x3f800054,0x2edbe6ff,0xffffffff,0x390,0x3f800054,0x2edbe6ff
.long 0xffffffff,0x3a0,0x3f800054,0x2edbe6ff,0xffffffff,0x3b0,0x3f800054,0x2edbe6ff
.long 0xffffffff,0x3c0,0x3f800054,0x2edbe6ff,0xffffffff,0x3d0,0x3f800054,0x2edbe6ff
.long 0xffffffff,0x3e0,0x3f800054,0x2edbe6ff,0xffffffff,0x3f0,0x3f800054,0x2edbe6ff
.long 0x80003f80,0x80003f80,0x80003f80,0x80003f80,0x80003f80,0xbe483f7b,0xbec43f6d,0xbf0e3f55
.long 0x80003f80,0xbec43f6d,0xbf353f35,0xbf6d3ec4,0x80003f80,0xbf0e3f55,0xbf6d3ec4,0xbf7bbe48
.long 0x80003f80,0xbf353f35,0xbf80248d,0xbf35bf35,0x80003f80,0xbf553f0e,0xbf6dbec4,0xbe48bf7b
.long 0x80003f80,0xbf6d3ec4,0xbf35bf35,0x3ec4bf6d,0x80003f80,0xbf7b3e48,0xbec4bf6d,0x3f55bf0e
.long 0x80003f80,0xbf80248d,0xa50dbf80,0x3f80a554,0x80003f80,0xbf7bbe48,0x3ec4bf6d,0x3f553f0e
.long 0x80003f80,0xbf6dbec4,0x3f35bf35,0x3ec43f6d,0x80003f80,0xbf55bf0e,0x3f6dbec4,0xbe483f7b
.long 0x80003f80,0xbf35bf35,0x3f80a554,0xbf353f35,0x80003f80,0xbf0ebf55,0x3f6d3ec4,0xbf7b3e48
.long 0x80003f80,0xbec4bf6d,0x3f353f35,0xbf6dbec4,0x80003f80,0xbe48bf7b,0x3ec43f6d,0xbf0ebf55
.long 0x80003f80,0x80003f80,0x80003f80,0x80003f80,0xbf353f35,0xbf553f0e,0xbf6d3ec4,0xbf7b3e48
.long 0xbf80248d,0xbf6dbec4,0xbf35bf35,0xbec4bf6d,0xbf35bf35,0xbe48bf7b,0x3ec4bf6d,0x3f55bf0e
.long 0xa50dbf80,0x3f35bf35,0x3f80a554,0x3f353f35,0x3f35bf35,0x3f7b3e48,0x3ec43f6d,0xbf0e3f55
.long 0x3f80a554,0x3ec43f6d,0xbf353f35,0xbf6dbec4,0x3f353f35,0xbf0e3f55,0xbf6dbec4,0x3e48bf7b
.long 0x80003f80,0xbf80248d,0xa50dbf80,0x3f80a554,0xbf353f35,0xbf0ebf55,0x3f6dbec4,0x3e483f7b
.long 0xbf80248d,0x3ec4bf6d,0x3f353f35,0xbf6d3ec4,0xbf35bf35,0x3f7bbe48,0xbec43f6d,0xbf0ebf55
.long 0xa50dbf80,0x3f353f35,0xbf80248d,0x3f35bf35,0x3f35bf35,0xbe483f7b,0xbec4bf6d,0x3f553f0e
.long 0x3f80a554,0xbf6d3ec4,0x3f35bf35,0xbec43f6d,0x3f353f35,0xbf55bf0e,0x3f6d3ec4,0xbf7bbe48
.long 0x80003f80,0x80003f80,0x80003f80,0x80003f80,0xbf80248d,0xbf7bbe48,0xbf6dbec4,0xbf55bf0e
.long 0xa50dbf80,0x3ec4bf6d,0x3f35bf35,0x3f6dbec4,0x3f80a554,0x3f553f0e,0x3ec43f6d,0xbe483f7b
.long 0x80003f80,0xbf353f35,0xbf80248d,0xbf35bf35,0xbf80248d,0xbf0ebf55,0x3ec4bf6d,0x3f7bbe48
.long 0xa50dbf80,0x3f6dbec4,0x3f353f35,0xbec43f6d,0x3f80a554,0x3e483f7b,0xbf6d3ec4,0xbf0ebf55
.long 0x80003f80,0xbf80248d,0xa50dbf80,0x3f80a554,0xbf80248d,0x3e48bf7b,0x3f6d3ec4,0xbf0e3f55
.long 0xa50dbf80,0x3f6d3ec4,0xbf353f35,0xbec4bf6d,0x3f80a554,0xbf0e3f55,0xbec4bf6d,0x3f7b3e48
.long 0x80003f80,0xbf35bf35,0x3f80a554,0xbf353f35,0xbf80248d,0x3f55bf0e,0xbec43f6d,0xbe48bf7b
.long 0xa50dbf80,0x3ec43f6d,0xbf35bf35,0x3f6d3ec4,0x3f80a554,0xbf7b3e48,0x3f6dbec4,0xbf553f0e
.long 0x80003f80,0x80003f80,0x80003f80,0x80003f80,0xbf35bf35,0xbf0ebf55,0xbec4bf6d,0xbe48bf7b
.long 0x3f80a554,0x3f6d3ec4,0x3f353f35,0x3ec43f6d,0xbf353f35,0xbf7b3e48,0xbf6dbec4,0xbf0ebf55
.long 0xa50dbf80,0x3f35bf35,0x3f80a554,0x3f353f35,0x3f353f35,0xbe483f7b,0xbf6d3ec4,0xbf55bf0e
.long 0xbf80248d,0xbec4bf6d,0x3f35bf35,0x3f6d3ec4,0x3f35bf35,0x3f553f0e,0xbec43f6d,0xbf7bbe48
.long 0x80003f80,0xbf80248d,0xa50dbf80,0x3f80a554,0xbf35bf35,0x3f55bf0e,0x3ec43f6d,0xbf7b3e48
.long 0x3f80a554,0xbec43f6d,0xbf35bf35,0x3f6dbec4,0xbf353f35,0xbe48bf7b,0x3f6d3ec4,0xbf553f0e
.long 0xa50dbf80,0x3f353f35,0xbf80248d,0x3f35bf35,0x3f353f35,0xbf7bbe48,0x3f6dbec4,0xbf0e3f55
.long 0xbf80248d,0x3f6dbec4,0xbf353f35,0x3ec4bf6d,0x3f35bf35,0xbf0e3f55,0x3ec4bf6d,0xbe483f7b
.long 0x3f800000,0x3f800000,0x3f800000,0x3f800000,0x3f800000,0x3f7b3e48,0x3f6d3ec4,0x3f553f0e
.long 0x3f800000,0x3f6d3ec4,0x3f353f35,0x3ec43f6d,0x3f800000,0x3f553f0e,0x3ec43f6d,0xbe483f7b
.long 0x3f800000,0x3f353f35,0x248d3f80,0xbf353f35,0x3f800000,0x3f0e3f55,0xbec43f6d,0xbf7b3e48
.long 0x3f800000,0x3ec43f6d,0xbf353f35,0xbf6dbec4,0x3f800000,0x3e483f7b,0xbf6d3ec4,0xbf0ebf55
.long 0x3f800000,0x248d3f80,0xbf80250d,0xa554bf80,0x3f800000,0xbe483f7b,0xbf6dbec4,0x3f0ebf55
.long 0x3f800000,0xbec43f6d,0xbf35bf35,0x3f6dbec4,0x3f800000,0xbf0e3f55,0xbec4bf6d,0x3f7b3e48
.long 0x3f800000,0xbf353f35,0xa554bf80,0x3f353f35,0x3f800000,0xbf553f0e,0x3ec4bf6d,0x3e483f7b
.long 0x3f800000,0xbf6d3ec4,0x3f35bf35,0xbec43f6d,0x3f800000,0xbf7b3e48,0x3f6dbec4,0xbf553f0e
.long 0x3f800000,0x3f800000,0x3f800000,0x3f800000,0x3f353f35,0x3f0e3f55,0x3ec43f6d,0x3e483f7b
.long 0x248d3f80,0xbec43f6d,0xbf353f35,0xbf6d3ec4,0xbf353f35,0xbf7b3e48,0xbf6dbec4,0xbf0ebf55
.long 0xbf80250d,0xbf35bf35,0xa554bf80,0x3f35bf35,0xbf35bf35,0x3e48bf7b,0x3f6dbec4,0x3f553f0e
.long 0xa554bf80,0x3f6dbec4,0x3f353f35,0xbec43f6d,0x3f35bf35,0x3f553f0e,0xbec43f6d,0xbf7bbe48
.long 0x3f800000,0x248d3f80,0xbf80250d,0xa554bf80,0x3f353f35,0xbf553f0e,0xbec4bf6d,0x3f7bbe48
.long 0x248d3f80,0xbf6dbec4,0x3f35bf35,0x3ec43f6d,0xbf353f35,0xbe48bf7b,0x3f6d3ec4,0xbf553f0e
.long 0xbf80250d,0x3f35bf35,0x248d3f80,0xbf35bf35,0xbf35bf35,0x3f7b3e48,0xbf6d3ec4,0x3f0ebf55
.long 0xa554bf80,0x3ec43f6d,0xbf35bf35,0x3f6d3ec4,0x3f35bf35,0xbf0e3f55,0x3ec4bf6d,0xbe483f7b
.long 0x3f800000,0x3f800000,0x3f800000,0x3f800000,0x248d3f80,0xbe483f7b,0xbec43f6d,0xbf0e3f55
.long 0xbf80250d,0xbf6dbec4,0xbf35bf35,0xbec4bf6d,0xa554bf80,0x3f0ebf55,0x3f6dbec4,0x3f7b3e48
.long 0x3f800000,0x3f353f35,0x248d3f80,0xbf353f35,0x248d3f80,0xbf553f0e,0xbf6dbec4,0xbe48bf7b
.long 0xbf80250d,0xbec4bf6d,0x3f35bf35,0x3f6d3ec4,0xa554bf80,0x3f7bbe48,0x3ec43f6d,0xbf553f0e
.long 0x3f800000,0x248d3f80,0xbf80250d,0xa554bf80,0x248d3f80,0xbf7bbe48,0x3ec4bf6d,0x3f553f0e
.long 0xbf80250d,0x3ec4bf6d,0x3f353f35,0xbf6d3ec4,0xa554bf80,0x3f553f0e,0xbf6d3ec4,0x3e48bf7b
.long 0x3f800000,0xbf353f35,0xa554bf80,0x3f353f35,0x248d3f80,0xbf0ebf55,0x3f6d3ec4,0xbf7b3e48
.long 0xbf80250d,0x3f6dbec4,0xbf353f35,0x3ec4bf6d,0xa554bf80,0x3e483f7b,0xbec4bf6d,0x3f0e3f55
.long 0x3f800000,0x3f800000,0x3f800000,0x3f800000,0xbf353f35,0xbf553f0e,0xbf6d3ec4,0xbf7b3e48
.long 0xa554bf80,0x3ec4bf6d,0x3f35bf35,0x3f6dbec4,0x3f353f35,0x3e483f7b,0xbec43f6d,0xbf553f0e
.long 0xbf80250d,0xbf35bf35,0xa554bf80,0x3f35bf35,0x3f35bf35,0x3f7b3e48,0x3ec43f6d,0xbf0e3f55
.long 0x248d3f80,0xbf6d3ec4,0xbf35bf35,0x3ec4bf6d,0xbf35bf35,0x3f0ebf55,0x3f6d3ec4,0xbe483f7b
.long 0x3f800000,0x248d3f80,0xbf80250d,0xa554bf80,0xbf353f35,0xbf0ebf55,0x3f6dbec4,0x3e483f7b
.long 0xa554bf80,0x3f6d3ec4,0xbf353f35,0xbec4bf6d,0x3f353f35,0xbf7b3e48,0x3ec4bf6d,0x3f0e3f55
.long 0xbf80250d,0x3f35bf35,0x248d3f80,0xbf35bf35,0x3f35bf35,0xbe483f7b,0xbec4bf6d,0x3f553f0e
.long 0x248d3f80,0xbec4bf6d,0x3f353f35,0xbf6dbec4,0xbf35bf35,0x3f553f0e,0xbf6dbec4,0x3f7b3e48
.long 0x80003f80,0xa50dbf80,0x80003f80,0xa50dbf80,0x80003f80,0x3e48bf7b,0xbec43f6d,0x3f0ebf55
.long 0x80003f80,0x3ec4bf6d,0xbf353f35,0x3f6dbec4,0x80003f80,0x3f0ebf55,0xbf6d3ec4,0x3f7b3e48
.long 0x80003f80,0x3f35bf35,0xbf80248d,0x3f353f35,0x80003f80,0x3f55bf0e,0xbf6dbec4,0x3e483f7b
.long 0x80003f80,0x3f6dbec4,0xbf35bf35,0xbec43f6d,0x80003f80,0x3f7bbe48,0xbec4bf6d,0xbf553f0e
.long 0x80003f80,0x3f80a554,0xa50dbf80,0xbf80248d,0x80003f80,0x3f7b3e48,0x3ec4bf6d,0xbf55bf0e
.long 0x80003f80,0x3f6d3ec4,0x3f35bf35,0xbec4bf6d,0x80003f80,0x3f553f0e,0x3f6dbec4,0x3e48bf7b
.long 0x80003f80,0x3f353f35,0x3f80a554,0x3f35bf35,0x80003f80,0x3f0e3f55,0x3f6d3ec4,0x3f7bbe48
.long 0x80003f80,0x3ec43f6d,0x3f353f35,0x3f6d3ec4,0x80003f80,0x3e483f7b,0x3ec43f6d,0x3f0e3f55
.long 0x80003f80,0xa50dbf80,0x80003f80,0xa50dbf80,0xbf353f35,0x3f55bf0e,0xbf6d3ec4,0x3f7bbe48
.long 0xbf80248d,0x3f6d3ec4,0xbf35bf35,0x3ec43f6d,0xbf35bf35,0x3e483f7b,0x3ec4bf6d,0xbf553f0e
.long 0xa50dbf80,0xbf353f35,0x3f80a554,0xbf35bf35,0x3f35bf35,0xbf7bbe48,0x3ec43f6d,0x3f0ebf55
.long 0x3f80a554,0xbec4bf6d,0xbf353f35,0x3f6d3ec4,0x3f353f35,0x3f0ebf55,0xbf6dbec4,0xbe483f7b
.long 0x80003f80,0x3f80a554,0xa50dbf80,0xbf80248d,0xbf353f35,0x3f0e3f55,0x3f6dbec4,0xbe48bf7b
.long 0xbf80248d,0xbec43f6d,0x3f353f35,0x3f6dbec4,0xbf35bf35,0xbf7b3e48,0xbec43f6d,0x3f0e3f55
.long 0xa50dbf80,0xbf35bf35,0xbf80248d,0xbf353f35,0x3f35bf35,0x3e48bf7b,0xbec4bf6d,0xbf55bf0e
.long 0x3f80a554,0x3f6dbec4,0x3f35bf35,0x3ec4bf6d,0x3f353f35,0x3f553f0e,0x3f6d3ec4,0x3f7b3e48
.long 0x80003f80,0xa50dbf80,0x80003f80,0xa50dbf80,0xbf80248d,0x3f7b3e48,0xbf6dbec4,0x3f553f0e
.long 0xa50dbf80,0xbec43f6d,0x3f35bf35,0xbf6d3ec4,0x3f80a554,0xbf55bf0e,0x3ec43f6d,0x3e48bf7b
.long 0x80003f80,0x3f35bf35,0xbf80248d,0x3f353f35,0xbf80248d,0x3f0e3f55,0x3ec4bf6d,0xbf7b3e48
.long 0xa50dbf80,0xbf6d3ec4,0x3f353f35,0x3ec4bf6d,0x3f80a554,0xbe48bf7b,0xbf6d3ec4,0x3f0e3f55
.long 0x80003f80,0x3f80a554,0xa50dbf80,0xbf80248d,0xbf80248d,0xbe483f7b,0x3f6d3ec4,0x3f0ebf55
.long 0xa50dbf80,0xbf6dbec4,0xbf353f35,0x3ec43f6d,0x3f80a554,0x3f0ebf55,0xbec4bf6d,0xbf7bbe48
.long 0x80003f80,0x3f353f35,0x3f80a554,0x3f35bf35,0xbf80248d,0xbf553f0e,0xbec43f6d,0x3e483f7b
.long 0xa50dbf80,0xbec4bf6d,0xbf35bf35,0xbf6dbec4,0x3f80a554,0x3f7bbe48,0x3f6dbec4,0x3f55bf0e
.long 0x80003f80,0xa50dbf80,0x80003f80,0xa50dbf80,0xbf35bf35,0x3f0e3f55,0xbec4bf6d,0x3e483f7b
.long 0x3f80a554,0xbf6dbec4,0x3f353f35,0xbec4bf6d,0xbf353f35,0x3f7bbe48,0xbf6dbec4,0x3f0e3f55
.long 0xa50dbf80,0xbf353f35,0x3f80a554,0xbf35bf35,0x3f353f35,0x3e48bf7b,0xbf6d3ec4,0x3f553f0e
.long 0xbf80248d,0x3ec43f6d,0x3f35bf35,0xbf6dbec4,0x3f35bf35,0xbf55bf0e,0xbec43f6d,0x3f7b3e48
.long 0x80003f80,0x3f80a554,0xa50dbf80,0xbf80248d,0xbf35bf35,0xbf553f0e,0x3ec43f6d,0x3f7bbe48
.long 0x3f80a554,0x3ec4bf6d,0xbf35bf35,0xbf6d3ec4,0xbf353f35,0x3e483f7b,0x3f6d3ec4,0x3f55bf0e
.long 0xa50dbf80,0xbf35bf35,0xbf80248d,0xbf353f35,0x3f353f35,0x3f7b3e48,0x3f6dbec4,0x3f0ebf55
.long 0xbf80248d,0xbf6d3ec4,0xbf353f35,0xbec43f6d,0x3f35bf35,0x3f0ebf55,0x3ec4bf6d,0x3e48bf7b
.long 0x3f800000,0xbf80250d,0x3f800000,0xbf80250d,0x3f800000,0xbf7bbe48,0x3f6d3ec4,0xbf55bf0e
.long 0x3f800000,0xbf6dbec4,0x3f353f35,0xbec4bf6d,0x3f800000,0xbf55bf0e,0x3ec43f6d,0x3e48bf7b
.long 0x3f800000,0xbf35bf35,0x248d3f80,0x3f35bf35,0x3f800000,0xbf0ebf55,0xbec43f6d,0x3f7bbe48
.long 0x3f800000,0xbec4bf6d,0xbf353f35,0x3f6d3ec4,0x3f800000,0xbe48bf7b,0xbf6d3ec4,0x3f0e3f55
.long 0x3f800000,0xa554bf80,0xbf80250d,0x248d3f80,0x3f800000,0x3e48bf7b,0xbf6dbec4,0xbf0e3f55
.long 0x3f800000,0x3ec4bf6d,0xbf35bf35,0xbf6d3ec4,0x3f800000,0x3f0ebf55,0xbec4bf6d,0xbf7bbe48
.long 0x3f800000,0x3f35bf35,0xa554bf80,0xbf35bf35,0x3f800000,0x3f55bf0e,0x3ec4bf6d,0xbe48bf7b
.long 0x3f800000,0x3f6dbec4,0x3f35bf35,0x3ec4bf6d,0x3f800000,0x3f7bbe48,0x3f6dbec4,0x3f55bf0e
.long 0x3f800000,0xbf80250d,0x3f800000,0xbf80250d,0x3f353f35,0xbf0ebf55,0x3ec43f6d,0xbe48bf7b
.long 0x248d3f80,0x3ec4bf6d,0xbf353f35,0x3f6dbec4,0xbf353f35,0x3f7bbe48,0xbf6dbec4,0x3f0e3f55
.long 0xbf80250d,0x3f353f35,0xa554bf80,0xbf353f35,0xbf35bf35,0xbe483f7b,0x3f6dbec4,0xbf55bf0e
.long 0xa554bf80,0xbf6d3ec4,0x3f353f35,0x3ec4bf6d,0x3f35bf35,0xbf55bf0e,0xbec43f6d,0x3f7b3e48
.long 0x3f800000,0xa554bf80,0xbf80250d,0x248d3f80,0x3f353f35,0x3f55bf0e,0xbec4bf6d,0xbf7b3e48
.long 0x248d3f80,0x3f6d3ec4,0x3f35bf35,0xbec4bf6d,0xbf353f35,0x3e483f7b,0x3f6d3ec4,0x3f55bf0e
.long 0xbf80250d,0xbf353f35,0x248d3f80,0x3f353f35,0xbf35bf35,0xbf7bbe48,0xbf6d3ec4,0xbf0e3f55
.long 0xa554bf80,0xbec4bf6d,0xbf35bf35,0xbf6dbec4,0x3f35bf35,0x3f0ebf55,0x3ec4bf6d,0x3e48bf7b
.long 0x3f800000,0xbf80250d,0x3f800000,0xbf80250d,0x248d3f80,0x3e48bf7b,0xbec43f6d,0x3f0ebf55
.long 0xbf80250d,0x3f6d3ec4,0xbf35bf35,0x3ec43f6d,0xa554bf80,0xbf0e3f55,0x3f6dbec4,0xbf7bbe48
.long 0x3f800000,0xbf35bf35,0x248d3f80,0x3f35bf35,0x248d3f80,0x3f55bf0e,0xbf6dbec4,0x3e483f7b
.long 0xbf80250d,0x3ec43f6d,0x3f35bf35,0xbf6dbec4,0xa554bf80,0xbf7b3e48,0x3ec43f6d,0x3f55bf0e
.long 0x3f800000,0xa554bf80,0xbf80250d,0x248d3f80,0x248d3f80,0x3f7b3e48,0x3ec4bf6d,0xbf55bf0e
.long 0xbf80250d,0xbec43f6d,0x3f353f35,0x3f6dbec4,0xa554bf80,0xbf55bf0e,0xbf6d3ec4,0xbe483f7b
.long 0x3f800000,0x3f35bf35,0xa554bf80,0xbf35bf35,0x248d3f80,0x3f0e3f55,0x3f6d3ec4,0x3f7bbe48
.long 0xbf80250d,0xbf6d3ec4,0xbf353f35,0xbec43f6d,0xa554bf80,0xbe48bf7b,0xbec4bf6d,0xbf0ebf55
.long 0x3f800000,0xbf80250d,0x3f800000,0xbf80250d,0xbf353f35,0x3f55bf0e,0xbf6d3ec4,0x3f7bbe48
.long 0xa554bf80,0xbec43f6d,0x3f35bf35,0xbf6d3ec4,0x3f353f35,0xbe48bf7b,0xbec43f6d,0x3f55bf0e
.long 0xbf80250d,0x3f353f35,0xa554bf80,0xbf353f35,0x3f35bf35,0xbf7bbe48,0x3ec43f6d,0x3f0ebf55
.long 0x248d3f80,0x3f6dbec4,0xbf35bf35,0xbec43f6d,0xbf35bf35,0xbf0e3f55,0x3f6d3ec4,0x3e48bf7b
.long 0x3f800000,0xa554bf80,0xbf80250d,0x248d3f80,0xbf353f35,0x3f0e3f55,0x3f6dbec4,0xbe48bf7b
.long 0xa554bf80,0xbf6dbec4,0xbf353f35,0x3ec43f6d,0x3f353f35,0x3f7bbe48,0x3ec4bf6d,0xbf0ebf55
.long 0xbf80250d,0xbf353f35,0x248d3f80,0x3f353f35,0x3f35bf35,0x3e48bf7b,0xbec4bf6d,0xbf55bf0e
.long 0x248d3f80,0x3ec43f6d,0x3f353f35,0x3f6d3ec4,0xbf35bf35,0xbf55bf0e,0xbf6dbec4,0xbf7bbe48
.long 0x3e124925,0x3e124925,0x3e124925,0x3e124925,0x3e124925,0x3e124576,0x3e123a69,0x3e122800
.long 0x3e124925,0x3e123a69,0x3e120e3a,0x3e11c4a1,0x3e124925,0x3e122800,0x3e11c4a1,0x3e111f35
.long 0x3e124925,0x3e120e3a,0x3e115dac,0x3e103806,0x3e124925,0x3e11ed1a,0x3e10d96f,0x3e0f0f7e
.long 0x3e124925,0x3e11c4a1,0x3e103806,0x3e0da623,0x3e124925,0x3e1194d1,0x3e0f7991,0x3e0bfc98
.long 0x3e124925,0x3e115dac,0x3e0e9e37,0x3e0a139f,0x3e124925,0x3e111f35,0x3e0da623,0x3e07ec15
.long 0x3e124925,0x3e10d96f,0x3e0c9188,0x3e0586f3,0x3e124925,0x3e108c5e,0x3e0b609d,0x3e02e551
.long 0x3e124925,0x3e103806,0x3e0a139f,0x3e00085e,0x3e124925,0x3e0fdc6b,0x3e08aad2,0x3df9e2ce
.long 0x3e124925,0x3e0f7991,0x3e07267f,0x3df343a6,0x3e124925,0x3e0f0f7e,0x3e0586f3,0x3dec3643
.long 0x3e124925,0x3e124925,0x3e124925,0x3e124925,0x3e120e3a,0x3e11ed1a,0x3e11c4a1,0x3e1194d1
.long 0x3e115dac,0x3e10d96f,0x3e103806,0x3e0f7991,0x3e103806,0x3e0f0f7e,0x3e0da623,0x3e0bfc98
.long 0x3e0e9e37,0x3e0c9188,0x3e0a139f,0x3e07267f,0x3e0c9188,0x3e0962ae,0x3e0586f3,0x3e010332
.long 0x3e0a139f,0x3e0586f3,0x3e00085e,0x3df343a6,0x3e07267f,0x3e010332,0x3df343a6,0x3de22928
.long 0x3e03cc83,0x3df7ba31,0x3de4bdd6,0x3dcee116,0x3e00085e,0x3dec3643,0x3dd4999d,0x3db99af8
.long 0x3df7ba31,0x3ddf8917,0x3dc2f437,0x3da28b42,0x3dee9c1c,0x3dd1c2a1,0x3dafed9f,0x3d89eacf
.long 0x3de4bdd6,0x3dc2f437,0x3d9ba84a,0x3d5fecab,0x3dda2752,0x3db3307b,0x3d8648f4,0x3d29dba6
.long 0x3dcee116,0x3da28b42,0x3d5fecab,0x3ce44fb9,0x3dc2f437,0x3d91197f,0x3d31b1bc,0x3c656a87
.long 0x3e124925,0x3e124925,0x3e124925,0x3e124925,0x3e115dac,0x3e111f35,0x3e10d96f,0x3e108c5e
.long 0x3e0e9e37,0x3e0da623,0x3e0c9188,0x3e0b609d,0x3e0a139f,0x3e07ec15,0x3e0586f3,0x3e02e551
.long 0x3e03cc83,0x3e00085e,0x3df7ba31,0x3dee9c1c,0x3df7ba31,0x3dec3643,0x3ddf8917,0x3dd1c2a1
.long 0x3de4bdd6,0x3dd4999d,0x3dc2f437,0x3dafed9f,0x3dcee116,0x3db99af8,0x3da28b42,0x3d89eacf
.long 0x3db66a51,0x3d9ba84a,0x3d7de24c,0x3d4142ac,0x3d9ba84a,0x3d767721,0x3d31b1bc,0x3cd43110
.long 0x3d7de24c,0x3d31b1bc,0x3cc407b7,0x3b8349dd,0x3d4142ac,0x3cd43110,0x3b8349dd,0xbc9353b8
.long 0x3d0234df,0x3c033ca5,0xbc8307ca,0xbd21fd03,0x3c8307ca,0xbc23ff69,0xbd1227a9,0xbd767721
.long 0x23215ccb,0xbce44fb9,0xbd5fecab,0xbda28b42,0xbc8307ca,0xbd397ee0,0xbd94a5f9,0xbdc5fe8a
.long 0x3e124925,0x3e124925,0x3d924925,0x3d924925,0x3e103806,0x3e0fdc6b,0xbd924925,0x3d924925
.long 0x3e0a139f,0x3e08aad2,0x3d924925,0x3d924925,0x3e00085e,0x3df9e2ce,0xbd924925,0x3d924925
.long 0x3de4bdd6,0x3dda2752,0x3d924925,0x3d924925,0x3dc2f437,0x3db3307b,0xbd924925,0x3d924925
.long 0x3d9ba84a,0x3d8648f4,0x3d924925,0x3d924925,0x3d5fecab,0x3d29dba6,0xbd924925,0x3d924925
.long 0x3d0234df,0x3c8307ca,0x3d924925,0x3d924925,0x3c033ca5,0xbc23ff69,0xbd924925,0x3d924925
.long 0xbc8307ca,0xbd1227a9,0x3d924925,0x3d924925,0xbd21fd03,0xbd767721,0xbd924925,0x3d924925
.long 0xbd7de24c,0xbda94d7d,0x3d924925,0x3d924925,0xbda94d7d,0xbdd1c2a1,0xbd924925,0x3d924925
.long 0xbdcee116,0xbdf343a6,0x3d924925,0x3d924925,0xbdee9c1c,0xbe065a1b,0xbd924925,0x3d924925
.long 0x3e124925,0x3e0e9e37,0x3e03cc83,0x3de4bdd6,0x3e124925,0x3e0e25c1,0x3e01f787,0x3ddcddc4
.long 0x3e124925,0x3e0da623,0x3e00085e,0x3dd4999d,0x3e124925,0x3e0d1f63,0x3dfbfed7,0x3dcbf520
.long 0x3e124925,0x3e0c9188,0x3df7ba31,0x3dc2f437,0x3e124925,0x3e0bfc98,0x3df343a6,0x3db99af8
.long 0x3e124925,0x3e0b609d,0x3dee9c1c,0x3dafed9f,0x3e124925,0x3e0abd9c,0x3de9c484,0x3da5f08d
.long 0x3e124925,0x3e0a139f,0x3de4bdd6,0x3d9ba84a,0x3e124925,0x3e0962ae,0x3ddf8917,0x3d91197f
.long 0x3e124925,0x3e08aad2,0x3dda2752,0x3d8648f4,0x3e124925,0x3e07ec15,0x3dd4999d,0x3d767721
.long 0x3e124925,0x3e07267f,0x3dcee116,0x3d5fecab,0x3e124925,0x3e065a1b,0x3dc8fee4,0x3d48fcbd
.long 0x3e124925,0x3e0586f3,0x3dc2f437,0x3d31b1bc,0x3e124925,0x3e04ad12,0x3dbcc247,0x3d1a1637
.long 0x3db66a51,0x3d7de24c,0x3d0234df,0x23215ccb,0x3da94d7d,0x3d58521f,0x3ca3983a,0xbc656a87
.long 0x3d9ba84a,0x3d31b1bc,0x3c033ca5,0xbce44fb9,0x3d8d85b7,0x3d0a31bf,0xbb8349dd,0xbd29dba6
.long 0x3d7de24c,0x3cc407b7,0xbc8307ca,0xbd5fecab,0x3d5fecab,0x3c656a87,0xbce44fb9,0xbd89eacf
.long 0x3d4142ac,0x3b8349dd,0xbd21fd03,0xbda28b42,0x3d21fd03,0xbbc4e688,0xbd50acaf,0xbdb99af8
.long 0x3d0234df,0xbc8307ca,0xbd7de24c,0xbdcee116,0x3cc407b7,0xbcd43110,0xbd94a5f9,0xbde22928
.long 0x3c8307ca,0xbd1227a9,0xbda94d7d,0xbdf343a6,0x3c033ca5,0xbd397ee0,0xbdbcc247,0xbe010332
.long 0x23215ccb,0xbd5fecab,0xbdcee116,0xbe07267f,0xbc033ca5,0xbd82a057,0xbddf8917,0xbe0bfc98
.long 0xbc8307ca,0xbd94a5f9,0xbdee9c1c,0xbe0f7991,0xbcc407b7,0xbda5f08d,0xbdfbfed7,0xbe1194d1
.long 0xbd0234df,0xbd7de24c,0xbdb66a51,0xbde4bdd6,0xbd4142ac,0xbd9f1dc8,0xbdd4999d,0xbdfe0e2f
.long 0xbd7de24c,0xbdbcc247,0xbdee9c1c,0xbe08aad2,0xbd9ba84a,0xbdd765e4,0xbe01f787,0xbe0f0f7e
.long 0xbdb66a51,0xbdee9c1c,0xbe0a139f,0xbe120e3a,0xbdcee116,0xbe010332,0xbe0f7991,0xbe1194d1
.long 0xbde4bdd6,0xbe08aad2,0xbe120e3a,0xbe0da623,0xbdf7ba31,0xbe0e25c1,0xbe11c4a1,0xbe065a1b
.long 0xbe03cc83,0xbe115dac,0xbe0e9e37,0xbdf7ba31,0xbe0a139f,0xbe124576,0xbe08aad2,0xbddcddc4
.long 0xbe0e9e37,0xbe10d96f,0xbe00085e,0xbdbcc247,0xbe115dac,0xbe0d1f63,0xbde9c484,0xbd982af6
.long 0xbe124925,0xbe07267f,0xbdcee116,0xbd5fecab,0xbe115dac,0xbdfe0e2f,0xbdafed9f,0xbd0a31bf
.long 0xbe0e9e37,0xbde9c484,0xbd8d85b7,0xbc44b9ec,0xbe0a139f,0xbdd1c2a1,0xbd50acaf,0x3c23ff69
.long 0xbe03cc83,0xbe0e9e37,0x3d924925,0x3d924925,0xbe0c9188,0xbe122800,0xbd924925,0x3d924925
.long 0xbe115dac,0xbe10d96f,0x3d924925,0x3d924925,0xbe120e3a,0xbe0abd9c,0xbd924925,0x3d924925
.long 0xbe0e9e37,0xbe00085e,0x3d924925,0x3d924925,0xbe07267f,0xbde22928,0xbd924925,0x3d924925
.long 0xbdf7ba31,0xbdbcc247,0x3d924925,0x3d924925,0xbdda2752,0xbd91197f,0xbd924925,0x3d924925
.long 0xbdb66a51,0xbd4142ac,0x3d924925,0x3d924925,0xbd8d85b7,0xbcb3d480,0xbd924925,0x3d924925
.long 0xbd4142ac,0x3b8349dd,0x3d924925,0x3d924925,0xbcc407b7,0x3cf462e3,0xbd924925,0x3d924925
.long 0xa3f20b30,0x3d5fecab,0x3d924925,0x3d924925,0x3cc407b7,0x3d9f1dc8,0xbd924925,0x3d924925
.long 0x3d4142ac,0x3dc8fee4,0x3d924925,0x3d924925,0x3d8d85b7,0x3dec3643,0xbd924925,0x3d924925
.long 0x0,0x0,0x0,0x0,0x0,0x3b034d2c,0x3b8349dd,0x3bc4e688
.long 0x0,0x3b8349dd,0x3c033ca5,0x3c44b9ec,0x0,0x3bc4e688,0x3c44b9ec,0x3c9353b8
.long 0x0,0x3c033ca5,0x3c8307ca,0x3cc407b7,0x0,0x3c23ff69,0x3ca3983a,0x3cf462e3
.long 0x0,0x3c44b9ec,0x3cc407b7,0x3d1227a9,0x0,0x3c656a87,0x3ce44fb9,0x3d29dba6
.long 0x0,0x3c8307ca,0x3d0234df,0x3d4142ac,0x0,0x3c9353b8,0x3d1227a9,0x3d58521f
.long 0x0,0x3ca3983a,0x3d21fd03,0x3d6eff8d,0x0,0x3cb3d480,0x3d31b1bc,0x3d82a057
.long 0x0,0x3cc407b7,0x3d4142ac,0x3d8d85b7,0x0,0x3cd43110,0x3d50acaf,0x3d982af6
.long 0x0,0x3ce44fb9,0x3d5fecab,0x3da28b42,0x0,0x3cf462e3,0x3d6eff8d,0x3daca1e6
.long 0x0,0x0,0x0,0x0,0x3c033ca5,0x3c23ff69,0x3c44b9ec,0x3c656a87
.long 0x3c8307ca,0x3ca3983a,0x3cc407b7,0x3ce44fb9,0x3cc407b7,0x3cf462e3,0x3d1227a9,0x3d29dba6
.long 0x3d0234df,0x3d21fd03,0x3d4142ac,0x3d5fecab,0x3d21fd03,0x3d48fcbd,0x3d6eff8d,0x3d89eacf
.long 0x3d4142ac,0x3d6eff8d,0x3d8d85b7,0x3da28b42,0x3d5fecab,0x3d89eacf,0x3da28b42,0x3db99af8
.long 0x3d7de24c,0x3d9ba84a,0x3db66a51,0x3dcee116,0x3d8d85b7,0x3daca1e6,0x3dc8fee4,0x3de22928
.long 0x3d9ba84a,0x3dbcc247,0x3dda2752,0x3df343a6,0x3da94d7d,0x3dcbf520,0x3de9c484,0x3e010332
.long 0x3db66a51,0x3dda2752,0x3df7ba31,0x3e07267f,0x3dc2f437,0x3de74700,0x3e01f787,0x3e0bfc98
.long 0x3dcee116,0x3df343a6,0x3e07267f,0x3e0f7991,0x3dda2752,0x3dfe0e2f,0x3e0b609d,0x3e1194d1
.long 0x0,0x0,0x0,0x0,0x3c8307ca,0x3c9353b8,0x3ca3983a,0x3cb3d480
.long 0x3d0234df,0x3d1227a9,0x3d21fd03,0x3d31b1bc,0x3d4142ac,0x3d58521f,0x3d6eff8d,0x3d82a057
.long 0x3d7de24c,0x3d8d85b7,0x3d9ba84a,0x3da94d7d,0x3d9ba84a,0x3daca1e6,0x3dbcc247,0x3dcbf520
.long 0x3db66a51,0x3dc8fee4,0x3dda2752,0x3de9c484,0x3dcee116,0x3de22928,0x3df343a6,0x3e010332
.long 0x3de4bdd6,0x3df7ba31,0x3e03cc83,0x3e0a139f,0x3df7ba31,0x3e04ad12,0x3e0b609d,0x3e0fdc6b
.long 0x3e03cc83,0x3e0b609d,0x3e103806,0x3e123a69,0x3e0a139f,0x3e0fdc6b,0x3e123a69,0x3e111f35
.long 0x3e0e9e37,0x3e120e3a,0x3e115dac,0x3e0c9188,0x3e115dac,0x3e11ed1a,0x3e0da623,0x3e04ad12
.long 0x3e124925,0x3e0f7991,0x3e07267f,0x3df343a6,0x3e115dac,0x3e0abd9c,0x3dfbfed7,0x3dd765e4
.long 0x0,0x0,0x0,0x0,0x3cc407b7,0x3cd43110,0x23215ccb,0x0
.long 0x3d4142ac,0x3d50acaf,0x0,0x0,0x3d8d85b7,0x3d982af6,0x23215ccb,0x0
.long 0x3db66a51,0x3dc2f437,0x0,0x0,0x3dda2752,0x3de74700,0x23215ccb,0x0
.long 0x3df7ba31,0x3e01f787,0x0,0x0,0x3e07267f,0x3e0bfc98,0x23215ccb,0x0
.long 0x3e0e9e37,0x3e115dac,0x0,0x0,0x3e120e3a,0x3e11ed1a,0x23215ccb,0x0
.long 0x3e115dac,0x3e0da623,0x0,0x0,0x3e0c9188,0x3e04ad12,0x23215ccb,0x0
.long 0x3e03cc83,0x3dee9c1c,0x0,0x0,0x3dee9c1c,0x3dcbf520,0x23215ccb,0x0
.long 0x3dcee116,0x3da28b42,0x0,0x0,0x3da94d7d,0x3d677bf0,0x23215ccb,0x0
.long 0x0,0x3d0234df,0x3d7de24c,0x3db66a51,0x0,0x3d0a31bf,0x3d8648f4,0x3dbfe014
.long 0x0,0x3d1227a9,0x3d8d85b7,0x3dc8fee4,0x0,0x3d1a1637,0x3d94a5f9,0x3dd1c2a1
.long 0x0,0x3d21fd03,0x3d9ba84a,0x3dda2752,0x0,0x3d29dba6,0x3da28b42,0x3de22928
.long 0x0,0x3d31b1bc,0x3da94d7d,0x3de9c484,0x0,0x3d397ee0,0x3dafed9f,0x3df0f5f2
.long 0x0,0x3d4142ac,0x3db66a51,0x3df7ba31,0x0,0x3d48fcbd,0x3dbcc247,0x3dfe0e2f
.long 0x0,0x3d50acaf,0x3dc2f437,0x3e01f787,0x0,0x3d58521f,0x3dc8fee4,0x3e04ad12
.long 0x0,0x3d5fecab,0x3dcee116,0x3e07267f,0x0,0x3d677bf0,0x3dd4999d,0x3e0962ae
.long 0x0,0x3d6eff8d,0x3dda2752,0x3e0b609d,0x0,0x3d767721,0x3ddf8917,0x3e0d1f63
.long 0x3de4bdd6,0x3e03cc83,0x3e0e9e37,0x3e124925,0x3dee9c1c,0x3e07ec15,0x3e10d96f,0x3e1194d1
.long 0x3df7ba31,0x3e0b609d,0x3e120e3a,0x3e0f7991,0x3e00085e,0x3e0e25c1,0x3e123a69,0x3e0bfc98
.long 0x3e03cc83,0x3e103806,0x3e115dac,0x3e07267f,0x3e07267f,0x3e1194d1,0x3e0f7991,0x3e010332
.long 0x3e0a139f,0x3e123a69,0x3e0c9188,0x3df343a6,0x3e0c9188,0x3e122800,0x3e08aad2,0x3de22928
.long 0x3e0e9e37,0x3e115dac,0x3e03cc83,0x3dcee116,0x3e103806,0x3e0fdc6b,0x3dfbfed7,0x3db99af8
.long 0x3e115dac,0x3e0da623,0x3dee9c1c,0x3da28b42,0x3e120e3a,0x3e0abd9c,0x3ddf8917,0x3d89eacf
.long 0x3e124925,0x3e07267f,0x3dcee116,0x3d5fecab,0x3e120e3a,0x3e02e551,0x3dbcc247,0x3d29dba6
.long 0x3e115dac,0x3dfbfed7,0x3da94d7d,0x3ce44fb9,0x3e103806,0x3df0f5f2,0x3d94a5f9,0x3c656a87
.long 0x3e0e9e37,0x3e03cc83,0x3de4bdd6,0x3db66a51,0x3e0a139f,0x3df5851a,0x3dc8fee4,0x3d91197f
.long 0x3e03cc83,0x3ddf8917,0x3da94d7d,0x3d50acaf,0x3df7ba31,0x3dc5fe8a,0x3d8648f4,0x3cf462e3
.long 0x3de4bdd6,0x3da94d7d,0x3d4142ac,0x3c033ca5,0x3dcee116,0x3d89eacf,0x3ce44fb9,0xbc656a87
.long 0x3db66a51,0x3d50acaf,0x3c033ca5,0xbd1227a9,0x3d9ba84a,0x3d0a31bf,0xbc44b9ec,0xbd677bf0
.long 0x3d7de24c,0x3c8307ca,0xbd0234df,0xbd9ba84a,0x3d4142ac,0xbb034d2c,0xbd50acaf,0xbdbfe014
.long 0x3d0234df,0xbca3983a,0xbd8d85b7,0xbddf8917,0x3c8307ca,0xbd1a1637,0xbdafed9f,0xbdf9e2ce
.long 0x23a15ccb,0xbd5fecab,0xbdcee116,0xbe07267f,0xbc8307ca,0xbd91197f,0xbde9c484,0xbe0e25c1
.long 0xbd0234df,0xbdafed9f,0xbe00085e,0xbe11c4a1,0xbd4142ac,0xbdcbf520,0xbe08aad2,0xbe11ed1a
.long 0x3d7de24c,0x3d0234df,0x0,0x0,0x3d21fd03,0x3bc4e688,0x23215ccb,0x0
.long 0x3c8307ca,0xbca3983a,0x0,0x0,0xbc033ca5,0xbd397ee0,0x23215ccb,0x0
.long 0xbd0234df,0xbd8d85b7,0x0,0x0,0xbd5fecab,0xbdb99af8,0x23215ccb,0x0
.long 0xbd9ba84a,0xbddf8917,0x0,0x0,0xbdc2f437,0xbdfe0e2f,0x23215ccb,0x0
.long 0xbde4bdd6,0xbe0a139f,0x0,0x0,0xbe00085e,0xbe108c5e,0x23215ccb,0x0
.long 0xbe0a139f,0xbe123a69,0x0,0x0,0xbe103806,0xbe0f0f7e,0x23215ccb,0x0
.long 0xbe124925,0xbe07267f,0x0,0x0,0xbe103806,0xbdf5851a,0x23215ccb,0x0
.long 0xbe0a139f,0xbdd4999d,0x0,0x0,0xbe00085e,0xbdaca1e6,0x23215ccb,0x0
.long 0x80003f80,0x80003f80,0x80003f80,0x80003f80,0x80003f80,0xbede3f67,0xbf483f20,0xbf7a3e64
.long 0x80003f80,0xbf483f20,0xbf7abe64,0xbedebf67,0x80003f80,0xbf7a3e64,0xbedebf67,0x3f48bf20
.long 0x80003f80,0xbf7abe64,0x3edebf67,0x3f483f20,0x80003f80,0xbf48bf20,0x3f7abe64,0xbede3f67
.long 0x80003f80,0xbedebf67,0x3f483f20,0xbf7abe64,0x80003f80,0xa50dbf80,0x80003f80,0xa50dbf80
.long 0x80003f80,0x3edebf67,0xbf483f20,0x3f7abe64,0x80003f80,0x3f48bf20,0xbf7abe64,0x3ede3f67
.long 0x80003f80,0x3f7abe64,0xbedebf67,0xbf483f20,0x80003f80,0x3f7a3e64,0x3edebf67,0xbf48bf20
.long 0x80003f80,0x3f483f20,0x3f7abe64,0x3edebf67,0x80003f80,0x3ede3f67,0x3f483f20,0x3f7a3e64
.long 0x0,0x0,0x0,0x0,0x0,0x0,0x0,0x0
.long 0x80003f80,0x80003f80,0x80003f80,0x80003f80,0xbf7abe64,0xbf48bf20,0xbedebf67,0xa50dbf80
.long 0x3edebf67,0x3f7abe64,0x3f483f20,0x80003f80,0x3f483f20,0xbede3f67,0xbf7abe64,0xa50dbf80
.long 0xbf483f20,0xbedebf67,0x3f7abe64,0x80003f80,0xbedebf67,0x3f7a3e64,0xbf483f20,0xa50dbf80
.long 0x3f7abe64,0xbf483f20,0x3edebf67,0x80003f80,0x80003f80,0xa50dbf80,0x80003f80,0xa50dbf80
.long 0xbf7abe64,0x3f483f20,0xbedebf67,0x80003f80,0x3edebf67,0xbf7a3e64,0x3f483f20,0xa50dbf80
.long 0x3f483f20,0x3edebf67,0xbf7abe64,0x80003f80,0xbf483f20,0x3ede3f67,0x3f7abe64,0xa50dbf80
.long 0xbedebf67,0xbf7abe64,0xbf483f20,0x80003f80,0x3f7abe64,0x3f48bf20,0x3edebf67,0xa50dbf80
.long 0x0,0x0,0x0,0x0,0x0,0x0,0x0,0x0
.long 0x80003f80,0x80003f80,0x80003f80,0x80003f80,0x3edebf67,0x3f48bf20,0x3f7abe64,0x3f7a3e64
.long 0xbf483f20,0xbf7abe64,0xbedebf67,0x3edebf67,0x3f7abe64,0x3ede3f67,0xbf483f20,0xbf48bf20
.long 0xbf7abe64,0x3edebf67,0x3f483f20,0xbf483f20,0x3f483f20,0xbf7a3e64,0x3edebf67,0x3ede3f67
.long 0xbedebf67,0x3f483f20,0xbf7abe64,0x3f7abe64,0x80003f80,0xa50dbf80,0x80003f80,0xa50dbf80
.long 0x3edebf67,0xbf483f20,0x3f7abe64,0xbf7abe64,0xbf483f20,0x3f7a3e64,0xbedebf67,0xbede3f67
.long 0x3f7abe64,0xbedebf67,0xbf483f20,0x3f483f20,0xbf7abe64,0xbede3f67,0x3f483f20,0x3f48bf20
.long 0x3f483f20,0x3f7abe64,0x3edebf67,0xbedebf67,0xbedebf67,0xbf48bf20,0xbf7abe64,0xbf7a3e64
.long 0x0,0x0,0x0,0x0,0x0,0x0,0x0,0x0
.long 0x80003f80,0x80003f80,0x80003f80,0x80003f80,0x3f483f20,0x3ede3f67,0x80003f80,0x80003f80
.long 0x3f7abe64,0x3f483f20,0x80003f80,0x80003f80,0x3edebf67,0x3f7a3e64,0x80003f80,0x80003f80
.long 0xbedebf67,0x3f7abe64,0x80003f80,0x80003f80,0xbf7abe64,0x3f48bf20,0x80003f80,0x80003f80
.long 0xbf483f20,0x3edebf67,0x80003f80,0x80003f80,0x80003f80,0xa50dbf80,0x80003f80,0x80003f80
.long 0x3f483f20,0xbedebf67,0x80003f80,0x80003f80,0x3f7abe64,0xbf48bf20,0x80003f80,0x80003f80
.long 0x3edebf67,0xbf7abe64,0x80003f80,0x80003f80,0xbedebf67,0xbf7a3e64,0x80003f80,0x80003f80
.long 0xbf7abe64,0xbf483f20,0x80003f80,0x80003f80,0xbf483f20,0xbede3f67,0x80003f80,0x80003f80
.long 0x0,0x0,0x0,0x0,0x0,0x0,0x0,0x0
.long 0xc0135761,0xbdd2d3e8,0x0,0x0,0xc0135761,0xbdd2d3e8,0x8,0xffffffff
.long 0xc0135761,0xbdd2d3e8,0x10,0xffffffff,0xc0135761,0xbdd2d3e8,0x18,0xffffffff
.long 0xc0135761,0xbdd2d3e8,0x20,0xffffffff,0xc0135761,0xbdd2d3e8,0x28,0xffffffff
.long 0xc0135761,0xbdd2d3e8,0x30,0xffffffff,0xc0135761,0xbdd2d3e8,0x38,0xffffffff
.long 0xc0135761,0xbdd2d3e8,0x40,0xffffffff,0xc0135761,0xbdd2d3e8,0x48,0xffffffff
.long 0xc0135761,0xbdd2d3e8,0x50,0xffffffff,0xc0135761,0xbdd2d3e8,0x58,0xffffffff
.long 0xc0135761,0xbdd2d3e8,0x60,0xffffffff,0xc0135761,0xbdd2d3e8,0x68,0xffffffff
.long 0xc0135761,0xbdd2d3e8,0x700,0xffffffff,0xc0135761,0xbdd2d3e8,0x0,0xffffffff
.long 0xc0135761,0xbdd2d3e8,0x1c0,0xffffffff,0xc0135761,0xbdd2d3e8,0x1c8,0xffffffff
.long 0xc0135761,0xbdd2d3e8,0x1d0,0xffffffff,0xc0135761,0xbdd2d3e8,0x1d8,0xffffffff
.long 0xc0135761,0xbdd2d3e8,0x1e0,0xffffffff,0xc0135761,0xbdd2d3e8,0x1e8,0xffffffff
.long 0xc0135761,0xbdd2d3e8,0x1f0,0xffffffff,0xc0135761,0xbdd2d3e8,0x1f8,0xffffffff
.long 0xc0135761,0xbdd2d3e8,0x200,0xffffffff,0xc0135761,0xbdd2d3e8,0x208,0xffffffff
.long 0xc0135761,0xbdd2d3e8,0x210,0xffffffff,0xc0135761,0xbdd2d3e8,0x218,0xffffffff
.long 0xc0135761,0xbdd2d3e8,0x220,0xffffffff,0xc0135761,0xbdd2d3e8,0x228,0xffffffff
.long 0xc0135761,0xbdd2d3e8,0x710,0x0,0xc0135761,0xbdd2d3e8,0x710,0x0
.long 0xc0135761,0xbdd2d3e8,0x380,0xffffffff,0xc0135761,0xbdd2d3e8,0x388,0xffffffff
.long 0xc0135761,0xbdd2d3e8,0x390,0xffffffff,0xc0135761,0xbdd2d3e8,0x398,0xffffffff
.long 0xc0135761,0xbdd2d3e8,0x3a0,0xffffffff,0xc0135761,0xbdd2d3e8,0x3a8,0xffffffff
.long 0xc0135761,0xbdd2d3e8,0x3b0,0xffffffff,0xc0135761,0xbdd2d3e8,0x3b8,0xffffffff
.long 0xc0135761,0xbdd2d3e8,0x3c0,0xffffffff,0xc0135761,0xbdd2d3e8,0x3c8,0xffffffff
.long 0xc0135761,0xbdd2d3e8,0x3d0,0xffffffff,0xc0135761,0xbdd2d3e8,0x3d8,0xffffffff
.long 0xc0135761,0xbdd2d3e8,0x3e0,0xffffffff,0xc0135761,0xbdd2d3e8,0x3e8,0xffffffff
.long 0xc0135761,0xbdd2d3e8,0x710,0x0,0xc0135761,0xbdd2d3e8,0x710,0x0
.long 0xc0135761,0xbdd2d3e8,0x540,0xffffffff,0xc0135761,0xbdd2d3e8,0x548,0xffffffff
.long 0xc0135761,0xbdd2d3e8,0x550,0xffffffff,0xc0135761,0xbdd2d3e8,0x558,0xffffffff
.long 0xc0135761,0xbdd2d3e8,0x560,0xffffffff,0xc0135761,0xbdd2d3e8,0x568,0xffffffff
.long 0xc0135761,0xbdd2d3e8,0x570,0xffffffff,0xc0135761,0xbdd2d3e8,0x578,0xffffffff
.long 0xc0135761,0xbdd2d3e8,0x580,0xffffffff,0xc0135761,0xbdd2d3e8,0x588,0xffffffff
.long 0xc0135761,0xbdd2d3e8,0x590,0xffffffff,0xc0135761,0xbdd2d3e8,0x598,0xffffffff
.long 0xc0135761,0xbdd2d3e8,0x5a0,0xffffffff,0xc0135761,0xbdd2d3e8,0x5a8,0xffffffff
.long 0xc0135761,0xbdd2d3e8,0x710,0x0,0xc0135761,0xbdd2d3e8,0x710,0x0
.long 0xffffffff,0x0,0x0,0x40,0xffffffff,0x10,0x8,0x48
.long 0xffffffff,0x20,0x10,0x50,0xffffffff,0x30,0x18,0x58
.long 0xffffffff,0x40,0x80,0xc0,0xffffffff,0x50,0x88,0xc8
.long 0xffffffff,0x60,0x90,0xd0,0xffffffff,0x70,0x98,0xd8
.long 0xffffffff,0x80,0x140,0x100,0xffffffff,0x90,0x148,0x108
.long 0xffffffff,0xa0,0x150,0x110,0xffffffff,0xb0,0x158,0x118
.long 0xffffffff,0xc0,0x1c0,0x180,0xffffffff,0xd0,0x1c8,0x188
.long 0x0,0xe0,0x1d0,0x190,0x0,0xf0,0x1d8,0x198
.long 0xffffffff,0x100,0x20,0x60,0xffffffff,0x110,0x28,0x68
.long 0xffffffff,0x120,0x30,0x70,0xffffffff,0x130,0x38,0x78
.long 0xffffffff,0x140,0xa0,0xe0,0xffffffff,0x150,0xa8,0xe8
.long 0xffffffff,0x160,0xb0,0xf0,0xffffffff,0x170,0xb8,0xf8
.long 0xffffffff,0x180,0x160,0x120,0xffffffff,0x190,0x168,0x128
.long 0xffffffff,0x1a0,0x170,0x130,0xffffffff,0x1b0,0x178,0x138
.long 0xffffffff,0x1c0,0x1e0,0x1a0,0xffffffff,0x1d0,0x1e8,0x1a8
.long 0x0,0x1e0,0x1f0,0x1b0,0x0,0x1f0,0x1f8,0x1b8
.long 0xffffffff,0x1c00,0x400,0x440,0xffffffff,0x1c10,0x408,0x448
.long 0xffffffff,0x1c20,0x410,0x450,0xffffffff,0x1c30,0x418,0x458
.long 0xffffffff,0x1c40,0x480,0x4c0,0xffffffff,0x1c50,0x488,0x4c8
.long 0xffffffff,0x1c60,0x490,0x4d0,0xffffffff,0x1c70,0x498,0x4d8
.long 0xffffffff,0x1c80,0x540,0x500,0xffffffff,0x1c90,0x548,0x508
.long 0xffffffff,0x1ca0,0x550,0x510,0xffffffff,0x1cb0,0x558,0x518
.long 0xffffffff,0x1cc0,0x5c0,0x580,0xffffffff,0x1cd0,0x5c8,0x588
.long 0x0,0x1ce0,0x5d0,0x590,0x0,0x1cf0,0x5d8,0x598
.long 0xffffffff,0x1d00,0x420,0x460,0xffffffff,0x1d10,0x428,0x468
.long 0xffffffff,0x1d20,0x430,0x470,0xffffffff,0x1d30,0x438,0x478
.long 0xffffffff,0x1d40,0x4a0,0x4e0,0xffffffff,0x1d50,0x4a8,0x4e8
.long 0xffffffff,0x1d60,0x4b0,0x4f0,0xffffffff,0x1d70,0x4b8,0x4f8
.long 0xffffffff,0x1d80,0x560,0x520,0xffffffff,0x1d90,0x568,0x528
.long 0xffffffff,0x1da0,0x570,0x530,0xffffffff,0x1db0,0x578,0x538
.long 0xffffffff,0x1dc0,0x5e0,0x5a0,0xffffffff,0x1dd0,0x5e8,0x5a8
.long 0x0,0x1de0,0x5f0,0x5b0,0x0,0x1df0,0x5f8,0x5b8
.long 0x0,0x0,0x0,0x0,0x10,0x10,0x2,0x0
.long 0x20,0x20,0x4,0x0,0x30,0x30,0x6,0x0
.long 0x40,0x40,0x8,0x0,0x50,0x50,0xa,0x0
.long 0x60,0x60,0xc,0x0,0x70,0x70,0xe,0x0
.long 0x0,0x80,0x10,0x0,0x10,0x90,0x12,0x0
.long 0x20,0xa0,0x14,0x0,0x30,0xb0,0x16,0x0
.long 0x40,0xc0,0x18,0x0,0x50,0xd0,0x1a,0x0
.long 0x60,0xe0,0x1c,0x0,0x70,0xf0,0x1e,0x0
.long 0x40,0x800,0x100,0x0,0x50,0x810,0x102,0x0
.long 0x60,0x820,0x104,0x0,0x70,0x830,0x106,0x0
.long 0x0,0x840,0x108,0x0,0x10,0x850,0x10a,0x0
.long 0x20,0x860,0x10c,0x0,0x30,0x870,0x10e,0x0
.long 0x40,0x880,0x110,0x0,0x50,0x890,0x112,0x0
.long 0x60,0x8a0,0x114,0x0,0x70,0x8b0,0x116,0x0
.long 0x0,0x8c0,0x118,0x0,0x10,0x8d0,0x11a,0x0
.long 0x20,0x8e0,0x11c,0x0,0x30,0x8f0,0x11e,0x0
.long 0x0,0x1000,0x200,0x0,0x10,0x1010,0x202,0x0
.long 0x20,0x1020,0x204,0x0,0x30,0x1030,0x206,0x0
.long 0x40,0x1040,0x208,0x0,0x50,0x1050,0x20a,0x0
.long 0x60,0x1060,0x20c,0x0,0x70,0x1070,0x20e,0x0
.long 0x0,0x1080,0x210,0x0,0x10,0x1090,0x212,0x0
.long 0x20,0x10a0,0x214,0x0,0x30,0x10b0,0x216,0x0
.long 0x40,0x10c0,0x218,0x0,0x50,0x10d0,0x21a,0x0
.long 0x60,0x10e0,0x21c,0x0,0x70,0x10f0,0x21e,0x0
.long 0x40,0x1800,0x300,0x0,0x50,0x1810,0x302,0x0
.long 0x60,0x1820,0x304,0x0,0x70,0x1830,0x306,0x0
.long 0x0,0x1840,0x308,0x0,0x10,0x1850,0x30a,0x0
.long 0x20,0x1860,0x30c,0x0,0x30,0x1870,0x30e,0x0
.long 0x40,0x1880,0x310,0x0,0x50,0x1890,0x312,0x0
.long 0x60,0x18a0,0x314,0x0,0x70,0x18b0,0x316,0x0
.long 0x0,0x18c0,0x318,0x0,0x10,0x18d0,0x31a,0x0
.long 0x20,0x18e0,0x31c,0x0,0x30,0x18f0,0x31e,0x0
.long 0x3f80,0x3f80,0x3f80,0x3f80,0x3f80,0x3ec43f6d,0x3f353f35,0x3f6d3ec4
.long 0x3f80,0x3f353f35,0x3f80248d,0x3f35bf35,0x3f80,0x3f6d3ec4,0x3f35bf35,0xbec4bf6d
.long 0x3f80,0x3f80248d,0x250dbf80,0xbf80a554,0x3f80,0x3f6dbec4,0xbf35bf35,0xbec43f6d
.long 0x3f80,0x3f35bf35,0xbf80a554,0x3f353f35,0x3f80,0x3ec4bf6d,0xbf353f35,0x3f6dbec4
.long 0x3f80,0x250dbf80,0x3f80,0x250dbf80,0x3f80,0xbec4bf6d,0x3f353f35,0xbf6dbec4
.long 0x3f80,0xbf35bf35,0x3f80248d,0xbf353f35,0x3f80,0xbf6dbec4,0x3f35bf35,0x3ec43f6d
.long 0x3f80,0xbf80a554,0x250dbf80,0x3f80248d,0x3f80,0xbf6d3ec4,0xbf35bf35,0x3ec4bf6d
.long 0x3f80,0xbf353f35,0xbf80a554,0xbf35bf35,0x3f80,0xbec43f6d,0xbf353f35,0xbf6d3ec4
.long 0x3f80,0x3f80,0x3f80,0x3f80,0x3f80248d,0x3f6dbec4,0x3f35bf35,0x3ec4bf6d
.long 0x250dbf80,0xbf35bf35,0xbf80a554,0xbf353f35,0xbf80a554,0xbec43f6d,0x3f353f35,0x3f6dbec4
.long 0x3f80,0x3f80248d,0x250dbf80,0xbf80a554,0x3f80248d,0xbec4bf6d,0xbf353f35,0x3f6d3ec4
.long 0x250dbf80,0xbf353f35,0x3f80248d,0xbf35bf35,0xbf80a554,0x3f6d3ec4,0xbf35bf35,0x3ec43f6d
.long 0x3f80,0x250dbf80,0x3f80,0x250dbf80,0x3f80248d,0xbf6d3ec4,0x3f35bf35,0xbec43f6d
.long 0x250dbf80,0x3f353f35,0xbf80a554,0x3f35bf35,0xbf80a554,0x3ec4bf6d,0x3f353f35,0xbf6d3ec4
.long 0x3f80,0xbf80a554,0x250dbf80,0x3f80248d,0x3f80248d,0x3ec43f6d,0xbf353f35,0xbf6dbec4
.long 0x250dbf80,0x3f35bf35,0x3f80248d,0x3f353f35,0xbf80a554,0xbf6dbec4,0xbf35bf35,0xbec4bf6d
.long 0x3f80,0x3f80,0x3f80,0x3f80,0x250dbf80,0xbec4bf6d,0xbf35bf35,0xbf6dbec4
.long 0x3f80,0x3f353f35,0x3f80248d,0x3f35bf35,0x250dbf80,0xbf6dbec4,0xbf353f35,0x3ec43f6d
.long 0x3f80,0x3f80248d,0x250dbf80,0xbf80a554,0x250dbf80,0xbf6d3ec4,0x3f353f35,0x3ec4bf6d
.long 0x3f80,0x3f35bf35,0xbf80a554,0x3f353f35,0x250dbf80,0xbec43f6d,0x3f35bf35,0xbf6d3ec4
.long 0x3f80,0x250dbf80,0x3f80,0x250dbf80,0x250dbf80,0x3ec43f6d,0xbf35bf35,0x3f6d3ec4
.long 0x3f80,0xbf35bf35,0x3f80248d,0xbf353f35,0x250dbf80,0x3f6d3ec4,0xbf353f35,0xbec4bf6d
.long 0x3f80,0xbf80a554,0x250dbf80,0x3f80248d,0x250dbf80,0x3f6dbec4,0x3f353f35,0xbec43f6d
.long 0x3f80,0xbf353f35,0xbf80a554,0xbf35bf35,0x250dbf80,0x3ec4bf6d,0x3f35bf35,0x3f6dbec4
.long 0x3f80,0x3f80,0x3f80,0x3f80,0xbf80a554,0xbf6d3ec4,0xbf353f35,0xbec43f6d
.long 0x250dbf80,0xbf35bf35,0xbf80a554,0xbf353f35,0x3f80248d,0x3ec4bf6d,0xbf35bf35,0xbf6d3ec4
.long 0x3f80,0x3f80248d,0x250dbf80,0xbf80a554,0xbf80a554,0x3ec43f6d,0x3f35bf35,0xbf6dbec4
.long 0x250dbf80,0xbf353f35,0x3f80248d,0xbf35bf35,0x3f80248d,0xbf6dbec4,0x3f353f35,0xbec4bf6d
.long 0x3f80,0x250dbf80,0x3f80,0x250dbf80,0xbf80a554,0x3f6dbec4,0xbf353f35,0x3ec4bf6d
.long 0x250dbf80,0x3f353f35,0xbf80a554,0x3f35bf35,0x3f80248d,0xbec43f6d,0xbf35bf35,0x3f6dbec4
.long 0x3f80,0xbf80a554,0x250dbf80,0x3f80248d,0xbf80a554,0xbec4bf6d,0x3f35bf35,0x3f6d3ec4
.long 0x250dbf80,0x3f35bf35,0x3f80248d,0x3f353f35,0x3f80248d,0x3f6d3ec4,0x3f353f35,0x3ec43f6d
.long 0x3f808000,0x3f808000,0x3f808000,0x3f808000,0x3f808000,0x3f6dbec4,0x3f35bf35,0x3ec4bf6d
.long 0x3f808000,0x3f35bf35,0x248dbf80,0xbf35bf35,0x3f808000,0x3ec4bf6d,0xbf35bf35,0xbf6d3ec4
.long 0x3f808000,0x248dbf80,0xbf80a50d,0xa5543f80,0x3f808000,0xbec4bf6d,0xbf353f35,0x3f6d3ec4
.long 0x3f808000,0xbf35bf35,0xa5543f80,0x3f35bf35,0x3f808000,0xbf6dbec4,0x3f353f35,0xbec4bf6d
.long 0x3f808000,0xbf80a50d,0x3f808000,0xbf80a50d,0x3f808000,0xbf6d3ec4,0x3f35bf35,0xbec43f6d
.long 0x3f808000,0xbf353f35,0x248dbf80,0x3f353f35,0x3f808000,0xbec43f6d,0xbf35bf35,0x3f6dbec4
.long 0x3f808000,0xa5543f80,0xbf80a50d,0x248dbf80,0x3f808000,0x3ec43f6d,0xbf353f35,0xbf6dbec4
.long 0x3f808000,0x3f353f35,0xa5543f80,0xbf353f35,0x3f808000,0x3f6d3ec4,0x3f353f35,0x3ec43f6d
.long 0x3f808000,0x3f808000,0x3f808000,0x3f808000,0x248dbf80,0xbec4bf6d,0xbf35bf35,0xbf6dbec4
.long 0xbf80a50d,0xbf353f35,0xa5543f80,0x3f353f35,0xa5543f80,0x3f6d3ec4,0x3f35bf35,0xbec4bf6d
.long 0x3f808000,0x248dbf80,0xbf80a50d,0xa5543f80,0x248dbf80,0xbf6d3ec4,0x3f353f35,0x3ec4bf6d
.long 0xbf80a50d,0x3f353f35,0x248dbf80,0xbf353f35,0xa5543f80,0x3ec4bf6d,0xbf353f35,0x3f6dbec4
.long 0x3f808000,0xbf80a50d,0x3f808000,0xbf80a50d,0x248dbf80,0x3ec43f6d,0xbf35bf35,0x3f6d3ec4
.long 0xbf80a50d,0x3f35bf35,0xa5543f80,0xbf35bf35,0xa5543f80,0xbf6dbec4,0x3f35bf35,0x3ec43f6d
.long 0x3f808000,0xa5543f80,0xbf80a50d,0x248dbf80,0x248dbf80,0x3f6dbec4,0x3f353f35,0xbec43f6d
.long 0xbf80a50d,0xbf35bf35,0x248dbf80,0x3f35bf35,0xa5543f80,0xbec43f6d,0xbf353f35,0xbf6d3ec4
.long 0x3f808000,0x3f808000,0x3f808000,0x3f808000,0xbf80a50d,0xbf6d3ec4,0xbf353f35,0xbec43f6d
.long 0x3f808000,0x3f35bf35,0x248dbf80,0xbf35bf35,0xbf80a50d,0xbec43f6d,0x3f353f35,0x3f6dbec4
.long 0x3f808000,0x248dbf80,0xbf80a50d,0xa5543f80,0xbf80a50d,0x3ec43f6d,0x3f35bf35,0xbf6dbec4
.long 0x3f808000,0xbf35bf35,0xa5543f80,0x3f35bf35,0xbf80a50d,0x3f6d3ec4,0xbf35bf35,0x3ec43f6d
.long 0x3f808000,0xbf80a50d,0x3f808000,0xbf80a50d,0xbf80a50d,0x3f6dbec4,0xbf353f35,0x3ec4bf6d
.long 0x3f808000,0xbf353f35,0x248dbf80,0x3f353f35,0xbf80a50d,0x3ec4bf6d,0x3f353f35,0xbf6d3ec4
.long 0x3f808000,0xa5543f80,0xbf80a50d,0x248dbf80,0xbf80a50d,0xbec4bf6d,0x3f35bf35,0x3f6d3ec4
.long 0x3f808000,0x3f353f35,0xa5543f80,0xbf353f35,0xbf80a50d,0xbf6dbec4,0xbf35bf35,0xbec4bf6d
.long 0x3f808000,0x3f808000,0x3f808000,0x3f808000,0xa5543f80,0x3ec43f6d,0x3f353f35,0x3f6d3ec4
.long 0xbf80a50d,0xbf353f35,0xa5543f80,0x3f353f35,0x248dbf80,0xbf6dbec4,0xbf353f35,0x3ec43f6d
.long 0x3f808000,0x248dbf80,0xbf80a50d,0xa5543f80,0xa5543f80,0x3f6dbec4,0xbf35bf35,0xbec43f6d
.long 0xbf80a50d,0x3f353f35,0x248dbf80,0xbf353f35,0x248dbf80,0xbec43f6d,0x3f35bf35,0xbf6d3ec4
.long 0x3f808000,0xbf80a50d,0x3f808000,0xbf80a50d,0xa5543f80,0xbec4bf6d,0x3f353f35,0xbf6dbec4
.long 0xbf80a50d,0x3f35bf35,0xa5543f80,0xbf35bf35,0x248dbf80,0x3f6d3ec4,0xbf353f35,0xbec4bf6d
.long 0x3f808000,0xa5543f80,0xbf80a50d,0x248dbf80,0xa5543f80,0xbf6d3ec4,0xbf35bf35,0x3ec4bf6d
.long 0xbf80a50d,0xbf35bf35,0x248dbf80,0x3f35bf35,0x248dbf80,0x3ec4bf6d,0x3f35bf35,0x3f6dbec4
.long 0x80003b80,0x80003b80,0x80003b80,0x80003b80,0x80003b80,0xbac43b6d,0xbb353b35,0xbb6d3ac4
.long 0x80003b80,0xbb353b35,0xbb80208d,0xbb35bb35,0x80003b80,0xbb6d3ac4,0xbb35bb35,0x3ac4bb6d
.long 0x80003b80,0xbb80208d,0xa10dbb80,0x3b80a154,0x80003b80,0xbb6dbac4,0x3b35bb35,0x3ac43b6d
.long 0x80003b80,0xbb35bb35,0x3b80a154,0xbb353b35,0x80003b80,0xbac4bb6d,0x3b353b35,0xbb6dbac4
.long 0x80003b80,0xa10dbb80,0x80003b80,0xa10dbb80,0x80003b80,0x3ac4bb6d,0xbb353b35,0x3b6dbac4
.long 0x80003b80,0x3b35bb35,0xbb80208d,0x3b353b35,0x80003b80,0x3b6dbac4,0xbb35bb35,0xbac43b6d
.long 0x80003b80,0x3b80a154,0xa10dbb80,0xbb80208d,0x80003b80,0x3b6d3ac4,0x3b35bb35,0xbac4bb6d
.long 0x80003b80,0x3b353b35,0x3b80a154,0x3b35bb35,0x80003b80,0x3ac43b6d,0x3b353b35,0x3b6d3ac4
.long 0x80003b80,0x80003b80,0x80003b80,0x80003b80,0xbb80208d,0xbb6dbac4,0xbb35bb35,0xbac4bb6d
.long 0xa10dbb80,0x3b35bb35,0x3b80a154,0x3b353b35,0x3b80a154,0x3ac43b6d,0xbb353b35,0xbb6dbac4
.long 0x80003b80,0xbb80208d,0xa10dbb80,0x3b80a154,0xbb80208d,0x3ac4bb6d,0x3b353b35,0xbb6d3ac4
.long 0xa10dbb80,0x3b353b35,0xbb80208d,0x3b35bb35,0x3b80a154,0xbb6d3ac4,0x3b35bb35,0xbac43b6d
.long 0x80003b80,0xa10dbb80,0x80003b80,0xa10dbb80,0xbb80208d,0x3b6d3ac4,0xbb35bb35,0x3ac43b6d
.long 0xa10dbb80,0xbb353b35,0x3b80a154,0xbb35bb35,0x3b80a154,0xbac4bb6d,0xbb353b35,0x3b6d3ac4
.long 0x80003b80,0x3b80a154,0xa10dbb80,0xbb80208d,0xbb80208d,0xbac43b6d,0x3b353b35,0x3b6dbac4
.long 0xa10dbb80,0xbb35bb35,0xbb80208d,0xbb353b35,0x3b80a154,0x3b6dbac4,0x3b35bb35,0x3ac4bb6d
.long 0x80003b80,0x80003b80,0x80003b80,0x80003b80,0xa10dbb80,0x3ac4bb6d,0x3b35bb35,0x3b6dbac4
.long 0x80003b80,0xbb353b35,0xbb80208d,0xbb35bb35,0xa10dbb80,0x3b6dbac4,0x3b353b35,0xbac43b6d
.long 0x80003b80,0xbb80208d,0xa10dbb80,0x3b80a154,0xa10dbb80,0x3b6d3ac4,0xbb353b35,0xbac4bb6d
.long 0x80003b80,0xbb35bb35,0x3b80a154,0xbb353b35,0xa10dbb80,0x3ac43b6d,0xbb35bb35,0x3b6d3ac4
.long 0x80003b80,0xa10dbb80,0x80003b80,0xa10dbb80,0xa10dbb80,0xbac43b6d,0x3b35bb35,0xbb6d3ac4
.long 0x80003b80,0x3b35bb35,0xbb80208d,0x3b353b35,0xa10dbb80,0xbb6d3ac4,0x3b353b35,0x3ac4bb6d
.long 0x80003b80,0x3b80a154,0xa10dbb80,0xbb80208d,0xa10dbb80,0xbb6dbac4,0xbb353b35,0x3ac43b6d
.long 0x80003b80,0x3b353b35,0x3b80a154,0x3b35bb35,0xa10dbb80,0xbac4bb6d,0xbb35bb35,0xbb6dbac4
.long 0x80003b80,0x80003b80,0x80003b80,0x80003b80,0x3b80a154,0x3b6d3ac4,0x3b353b35,0x3ac43b6d
.long 0xa10dbb80,0x3b35bb35,0x3b80a154,0x3b353b35,0xbb80208d,0xbac4bb6d,0x3b35bb35,0x3b6d3ac4
.long 0x80003b80,0xbb80208d,0xa10dbb80,0x3b80a154,0x3b80a154,0xbac43b6d,0xbb35bb35,0x3b6dbac4
.long 0xa10dbb80,0x3b353b35,0xbb80208d,0x3b35bb35,0xbb80208d,0x3b6dbac4,0xbb353b35,0x3ac4bb6d
.long 0x80003b80,0xa10dbb80,0x80003b80,0xa10dbb80,0x3b80a154,0xbb6dbac4,0x3b353b35,0xbac4bb6d
.long 0xa10dbb80,0xbb353b35,0x3b80a154,0xbb35bb35,0xbb80208d,0x3ac43b6d,0x3b35bb35,0xbb6dbac4
.long 0x80003b80,0x3b80a154,0xa10dbb80,0xbb80208d,0x3b80a154,0x3ac4bb6d,0xbb35bb35,0xbb6d3ac4
.long 0xa10dbb80,0xbb35bb35,0xbb80208d,0xbb353b35,0xbb80208d,0xbb6d3ac4,0xbb353b35,0xbac43b6d
.long 0x3b800000,0x3b800000,0x3b800000,0x3b800000,0x3b800000,0x3b6d3ac4,0x3b353b35,0x3ac43b6d
.long 0x3b800000,0x3b353b35,0x208d3b80,0xbb353b35,0x3b800000,0x3ac43b6d,0xbb353b35,0xbb6dbac4
.long 0x3b800000,0x208d3b80,0xbb80210d,0xa154bb80,0x3b800000,0xbac43b6d,0xbb35bb35,0x3b6dbac4
.long 0x3b800000,0xbb353b35,0xa154bb80,0x3b353b35,0x3b800000,0xbb6d3ac4,0x3b35bb35,0xbac43b6d
.long 0x3b800000,0xbb80210d,0x3b800000,0xbb80210d,0x3b800000,0xbb6dbac4,0x3b353b35,0xbac4bb6d
.long 0x3b800000,0xbb35bb35,0x208d3b80,0x3b35bb35,0x3b800000,0xbac4bb6d,0xbb353b35,0x3b6d3ac4
.long 0x3b800000,0xa154bb80,0xbb80210d,0x208d3b80,0x3b800000,0x3ac4bb6d,0xbb35bb35,0xbb6d3ac4
.long 0x3b800000,0x3b35bb35,0xa154bb80,0xbb35bb35,0x3b800000,0x3b6dbac4,0x3b35bb35,0x3ac4bb6d
.long 0x3b800000,0x3b800000,0x3b800000,0x3b800000,0x208d3b80,0xbac43b6d,0xbb353b35,0xbb6d3ac4
.long 0xbb80210d,0xbb35bb35,0xa154bb80,0x3b35bb35,0xa154bb80,0x3b6dbac4,0x3b353b35,0xbac43b6d
.long 0x3b800000,0x208d3b80,0xbb80210d,0xa154bb80,0x208d3b80,0xbb6dbac4,0x3b35bb35,0x3ac43b6d
.long 0xbb80210d,0x3b35bb35,0x208d3b80,0xbb35bb35,0xa154bb80,0x3ac43b6d,0xbb35bb35,0x3b6d3ac4
.long 0x3b800000,0xbb80210d,0x3b800000,0xbb80210d,0x208d3b80,0x3ac4bb6d,0xbb353b35,0x3b6dbac4
.long 0xbb80210d,0x3b353b35,0xa154bb80,0xbb353b35,0xa154bb80,0xbb6d3ac4,0x3b353b35,0x3ac4bb6d
.long 0x3b800000,0xa154bb80,0xbb80210d,0x208d3b80,0x208d3b80,0x3b6d3ac4,0x3b35bb35,0xbac4bb6d
.long 0xbb80210d,0xbb353b35,0x208d3b80,0x3b353b35,0xa154bb80,0xbac4bb6d,0xbb35bb35,0xbb6dbac4
.long 0x3b800000,0x3b800000,0x3b800000,0x3b800000,0xbb80210d,0xbb6dbac4,0xbb35bb35,0xbac4bb6d
.long 0x3b800000,0x3b353b35,0x208d3b80,0xbb353b35,0xbb80210d,0xbac4bb6d,0x3b35bb35,0x3b6d3ac4
.long 0x3b800000,0x208d3b80,0xbb80210d,0xa154bb80,0xbb80210d,0x3ac4bb6d,0x3b353b35,0xbb6d3ac4
.long 0x3b800000,0xbb353b35,0xa154bb80,0x3b353b35,0xbb80210d,0x3b6dbac4,0xbb353b35,0x3ac4bb6d
.long 0x3b800000,0xbb80210d,0x3b800000,0xbb80210d,0xbb80210d,0x3b6d3ac4,0xbb35bb35,0x3ac43b6d
.long 0x3b800000,0xbb35bb35,0x208d3b80,0x3b35bb35,0xbb80210d,0x3ac43b6d,0x3b35bb35,0xbb6dbac4
.long 0x3b800000,0xa154bb80,0xbb80210d,0x208d3b80,0xbb80210d,0xbac43b6d,0x3b353b35,0x3b6dbac4
.long 0x3b800000,0x3b35bb35,0xa154bb80,0xbb35bb35,0xbb80210d,0xbb6d3ac4,0xbb353b35,0xbac43b6d
.long 0x3b800000,0x3b800000,0x3b800000,0x3b800000,0xa154bb80,0x3ac4bb6d,0x3b35bb35,0x3b6dbac4
.long 0xbb80210d,0xbb35bb35,0xa154bb80,0x3b35bb35,0x208d3b80,0xbb6d3ac4,0xbb35bb35,0x3ac4bb6d
.long 0x3b800000,0x208d3b80,0xbb80210d,0xa154bb80,0xa154bb80,0x3b6d3ac4,0xbb353b35,0xbac4bb6d
.long 0xbb80210d,0x3b35bb35,0x208d3b80,0xbb35bb35,0x208d3b80,0xbac4bb6d,0x3b353b35,0xbb6dbac4
.long 0x3b800000,0xbb80210d,0x3b800000,0xbb80210d,0xa154bb80,0xbac43b6d,0x3b35bb35,0xbb6d3ac4
.long 0xbb80210d,0x3b353b35,0xa154bb80,0xbb353b35,0x208d3b80,0x3b6dbac4,0xbb35bb35,0xbac43b6d
.long 0x3b800000,0xa154bb80,0xbb80210d,0x208d3b80,0xa154bb80,0xbb6dbac4,0xbb353b35,0x3ac43b6d
.long 0xbb80210d,0xbb353b35,0x208d3b80,0x3b353b35,0x208d3b80,0x3ac43b6d,0x3b353b35,0x3b6d3ac4
.long 0x3f800000,0x3f800000,0x3f800000,0x3f800000,0x3f800000,0x3f7fec43,0x3f7fb10f,0x3f7f4e6d
.long 0x3f800000,0x3f7fb10f,0x3f7ec46d,0x3f7d3aac,0x3f800000,0x3f7f4e6d,0x3f7d3aac,0x3f79c79d
.long 0x3f800000,0x3f7ec46d,0x3f7b14be,0x3f74fa0b,0x3f800000,0x3f7e1324,0x3f7853f8,0x3f6ed89e
.long 0x3f800000,0x3f7d3aac,0x3f74fa0b,0x3f676bd8,0x3f800000,0x3f7c3b28,0x3f710908,0x3f5ebe05
.long 0x3f800000,0x3f7b14be,0x3f6c835e,0x3f54db31,0x3f800000,0x3f79c79d,0x3f676bd8,0x3f49d112
.long 0x3f800000,0x3f7853f8,0x3f61c598,0x3f3daef9,0x3f800000,0x3f76ba07,0x3f5b941a,0x3f3085bb
.long 0x3f800000,0x3f74fa0b,0x3f54db31,0x3f226799,0x3f800000,0x3f731447,0x3f4d9f02,0x3f13682a
.long 0x3f800000,0x3f710908,0x3f45e403,0x3f039c3d,0x3f800000,0x3f6ed89e,0x3f3daef9,0x3ee63375
.long 0x3f800000,0x3f800000,0x3f800000,0x3f800000,0x3f7ec46d,0x3f7e1324,0x3f7d3aac,0x3f7c3b28
.long 0x3f7b14be,0x3f7853f8,0x3f74fa0b,0x3f710908,0x3f74fa0b,0x3f6ed89e,0x3f676bd8,0x3f5ebe05
.long 0x3f6c835e,0x3f61c598,0x3f54db31,0x3f45e403,0x3f61c598,0x3f514d3d,0x3f3daef9,0x3f273656
.long 0x3f54db31,0x3f3daef9,0x3f226799,0x3f039c3d,0x3f45e403,0x3f273656,0x3f039c3d,0x3eb8442a
.long 0x3f3504f3,0x3f0e39da,0x3ec3ef15,0x3e47c5c2,0x3f226799,0x3ee63375,0x3e78cfcc,0x3cc90ab0
.long 0x3f0e39da,0x3eac7cd4,0x3dc8bd36,0xbe164083,0x3ef15aea,0x3e605c13,0xbd48fb30,0xbea09ae5
.long 0x3ec3ef15,0x3dc8bd36,0xbe47c5c2,0xbef15aea,0x3e94a031,0xbcc90ab0,0xbeac7cd4,0xbf1d7fd1
.long 0x3e47c5c2,0xbe164083,0xbef15aea,0xbf3daef9,0x3dc8bd36,0xbe888e93,0xbf187fc0,0xbf584853
.long 0x3f800000,0x3f800000,0x3f800000,0x3f800000,0x3f7b14be,0x3f79c79d,0x3f7853f8,0x3f76ba07
.long 0x3f6c835e,0x3f676bd8,0x3f61c598,0x3f5b941a,0x3f54db31,0x3f49d112,0x3f3daef9,0x3f3085bb
.long 0x3f3504f3,0x3f226799,0x3f0e39da,0x3ef15aea,0x3f0e39da,0x3ee63375,0x3eac7cd4,0x3e605c13
.long 0x3ec3ef15,0x3e78cfcc,0x3dc8bd36,0xbd48fb30,0x3e47c5c2,0x3cc90ab0,0xbe164083,0xbea09ae5
.long 0x248d3132,0xbe47c5c2,0xbec3ef15,0xbf0e39da,0xbe47c5c2,0xbecf7bca,0xbf187fc0,0xbf41d870
.long 0xbec3ef15,0xbf187fc0,0xbf45e403,0xbf676bd8,0xbf0e39da,0xbf41d870,0xbf676bd8,0xbf7c3b28
.long 0xbf3504f3,0xbf61c598,0xbf7b14be,0xbf7ec46d,0xbf54db31,0xbf76ba07,0xbf7fb10f,0xbf6ed89e
.long 0xbf6c835e,0xbf7fb10f,0xbf74fa0b,0xbf4d9f02,0xbf7b14be,0xbf7c3b28,0xbf5b941a,0xbf1d7fd1
.long 0x3f800000,0x3f800000,0x3f800000,0x3f800000,0x3f74fa0b,0x3f731447,0x3f710908,0x3f6ed89e
.long 0x3f54db31,0x3f4d9f02,0x3f45e403,0x3f3daef9,0x3f226799,0x3f13682a,0x3f039c3d,0x3ee63375
.long 0x3ec3ef15,0x3e94a031,0x3e47c5c2,0x3dc8bd36,0x3dc8bd36,0xbcc90ab0,0xbe164083,0xbe888e93
.long 0xbe47c5c2,0xbeac7cd4,0xbef15aea,0xbf187fc0,0xbef15aea,0xbf1d7fd1,0xbf3daef9,0xbf584853
.long 0xbf3504f3,0xbf54db31,0xbf6c835e,0xbf7b14be,0xbf61c598,0xbf76ba07,0xbf7fb10f,0xbf7c3b28
.long 0xbf7b14be,0xbf7fb10f,0xbf74fa0b,0xbf5b941a,0xbf7ec46d,0xbf6ed89e,0xbf4d9f02,0xbf1d7fd1
.long 0xbf6c835e,0xbf45e403,0xbf0e39da,0xbe94a031,0xbf45e403,0xbf08f59b,0xbe78cfcc,0x3d96a905
.long 0xbf0e39da,0xbe78cfcc,0x3dc8bd36,0x3edae880,0xbe94a031,0x3d96a905,0x3edae880,0x3f396842
.long 0x0,0x0,0x0,0x0,0x0,0x3cc90ab0,0x3d48fb30,0x3d96a905
.long 0x0,0x3d48fb30,0x3dc8bd36,0x3e164083,0x0,0x3d96a905,0x3e164083,0x3e605c13
.long 0x0,0x3dc8bd36,0x3e47c5c2,0x3e94a031,0x0,0x3dfab273,0x3e78cfcc,0x3eb8442a
.long 0x0,0x3e164083,0x3e94a031,0x3edae880,0x0,0x3e2f10a2,0x3eac7cd4,0x3efc5d27
.long 0x0,0x3e47c5c2,0x3ec3ef15,0x3f0e39da,0x0,0x3e605c13,0x3edae880,0x3f1d7fd1
.long 0x0,0x3e78cfcc,0x3ef15aea,0x3f2beb4a,0x0,0x3e888e93,0x3f039c3d,0x3f396842
.long 0x0,0x3e94a031,0x3f0e39da,0x3f45e403,0x0,0x3ea09ae5,0x3f187fc0,0x3f514d3d
.long 0x0,0x3eac7cd4,0x3f226799,0x3f5b941a,0x0,0x3eb8442a,0x3f2beb4a,0x3f64aa59
.long 0x0,0x0,0x0,0x0,0x3dc8bd36,0x3dfab273,0x3e164083,0x3e2f10a2
.long 0x3e47c5c2,0x3e78cfcc,0x3e94a031,0x3eac7cd4,0x3e94a031,0x3eb8442a,0x3edae880,0x3efc5d27
.long 0x3ec3ef15,0x3ef15aea,0x3f0e39da,0x3f226799,0x3ef15aea,0x3f13682a,0x3f2beb4a,0x3f41d870
.long 0x3f0e39da,0x3f2beb4a,0x3f45e403,0x3f5b941a,0x3f226799,0x3f41d870,0x3f5b941a,0x3f6ed89e
.long 0x3f3504f3,0x3f54db31,0x3f6c835e,0x3f7b14be,0x3f45e403,0x3f64aa59,0x3f7853f8,0x3f7fec43
.long 0x3f54db31,0x3f710908,0x3f7ec46d,0x3f7d3aac,0x3f61c598,0x3f79c79d,0x3f7fb10f,0x3f731447
.long 0x3f6c835e,0x3f7ec46d,0x3f7b14be,0x3f61c598,0x3f74fa0b,0x3f7fec43,0x3f710908,0x3f49d112
.long 0x3f7b14be,0x3f7d3aac,0x3f61c598,0x3f2beb4a,0x3f7ec46d,0x3f76ba07,0x3f4d9f02,0x3f08f59b
.long 0x0,0x0,0x0,0x0,0x3e47c5c2,0x3e605c13,0x3e78cfcc,0x3e888e93
.long 0x3ec3ef15,0x3edae880,0x3ef15aea,0x3f039c3d,0x3f0e39da,0x3f1d7fd1,0x3f2beb4a,0x3f396842
.long 0x3f3504f3,0x3f45e403,0x3f54db31,0x3f61c598,0x3f54db31,0x3f64aa59,0x3f710908,0x3f79c79d
.long 0x3f6c835e,0x3f7853f8,0x3f7ec46d,0x3f7fb10f,0x3f7b14be,0x3f7fec43,0x3f7d3aac,0x3f731447
.long 0x3f800000,0x3f7b14be,0x3f6c835e,0x3f54db31,0x3f7b14be,0x3f6a09a7,0x3f4d9f02,0x3f273656
.long 0x3f6c835e,0x3f4d9f02,0x3f226799,0x3edae880,0x3f54db31,0x3f273656,0x3edae880,0x3e2f10a2
.long 0x3f3504f3,0x3ef15aea,0x3e47c5c2,0xbdc8bd36,0x3f0e39da,0x3e888e93,0xbd48fb30,0xbeb8442a
.long 0x3ec3ef15,0x3d48fb30,0xbe94a031,0xbf187fc0,0x3e47c5c2,0xbe2f10a2,0xbf039c3d,0xbf49d112
.long 0x0,0x0,0x0,0x0,0x3e94a031,0x3ea09ae5,0x3eac7cd4,0x3eb8442a
.long 0x3f0e39da,0x3f187fc0,0x3f226799,0x3f2beb4a,0x3f45e403,0x3f514d3d,0x3f5b941a,0x3f64aa59
.long 0x3f6c835e,0x3f74fa0b,0x3f7b14be,0x3f7ec46d,0x3f7ec46d,0x3f7fec43,0x3f7d3aac,0x3f76ba07
.long 0x3f7b14be,0x3f710908,0x3f61c598,0x3f4d9f02,0x3f61c598,0x3f49d112,0x3f2beb4a,0x3f08f59b
.long 0x3f3504f3,0x3f0e39da,0x3ec3ef15,0x3e47c5c2,0x3ef15aea,0x3e888e93,0x3d48fb30,0xbe2f10a2
.long 0x3e47c5c2,0xbd48fb30,0xbe94a031,0xbf039c3d,0xbdc8bd36,0xbeb8442a,0xbf187fc0,0xbf49d112
.long 0xbec3ef15,0xbf226799,0xbf54db31,0xbf74fa0b,0xbf226799,0xbf584853,0xbf7853f8,0xbf7f4e6d
.long 0xbf54db31,0xbf7853f8,0xbf7ec46d,0xbf676bd8,0xbf74fa0b,0xbf7f4e6d,0xbf676bd8,0xbf3085bb
L_table_end:
.size L_table, L_table_end-L_table
.section .rodata,"a"
.p2align 6
.amdhsa_kernel interleave_layers__spectral_gfnet__mixer_token_mlp__prompt_kernel
  .amdhsa_next_free_vgpr 512
  .amdhsa_next_free_sgpr 102
  .amdhsa_accum_offset 256
  .amdhsa_group_segment_fixed_size 0
  .amdhsa_kernarg_size 88
  .amdhsa_user_sgpr_count 2
  .amdhsa_user_sgpr_kernarg_segment_ptr 1
  .amdhsa_system_sgpr_workgroup_id_x 1
.end_amdhsa_kernel
```
